```python
import torch

def _softmax(x, axis=-1):
    return torch.softmax(x, dim=axis)
def _gelu(x):
    return torch.nn.functional.gelu(x, approximate="tanh")
def _silu(x):
    return torch.nn.functional.silu(x)
def _sigmoid(x):
    return torch.sigmoid(x)
def _layernorm(x, axis=-1, eps=1e-5):
    m = x.mean(dim=axis, keepdim=True)
    v = x.var(dim=axis, keepdim=True, unbiased=False)
    return (x - m) / torch.sqrt(v + eps)
def _scatter_add(tgt, idx, src, axis=0):
    return tgt.clone().index_add_(axis, idx, src)
def _segment_sum(src, seg, n):
    out = torch.zeros((n,) + src.shape[1:], dtype=src.dtype)
    return out.index_add_(0, seg, src)
def _pad(x, pw):
    flat = tuple(v for pair in reversed(pw) for v in pair)
    return torch.nn.functional.pad(x, flat)

kernel_name = 'interleave_layers__grouped_kv_mqa__dense_activation_silu__prompt'

def setup_inputs():

    _w = (lambda a: (lambda t: t.to(torch.bfloat16) if t.is_floating_point() else t)(torch.as_tensor(a)))
    def _A_setup():
        B, S, D, H = 1, 2048, 1024, 32
        Dh = D // H
        return {
            "x": _w((lambda *s: torch.randn(*s, dtype=torch.bfloat16) * 0.05)(B, S, D)),
            "wq": _w((lambda *s: torch.randn(*s, dtype=torch.bfloat16) * 0.05)(D, H * Dh)),
            "wk": _w((lambda *s: torch.randn(*s, dtype=torch.bfloat16) * 0.05)(D, Dh)),
            "wv": _w((lambda *s: torch.randn(*s, dtype=torch.bfloat16) * 0.05)(D, Dh)),
            "wo": _w((lambda *s: torch.randn(*s, dtype=torch.bfloat16) * 0.05)(H * Dh, D)),
        }
    _A_in = _A_setup()

    def _B_setup():
        B, S, D, F = 1, 2048, 1024, 3584
        return {
            "x": _w((lambda *s: torch.randn(*s, dtype=torch.bfloat16) * 0.05)(B, S, D)),
            "w1": _w((lambda *s: torch.randn(*s, dtype=torch.bfloat16) * 1.6)(D, F) * (D ** -0.5)),
            "w2": _w((lambda *s: torch.randn(*s, dtype=torch.bfloat16) * 1.6)(F, D) * (F ** -0.5)),
        }
    _B_in = _B_setup()

    return {
        "A_x": _A_in["x"],
        "A_wq": _A_in["wq"],
        "A_wk": _A_in["wk"],
        "A_wv": _A_in["wv"],
        "A_wo": _A_in["wo"],
        "B_x": _B_in["x"],
        "B_w1": _B_in["w1"],
        "B_w2": _B_in["w2"],
    }

def reference(A_x, A_wq, A_wk, A_wv, A_wo, B_x, B_w1, B_w2):
    def _A_ref(x, wq, wk, wv, wo):
        B, S, D = x.shape
        H = 32
        Dh = D // H
        q = (lambda x, *d: x.permute(*d))((x @ wq).reshape(B, S, H, Dh), 0, 2, 1, 3)
        k = x @ wk
        v = x @ wv
        scores = torch.einsum("bhqd,bkd->bhqk", q, k) * (Dh ** -0.5)
        p = _softmax(scores, axis=-1)
        o = torch.einsum("bhqk,bkd->bhqd", p, v)
        return (lambda x, *d: x.permute(*d))(o, 0, 2, 1, 3).reshape(B, S, H * Dh) @ wo

    def _B_ref(x, w1, w2):
        h = torch.einsum("bsd,df->bsf", x, w1)
        h = _silu(h)
        out = torch.einsum("bsf,fd->bsd", h, w2)
        return out

    x = A_x
    x = x + _A_ref(_layernorm(x, axis=-1), A_wq, A_wk, A_wv, A_wo)
    x = x + _B_ref(_layernorm(x, axis=-1), B_w1, B_w2)
    x = x + _A_ref(_layernorm(x, axis=-1), A_wq, A_wk, A_wv, A_wo)
    x = x + _B_ref(_layernorm(x, axis=-1), B_w1, B_w2)
    return x
```

```asm
; @launch grid=(256,1,1) block=(512,1,1) lds=163840
.amdgcn_target "amdgcn-amd-amdhsa--gfx950"
.text
.globl interleave_layers__grouped_kv_mqa__dense_activation_silu__prompt_kernel
.p2align 8
.type interleave_layers__grouped_kv_mqa__dense_activation_silu__prompt_kernel,@function
interleave_layers__grouped_kv_mqa__dense_activation_silu__prompt_kernel:
    s_cmp_ge_u32 s2, 256
    s_cbranch_scc1 k_exit
    s_load_dwordx8 s[40:47], s[0:1], 0
    s_load_dwordx2 s[74:75], s[0:1], 32
    s_load_dwordx4 s[76:79], s[0:1], 48
    s_load_dwordx4 s[48:51], s[0:1], 64
    s_load_dwordx2 s[72:73], s[0:1], 80
    s_mov_b32 s3, 0
    s_and_b32 s7, s2, 7
    s_lshr_b32 s5, s2, 3
    s_lshr_b32 s4, s7, 1
    s_lshl_b32 s4, s4, 2
    s_lshr_b32 s6, s5, 3
    s_add_u32 s4, s4, s6
    s_and_b32 s5, s5, 7
    s_and_b32 s7, s7, 1
    s_lshl_b32 s5, s5, 1
    s_add_u32 s5, s5, s7
    v_lshrrev_b32 v1, 6, v0
    v_and_b32 v0, 63, v0
    s_lshl_b32 s37, s4, 4
    v_readfirstlane_b32 s6, v1
    s_add_u32 s37, s37, s5
    s_mov_b32 s36, 0
    s_mov_b32 s38, 0x4500000
    s_and_b32 s7, s6, 3
    s_waitcnt lgkmcnt(0)
    s_mov_b32 s8, s72
    s_mov_b32 s9, s73
    s_mov_b32 s10, 0x10000000
    s_mov_b32 s11, 0x20000
    s_mov_b32 s12, s40
    s_mov_b32 s13, s41
    s_mov_b32 s14, 0x400000
    s_mov_b32 s15, 0x20000
    s_add_u32 s16, s72, 0x4000000
    s_addc_u32 s17, s73, 0
    s_mov_b32 s18, 0x400000
    s_mov_b32 s19, 0x20000
    s_mov_b32 s20, s42
    s_mov_b32 s21, s43
    s_mov_b32 s22, 0x200000
    s_mov_b32 s23, 0x20000
    s_bitcmp1_b32 s5, 0
    s_cselect_b32 s44, s46, s44
    s_cselect_b32 s45, s47, s45
    s_mov_b32 s24, s44
    s_mov_b32 s25, s45
    s_mov_b32 s26, 0x10000
    s_mov_b32 s27, 0x20000
    s_mov_b32 s28, s74
    s_mov_b32 s29, s75
    s_mov_b32 s30, 0x200000
    s_mov_b32 s31, 0x20000
    s_mov_b32 s32, s50
    s_mov_b32 s33, s51
    s_mov_b32 s34, 0x100
    s_mov_b32 s35, 0x20000
    s_mov_b32 s70, s48
    s_mov_b32 s71, s49
    s_cmp_lt_u32 s6, 4
    s_cbranch_scc1 k_comp
qkv_loader:
    v_lshrrev_b32 v12, 4, v0
    v_and_b32 v13, 15, v0
    v_xor_b32 v9, v13, v12
    v_lshlrev_b32 v12, 11, v12
    v_xor_b32 v156, 0, v9
    v_lshl_add_u32 v156, v156, 4, v12
    v_add_u32 v156, 0, v156
    v_xor_b32 v157, 4, v9
    v_lshl_add_u32 v157, v157, 4, v12
    v_add_u32 v157, 8192, v157
    v_xor_b32 v158, 8, v9
    v_lshl_add_u32 v158, v158, 4, v12
    v_add_u32 v158, 16384, v158
    v_xor_b32 v159, 12, v9
    v_lshl_add_u32 v159, v159, 4, v12
    v_add_u32 v159, 24576, v159
    s_lshl_b32 s68, s7, 12
    s_add_u32 s68, s68, 32768
    s_lshr_b32 s52, s37, 1
    s_lshl_b32 s52, s52, 15
    s_lshl_b32 s53, s7, 9
    s_add_u32 s52, s52, s53
    s_mov_b32 s59, 256
    s_cmp_lg_u32 s3, 0
    s_cbranch_scc1 qkv_nox
    s_add_u32 m0, s68, 0
    s_nop 0
    buffer_load_dwordx4 v156, s[12:15], s52 offen sc1 lds
    s_add_u32 m0, s68, 1024
    s_nop 0
    buffer_load_dwordx4 v157, s[12:15], s52 offen sc1 lds
    s_add_u32 m0, s68, 2048
    s_nop 0
    buffer_load_dwordx4 v158, s[12:15], s52 offen sc1 lds
    s_add_u32 m0, s68, 3072
    s_nop 0
    buffer_load_dwordx4 v159, s[12:15], s52 offen sc1 lds
    s_add_u32 s52, s52, s59
    s_add_u32 m0, s68, 16384
    s_nop 0
    buffer_load_dwordx4 v156, s[12:15], s52 offen sc1 lds
    s_add_u32 m0, s68, 17408
    s_nop 0
    buffer_load_dwordx4 v157, s[12:15], s52 offen sc1 lds
    s_add_u32 m0, s68, 18432
    s_nop 0
    buffer_load_dwordx4 v158, s[12:15], s52 offen sc1 lds
    s_add_u32 m0, s68, 19456
    s_nop 0
    buffer_load_dwordx4 v159, s[12:15], s52 offen sc1 lds
    v_lshrrev_b32 v12, 4, v0
    v_lshlrev_b32 v12, 3, v12
    v_bfe_u32 v13, v0, 2, 2
    v_add_u32 v12, v12, v13
    v_lshlrev_b32 v8, 6, v12
    v_bfe_u32 v12, v0, 4, 1
    v_lshlrev_b32 v12, 1, v12
    v_and_b32 v13, 3, v0
    v_xor_b32 v12, v12, v13
    v_lshl_add_u32 v8, v12, 4, v8
    s_lshl_b32 s50, s7, 14
    s_add_u32 s58, s50, 98304
    s_add_u32 m0, s58, 0
    s_add_u32 s47, s50, 0
    buffer_load_dwordx4 v8, s[24:27], s47 offen lds
    s_add_u32 m0, s58, 1024
    s_add_u32 s47, s50, 256
    buffer_load_dwordx4 v8, s[24:27], s47 offen lds
    s_add_u32 m0, s58, 2048
    s_add_u32 s47, s50, 2048
    buffer_load_dwordx4 v8, s[24:27], s47 offen lds
    s_add_u32 m0, s58, 3072
    s_add_u32 s47, s50, 2304
    buffer_load_dwordx4 v8, s[24:27], s47 offen lds
    s_add_u32 m0, s58, 4096
    s_add_u32 s47, s50, 4096
    buffer_load_dwordx4 v8, s[24:27], s47 offen lds
    s_add_u32 m0, s58, 5120
    s_add_u32 s47, s50, 4352
    buffer_load_dwordx4 v8, s[24:27], s47 offen lds
    s_add_u32 m0, s58, 6144
    s_add_u32 s47, s50, 6144
    buffer_load_dwordx4 v8, s[24:27], s47 offen lds
    s_add_u32 m0, s58, 7168
    s_add_u32 s47, s50, 6400
    buffer_load_dwordx4 v8, s[24:27], s47 offen lds
    s_add_u32 m0, s58, 8192
    s_add_u32 s47, s50, 8192
    buffer_load_dwordx4 v8, s[24:27], s47 offen lds
    s_add_u32 m0, s58, 9216
    s_add_u32 s47, s50, 8448
    buffer_load_dwordx4 v8, s[24:27], s47 offen lds
    s_add_u32 m0, s58, 10240
    s_add_u32 s47, s50, 10240
    buffer_load_dwordx4 v8, s[24:27], s47 offen lds
    s_add_u32 m0, s58, 11264
    s_add_u32 s47, s50, 10496
    buffer_load_dwordx4 v8, s[24:27], s47 offen lds
    s_add_u32 m0, s58, 12288
    s_add_u32 s47, s50, 12288
    buffer_load_dwordx4 v8, s[24:27], s47 offen lds
    s_add_u32 m0, s58, 13312
    s_add_u32 s47, s50, 12544
    buffer_load_dwordx4 v8, s[24:27], s47 offen lds
    s_add_u32 m0, s58, 14336
    s_add_u32 s47, s50, 14336
    buffer_load_dwordx4 v8, s[24:27], s47 offen lds
    s_add_u32 m0, s58, 15360
    s_add_u32 s47, s50, 14592
    buffer_load_dwordx4 v8, s[24:27], s47 offen lds
qkv_nox:
    v_lshrrev_b32 v12, 3, v0
    v_and_b32 v13, 7, v0
    v_xor_b32 v13, v13, v12
    v_lshlrev_b32 v2, 11, v12
    v_lshl_add_u32 v2, v13, 4, v2
    s_lshl_b32 s40, s7, 16
    v_add_u32 v2, s40, v2
    v_add_u32 v3, 15360, v2
    v_add_u32 v4, 30720, v2
    v_add_u32 v5, 46080, v2
    v_lshrrev_b32 v12, 5, v0
    v_lshlrev_b32 v12, 3, v12
    v_bfe_u32 v13, v0, 3, 2
    v_add_u32 v12, v12, v13
    s_lshr_b32 s40, s7, 1
    s_lshl_b32 s40, s40, 5
    s_and_b32 s41, s7, 1
    s_lshl_b32 s41, s41, 2
    s_add_u32 s40, s40, s41
    v_add_u32 v12, s40, v12
    v_lshlrev_b32 v6, 11, v12
    v_lshrrev_b32 v12, 4, v0
    v_lshlrev_b32 v12, 1, v12
    v_and_b32 v13, 7, v0
    v_xor_b32 v12, v12, v13
    v_lshl_add_u32 v6, v12, 4, v6
    v_add_u32 v7, 31744, v6
    s_lshl_b32 s40, s7, 12
    s_lshl_b32 s41, s7, 11
    s_lshl_b32 s42, s4, 18
    s_lshl_b32 s43, s5, 7
    v_and_b32 v13, 15, v0
    v_lshlrev_b32 v13, 8, v13
    v_lshl_add_u32 v13, v9, 4, v13
    v_xor_b32 v160, 0, v13
    v_add_u32 v160, s68, v160
    v_xor_b32 v161, 64, v13
    v_add_u32 v161, s68, v161
    v_xor_b32 v162, 128, v13
    v_add_u32 v162, s68, v162
    v_xor_b32 v163, 192, v13
    v_add_u32 v163, s68, v163
    v_lshrrev_b32 v13, 2, v0
    v_lshlrev_b32 v10, 6, v13
    v_and_b32 v12, 3, v0
    v_lshl_add_u32 v10, v12, 3, v10
    v_lshrrev_b32 v12, 4, v0
    v_and_b32 v12, 1, v12
    v_lshlrev_b32 v12, 5, v12
    v_add_u32 v10, s58, v10
    v_xor_b32 v13, 32, v12
    v_add_u32 v11, v10, v13
    v_add_u32 v10, v10, v12
    v_mov_b32 v152, 0x3f803f80
    v_mov_b32 v153, 0x3f803f80
    v_mov_b32 v154, 0x3f803f80
    v_mov_b32 v155, 0x3f803f80
    s_mov_b32 s65, s4
    s_mov_b32 s69, 7
    s_mov_b32 s39, 17
    s_cmp_eq_u32 s3, 0
    s_cbranch_scc1 qkv_rowmajor
    s_mov_b32 s65, 0
    s_mov_b32 s69, 14
    s_mov_b32 s39, 13
    s_mov_b32 s59, 32768
    v_lshl_add_u32 v2, v0, 4, s40
    v_mov_b32 v3, v2
    v_mov_b32 v4, v2
    v_mov_b32 v5, v2
    v_lshl_add_u32 v6, v0, 4, s41
    v_mov_b32 v7, v6
    s_lshl_b32 s43, s5, 17
    v_lshrrev_b32 v12, 4, v0
    v_lshlrev_b32 v12, 7, v12
    v_xor_b32 v13, 0, v9
    v_lshrrev_b32 v156, 3, v13
    v_lshl_add_u32 v156, v156, 14, v12
    v_and_b32 v13, 7, v0
    v_lshl_add_u32 v156, v13, 4, v156
    v_add_u32 v156, 0, v156
    v_xor_b32 v13, 4, v9
    v_lshrrev_b32 v157, 3, v13
    v_lshl_add_u32 v157, v157, 14, v12
    v_and_b32 v13, 7, v0
    v_lshl_add_u32 v157, v13, 4, v157
    v_add_u32 v157, 512, v157
    v_xor_b32 v13, 8, v9
    v_lshrrev_b32 v158, 3, v13
    v_lshl_add_u32 v158, v158, 14, v12
    v_and_b32 v13, 7, v0
    v_lshl_add_u32 v158, v13, 4, v158
    v_add_u32 v158, 1024, v158
    v_xor_b32 v13, 12, v9
    v_lshrrev_b32 v159, 3, v13
    v_lshl_add_u32 v159, v159, 14, v12
    v_and_b32 v13, 7, v0
    v_lshl_add_u32 v159, v13, 4, v159
    v_add_u32 v159, 1536, v159
    s_lshr_b32 s52, s5, 1
    s_lshl_b32 s52, s52, 11
    s_add_u32 s52, s52, s42
    s_lshl_b32 s53, s7, 16
    s_add_u32 s52, s52, s53
qkv_rowmajor:
    s_mov_b32 s66, s65
    s_cmp_lg_u32 s3, 0
    s_cbranch_scc1 qkv_ld1
    s_mov_b32 s44, 0
    s_mov_b32 s45, 65536
    s_add_u32 m0, s45, s41
    s_lshl_b32 s67, s66, s39
    s_add_u32 s67, s67, s43
    buffer_load_dwordx4 v6, s[20:23], s67 offen sc1 lds
    buffer_load_dwordx4 v7, s[20:23], s67 offen offset:1024 sc1 lds
    s_add_u32 s66, s66, 1
    s_and_b32 s66, s66, 15
    s_add_u32 s45, s45, 8192
    s_cmp_ge_u32 s45, 139264
    s_cselect_b32 s45, 65536, s45
    s_add_u32 m0, s44, s40
    s_lshl_b32 s67, s65, s69
    s_add_u32 s67, s67, s42
    buffer_load_dwordx4 v2, s[12:15], s67 offen offset:0 sc1 lds
    buffer_load_dwordx4 v3, s[12:15], s67 offen offset:1024 sc1 lds
    buffer_load_dwordx4 v4, s[12:15], s67 offen offset:2048 sc1 lds
    buffer_load_dwordx4 v5, s[12:15], s67 offen offset:3072 sc1 lds
    s_add_u32 s65, s65, 1
    s_and_b32 s65, s65, 15
    s_add_u32 s44, s44, 16384
    s_cmp_ge_u32 s44, 65536
    s_cselect_b32 s44, 0, s44
    v_and_b32 v12, 3, v0
    v_cmp_eq_u32 s[80:81], 1, v12
    v_cmp_eq_u32 s[82:83], 2, v12
    v_cmp_eq_u32 s[84:85], 3, v12
    v_bfe_u32 v12, v0, 2, 2
    v_lshrrev_b32 v13, 4, v0
    v_cmp_eq_u32 s[62:63], v12, v13
    s_and_b32 s57, s7, 1
    v_and_b32 v12, 0x33, v0
    v_bfe_u32 v13, v0, 2, 1
    v_lshl_add_u32 v12, v13, 3, v12
    v_bfe_u32 v13, v0, 3, 1
    v_lshl_add_u32 v12, v13, 2, v12
    s_lshl_b32 s47, s57, 3
    v_lshl_add_u32 v28, v12, 4, s47
    v_bfe_u32 v12, v0, 3, 1
    v_lshlrev_b32 v12, 5, v12
    v_lshrrev_b32 v13, 5, v0
    v_lshl_add_u32 v12, v13, 4, v12
    v_bfe_u32 v13, v0, 4, 1
    v_lshl_add_u32 v12, v13, 2, v12
    v_lshlrev_b32 v12, 4, v12
    v_and_b32 v13, 7, v0
    v_lshl_add_u32 v12, v13, 1, v12
    s_lshl_b32 s47, s57, 7
    v_add_u32 v12, s47, v12
    s_lshl_b32 s64, s4, 2
    s_lshr_b32 s53, s5, 2
    s_add_u32 s64, s64, s53
    s_lshl_b32 s64, s64, 12
    s_add_u32 s64, s64, s36
    s_add_u32 s64, s64, 0x1e00000
    s_bfe_u32 s53, s5, 0x10001
    v_lshlrev_b32 v23, 4, v0
    v_lshrrev_b32 v17, 4, v0
    v_lshl_add_u32 v17, v17, 8, v23
    s_lshl_b32 s54, s53, 8
    s_lshl_b32 s55, s53, 10
    s_add_u32 s55, s55, 2048
    s_bitcmp1_b32 s5, 0
    s_cselect_b32 s54, s55, s54
    s_cselect_b32 s47, 16, 2
    s_cselect_b64 vcc, -1, 0
    s_add_u32 s64, s64, s54
    v_add_u32 v18, 157696, v23
    v_cndmask_b32 v17, v17, v23, vcc
    v_cndmask_b32 v28, v28, v12, vcc
    v_add_u32 v28, 157696, v28
    v_add_u32 v29, s47, v28
    v_add_u32 v30, s47, v29
    v_add_u32 v31, s47, v30
    s_lshl_b32 s48, s3, 11
    s_add_u32 s48, s48, 0x4550000
    s_lshl_b32 s53, s4, 7
    s_lshl_b32 s54, s5, 2
    s_add_u32 s53, s53, s54
    s_add_u32 s53, s53, s48
    v_and_b32 v19, 15, v0
    v_lshlrev_b32 v19, 4, v19
    v_lshrrev_b32 v20, 2, v0
    v_lshlrev_b32 v20, 7, v20
    v_and_b32 v21, 3, v0
    v_lshl_add_u32 v20, v21, 4, v20
    s_waitcnt vmcnt(6)
    s_add_u32 m0, s45, s41
    s_lshl_b32 s67, s66, s39
    s_add_u32 s67, s67, s43
    buffer_load_dwordx4 v6, s[20:23], s67 offen sc1 lds
    ds_read_b64_tr_b16 v[32:33], v10 offset:0
    ds_read_b64_tr_b16 v[34:35], v10 offset:1024
    ds_read_b64_tr_b16 v[36:37], v11 offset:0
    ds_read_b64_tr_b16 v[38:39], v11 offset:1024
    ds_read_b64_tr_b16 v[40:41], v10 offset:2048
    ds_read_b64_tr_b16 v[42:43], v10 offset:3072
    ds_read_b64_tr_b16 v[44:45], v11 offset:2048
    ds_read_b64_tr_b16 v[46:47], v11 offset:3072
    s_waitcnt lgkmcnt(0)
    buffer_load_dwordx4 v7, s[20:23], s67 offen offset:1024 sc1 lds
    v_mfma_f32_16x16x32_bf16 v[136:139], v[32:35], v[152:155], 0
    v_mfma_f32_16x16x32_bf16 v[140:143], v[36:39], v[152:155], 0
    v_mfma_f32_16x16x32_bf16 v[136:139], v[40:43], v[152:155], v[136:139]
    v_mfma_f32_16x16x32_bf16 v[140:143], v[44:47], v[152:155], v[140:143]
    ds_read_b64_tr_b16 v[48:49], v10 offset:4096
    ds_read_b64_tr_b16 v[50:51], v10 offset:5120
    ds_read_b64_tr_b16 v[52:53], v11 offset:4096
    ds_read_b64_tr_b16 v[54:55], v11 offset:5120
    ds_read_b64_tr_b16 v[56:57], v10 offset:6144
    s_add_u32 s66, s66, 1
    s_and_b32 s66, s66, 15
    s_add_u32 s45, s45, 8192
    s_cmp_ge_u32 s45, 139264
    s_cselect_b32 s45, 65536, s45
    s_add_u32 m0, s44, s40
    s_lshl_b32 s67, s65, s69
    s_add_u32 s67, s67, s42
    buffer_load_dwordx4 v2, s[12:15], s67 offen offset:0 sc1 lds
    ds_read_b64_tr_b16 v[58:59], v10 offset:7168
    ds_read_b64_tr_b16 v[60:61], v11 offset:6144
    ds_read_b64_tr_b16 v[62:63], v11 offset:7168
    s_waitcnt lgkmcnt(0)
    v_mfma_f32_16x16x32_bf16 v[136:139], v[48:51], v[152:155], v[136:139]
    v_mfma_f32_16x16x32_bf16 v[140:143], v[52:55], v[152:155], v[140:143]
    v_mfma_f32_16x16x32_bf16 v[136:139], v[56:59], v[152:155], v[136:139]
    v_mfma_f32_16x16x32_bf16 v[140:143], v[60:63], v[152:155], v[140:143]
    ds_read_b64_tr_b16 v[64:65], v10 offset:8192
    buffer_load_dwordx4 v3, s[12:15], s67 offen offset:1024 sc1 lds
    ds_read_b64_tr_b16 v[66:67], v10 offset:9216
    ds_read_b64_tr_b16 v[68:69], v11 offset:8192
    ds_read_b64_tr_b16 v[70:71], v11 offset:9216
    ds_read_b64_tr_b16 v[72:73], v10 offset:10240
    ds_read_b64_tr_b16 v[74:75], v10 offset:11264
    ds_read_b64_tr_b16 v[76:77], v11 offset:10240
    ds_read_b64_tr_b16 v[78:79], v11 offset:11264
    s_waitcnt lgkmcnt(0)
    v_mfma_f32_16x16x32_bf16 v[136:139], v[64:67], v[152:155], v[136:139]
    buffer_load_dwordx4 v4, s[12:15], s67 offen offset:2048 sc1 lds
    v_mfma_f32_16x16x32_bf16 v[140:143], v[68:71], v[152:155], v[140:143]
    v_mfma_f32_16x16x32_bf16 v[136:139], v[72:75], v[152:155], v[136:139]
    v_mfma_f32_16x16x32_bf16 v[140:143], v[76:79], v[152:155], v[140:143]
    ds_read_b64_tr_b16 v[80:81], v10 offset:12288
    ds_read_b64_tr_b16 v[82:83], v10 offset:13312
    ds_read_b64_tr_b16 v[84:85], v11 offset:12288
    ds_read_b64_tr_b16 v[86:87], v11 offset:13312
    ds_read_b64_tr_b16 v[88:89], v10 offset:14336
    ds_read_b64_tr_b16 v[90:91], v10 offset:15360
    buffer_load_dwordx4 v5, s[12:15], s67 offen offset:3072 sc1 lds
    ds_read_b64_tr_b16 v[92:93], v11 offset:14336
    ds_read_b64_tr_b16 v[94:95], v11 offset:15360
    s_waitcnt lgkmcnt(0)
    v_mfma_f32_16x16x32_bf16 v[136:139], v[80:83], v[152:155], v[136:139]
    v_mfma_f32_16x16x32_bf16 v[140:143], v[84:87], v[152:155], v[140:143]
    v_mfma_f32_16x16x32_bf16 v[136:139], v[88:91], v[152:155], v[136:139]
    v_mfma_f32_16x16x32_bf16 v[140:143], v[92:95], v[152:155], v[140:143]
    s_add_u32 s65, s65, 1
    s_and_b32 s65, s65, 15
    s_add_u32 s44, s44, 16384
    s_cmp_ge_u32 s44, 65536
    s_cselect_b32 s44, 0, s44
    s_mul_i32 s47, s7, 4608
    s_add_u32 s47, s47, 139264
    v_lshl_add_u32 v156, v0, 4, s47
    v_and_b32 v13, 15, v0
    v_lshl_add_u32 v157, v13, 3, s47
    s_and_b32 s47, s7, 1
    s_lshl_b32 s47, s47, 10
    s_add_u32 s47, s47, 139264
    v_lshl_add_u32 v158, v0, 4, s47
    v_lshlrev_b32 v13, 3, v13
    v_add_u32 v159, 143360, v13
    ds_read_b128 v[96:99], v160 offset:0
    ds_read_b128 v[100:103], v161 offset:0
    ds_read_b128 v[104:107], v162 offset:0
    ds_read_b128 v[108:111], v163 offset:0
    ds_read_b128 v[112:115], v160 offset:16384
    ds_read_b128 v[116:119], v161 offset:16384
    ds_read_b128 v[120:123], v162 offset:16384
    ds_read_b128 v[124:127], v163 offset:16384
    s_waitcnt lgkmcnt(0)
    s_barrier
    s_add_u32 m0, s45, s41
    s_lshl_b32 s67, s66, s39
    s_add_u32 s67, s67, s43
    buffer_load_dwordx4 v6, s[20:23], s67 offen sc1 lds
    v_mfma_f32_16x16x32_bf16 v[128:131], v[32:35], v[96:99], 0
    v_mfma_f32_16x16x32_bf16 v[132:135], v[36:39], v[96:99], 0
    v_mfma_f32_16x16x32_bf16 v[144:147], v[152:155], v[96:99], 0
    v_mfma_f32_16x16x32_bf16 v[148:151], v[96:99], v[96:99], 0
    buffer_load_dwordx4 v7, s[20:23], s67 offen offset:1024 sc1 lds
    v_mfma_f32_16x16x32_bf16 v[128:131], v[40:43], v[100:103], v[128:131]
    v_mfma_f32_16x16x32_bf16 v[132:135], v[44:47], v[100:103], v[132:135]
    v_mfma_f32_16x16x32_bf16 v[144:147], v[152:155], v[100:103], v[144:147]
    v_mfma_f32_16x16x32_bf16 v[148:151], v[100:103], v[100:103], v[148:151]
    s_add_u32 s66, s66, 1
    s_and_b32 s66, s66, 15
    s_add_u32 s45, s45, 8192
    s_cmp_ge_u32 s45, 139264
    s_cselect_b32 s45, 65536, s45
    s_add_u32 m0, s44, s40
    s_lshl_b32 s67, s65, s69
    s_add_u32 s67, s67, s42
    buffer_load_dwordx4 v2, s[12:15], s67 offen offset:0 sc1 lds
    v_mfma_f32_16x16x32_bf16 v[128:131], v[48:51], v[104:107], v[128:131]
    v_mfma_f32_16x16x32_bf16 v[132:135], v[52:55], v[104:107], v[132:135]
    v_mfma_f32_16x16x32_bf16 v[144:147], v[152:155], v[104:107], v[144:147]
    v_mfma_f32_16x16x32_bf16 v[148:151], v[104:107], v[104:107], v[148:151]
    buffer_load_dwordx4 v3, s[12:15], s67 offen offset:1024 sc1 lds
    v_mfma_f32_16x16x32_bf16 v[128:131], v[56:59], v[108:111], v[128:131]
    v_mfma_f32_16x16x32_bf16 v[132:135], v[60:63], v[108:111], v[132:135]
    v_mfma_f32_16x16x32_bf16 v[144:147], v[152:155], v[108:111], v[144:147]
    v_mfma_f32_16x16x32_bf16 v[148:151], v[108:111], v[108:111], v[148:151]
    buffer_load_dwordx4 v4, s[12:15], s67 offen offset:2048 sc1 lds
    v_mfma_f32_16x16x32_bf16 v[128:131], v[64:67], v[112:115], v[128:131]
    v_mfma_f32_16x16x32_bf16 v[132:135], v[68:71], v[112:115], v[132:135]
    v_mfma_f32_16x16x32_bf16 v[144:147], v[152:155], v[112:115], v[144:147]
    v_mfma_f32_16x16x32_bf16 v[148:151], v[112:115], v[112:115], v[148:151]
    buffer_load_dwordx4 v5, s[12:15], s67 offen offset:3072 sc1 lds
    v_mfma_f32_16x16x32_bf16 v[128:131], v[72:75], v[116:119], v[128:131]
    v_mfma_f32_16x16x32_bf16 v[132:135], v[76:79], v[116:119], v[132:135]
    v_mfma_f32_16x16x32_bf16 v[144:147], v[152:155], v[116:119], v[144:147]
    v_mfma_f32_16x16x32_bf16 v[148:151], v[116:119], v[116:119], v[148:151]
    s_add_u32 s65, s65, 1
    s_and_b32 s65, s65, 15
    s_add_u32 s44, s44, 16384
    s_cmp_ge_u32 s44, 65536
    s_cselect_b32 s44, 0, s44
    s_add_u32 m0, s45, s41
    s_lshl_b32 s67, s66, s39
    s_add_u32 s67, s67, s43
    buffer_load_dwordx4 v6, s[20:23], s67 offen sc1 lds
    v_mfma_f32_16x16x32_bf16 v[128:131], v[80:83], v[120:123], v[128:131]
    v_mfma_f32_16x16x32_bf16 v[132:135], v[84:87], v[120:123], v[132:135]
    v_mfma_f32_16x16x32_bf16 v[144:147], v[152:155], v[120:123], v[144:147]
    v_mfma_f32_16x16x32_bf16 v[148:151], v[120:123], v[120:123], v[148:151]
    buffer_load_dwordx4 v7, s[20:23], s67 offen offset:1024 sc1 lds
    v_mfma_f32_16x16x32_bf16 v[128:131], v[88:91], v[124:127], v[128:131]
    v_mfma_f32_16x16x32_bf16 v[132:135], v[92:95], v[124:127], v[132:135]
    v_mfma_f32_16x16x32_bf16 v[144:147], v[152:155], v[124:127], v[144:147]
    v_mfma_f32_16x16x32_bf16 v[148:151], v[124:127], v[124:127], v[148:151]
    s_add_u32 s66, s66, 1
    s_and_b32 s66, s66, 15
    s_add_u32 s45, s45, 8192
    s_cmp_ge_u32 s45, 139264
    s_cselect_b32 s45, 65536, s45
    s_add_u32 m0, s44, s40
    s_lshl_b32 s67, s65, s69
    s_add_u32 s67, s67, s42
    buffer_load_dwordx4 v2, s[12:15], s67 offen offset:0 sc1 lds
    s_nop 7
    ds_write_b128 v156, v[128:131] offset:0
    ds_write_b128 v156, v[132:135] offset:1024
    ds_write_b128 v156, v[136:139] offset:2048
    buffer_load_dwordx4 v3, s[12:15], s67 offen offset:1024 sc1 lds
    ds_write_b128 v156, v[140:143] offset:3072
    v_cndmask_b32 v148, v148, v149, s[80:81]
    v_cndmask_b32 v148, v148, v150, s[82:83]
    v_cndmask_b32 v145, v148, v151, s[84:85]
    buffer_load_dwordx4 v4, s[12:15], s67 offen offset:2048 sc1 lds
    s_mov_b64 exec, s[62:63]
    ds_write_b64 v157, v[144:145] offset:4096
    s_mov_b64 exec, -1
    s_waitcnt lgkmcnt(0)
    buffer_load_dwordx4 v5, s[12:15], s67 offen offset:3072 sc1 lds
    s_add_u32 s65, s65, 1
    s_and_b32 s65, s65, 15
    s_add_u32 s44, s44, 16384
    s_cmp_ge_u32 s44, 65536
    s_cselect_b32 s44, 0, s44
    s_waitcnt vmcnt(18)
    s_barrier
    ds_read_b64 v[32:33], v159 offset:0
    ds_read_b64 v[34:35], v159 offset:4608
    ds_read_b64 v[36:37], v159 offset:9216
    ds_read_b64 v[38:39], v159 offset:13824
    ds_read_b128 v[96:99], v158 offset:0
    ds_read_b128 v[100:103], v158 offset:2048
    ds_read_b128 v[104:107], v158 offset:4608
    ds_read_b128 v[108:111], v158 offset:6656
    ds_read_b128 v[112:115], v158 offset:9216
    ds_read_b128 v[116:119], v158 offset:11264
    ds_read_b128 v[120:123], v158 offset:13824
    ds_read_b128 v[124:127], v158 offset:15872
    s_waitcnt lgkmcnt(8)
    v_pk_add_f32 v[32:33], v[32:33], v[34:35]
    v_pk_add_f32 v[32:33], v[32:33], v[36:37]
    v_pk_add_f32 v[32:33], v[32:33], v[38:39]
    v_mul_f32 v32, 0x3a800000, v32
    v_mul_f32 v33, 0x3a800000, v33
    v_fma_f32 v33, -v32, v32, v33
    v_max_f32 v33, 0, v33
    v_cvt_pk_bf16_f32 v34, v32, v33
    v_lshlrev_b32 v32, 16, v34
    v_and_b32 v33, 0xffff0000, v34
    v_add_f32 v33, 0x3727c5ac, v33
    v_cvt_pk_bf16_f32 v34, v33, v33
    v_lshlrev_b32 v33, 16, v34
    v_sqrt_f32 v33, v33
    s_nop 0
    v_cvt_pk_bf16_f32 v34, v33, v33
    v_lshlrev_b32 v33, 16, v34
    v_rcp_f32 v33, v33
    s_waitcnt lgkmcnt(0)
    v_pk_add_f32 v[96:97], v[96:97], v[104:105]
    v_pk_add_f32 v[98:99], v[98:99], v[106:107]
    v_pk_add_f32 v[100:101], v[100:101], v[108:109]
    v_pk_add_f32 v[102:103], v[102:103], v[110:111]
    v_pk_add_f32 v[96:97], v[96:97], v[112:113]
    v_pk_add_f32 v[98:99], v[98:99], v[114:115]
    v_pk_add_f32 v[100:101], v[100:101], v[116:117]
    v_pk_add_f32 v[102:103], v[102:103], v[118:119]
    v_pk_add_f32 v[96:97], v[96:97], v[120:121]
    v_pk_add_f32 v[98:99], v[98:99], v[122:123]
    v_pk_add_f32 v[100:101], v[100:101], v[124:125]
    v_pk_add_f32 v[102:103], v[102:103], v[126:127]
    v_pk_fma_f32 v[96:97], v[100:101], v[32:33], v[96:97] op_sel:[0,0,0] op_sel_hi:[1,0,1] neg_lo:[0,1,0] neg_hi:[0,1,0]
    v_pk_fma_f32 v[98:99], v[102:103], v[32:33], v[98:99] op_sel:[0,0,0] op_sel_hi:[1,0,1] neg_lo:[0,1,0] neg_hi:[0,1,0]
    v_pk_mul_f32 v[96:97], v[96:97], v[32:33] op_sel:[0,1] op_sel_hi:[1,1]
    v_pk_mul_f32 v[98:99], v[98:99], v[32:33] op_sel:[0,1] op_sel_hi:[1,1]
    v_cvt_pk_bf16_f32 v96, v96, v97
    v_cvt_pk_bf16_f32 v97, v98, v99
    ds_write_b16 v28, v96
    ds_write_b16_d16_hi v29, v96
    ds_write_b16 v30, v97
    ds_write_b16_d16_hi v31, v97
    s_waitcnt lgkmcnt(0)
    s_waitcnt vmcnt(12)
    s_barrier
    s_cmp_lg_u32 s7, 0
    s_cbranch_scc1 kvst_1
    ds_read_b128 v[24:27], v18
    s_lshl_b32 s47, s4, 10
    s_lshr_b32 s55, s5, 1
    s_lshl_b32 s55, s55, 7
    s_add_u32 s47, s47, s55
    s_add_u32 s47, s47, s36
    s_add_u32 s47, s47, 0x1f00000
    v_lshlrev_b32 v12, 3, v0
    s_waitcnt lgkmcnt(0)
    buffer_store_dwordx4 v[24:27], v17, s[8:11], s64 offen sc0 sc1
    s_bitcmp1_b32 s5, 0
    s_cbranch_scc1 kvst_1
    s_mov_b64 exec, 0xffff
    buffer_store_dwordx2 v[32:33], v12, s[8:11], s47 offen sc0 sc1
    s_mov_b64 exec, -1
kvst_1:
    s_add_u32 m0, s45, s41
    s_lshl_b32 s67, s66, s39
    s_add_u32 s67, s67, s43
    buffer_load_dwordx4 v6, s[20:23], s67 offen sc1 lds
    buffer_load_dwordx4 v7, s[20:23], s67 offen offset:1024 sc1 lds
    s_add_u32 s66, s66, 1
    s_and_b32 s66, s66, 15
    s_add_u32 s45, s45, 8192
    s_cmp_ge_u32 s45, 139264
    s_cselect_b32 s45, 65536, s45
    s_add_u32 m0, s44, s40
    s_lshl_b32 s67, s65, s69
    s_add_u32 s67, s67, s42
    buffer_load_dwordx4 v2, s[12:15], s67 offen offset:0 sc1 lds
    buffer_load_dwordx4 v3, s[12:15], s67 offen offset:1024 sc1 lds
    buffer_load_dwordx4 v4, s[12:15], s67 offen offset:2048 sc1 lds
    buffer_load_dwordx4 v5, s[12:15], s67 offen offset:3072 sc1 lds
    s_add_u32 s65, s65, 1
    s_and_b32 s65, s65, 15
    s_add_u32 s44, s44, 16384
    s_cmp_ge_u32 s44, 65536
    s_cselect_b32 s44, 0, s44
    s_waitcnt vmcnt(12)
    s_barrier
    s_add_u32 m0, s45, s41
    s_lshl_b32 s67, s66, s39
    s_add_u32 s67, s67, s43
    buffer_load_dwordx4 v6, s[20:23], s67 offen sc1 lds
    buffer_load_dwordx4 v7, s[20:23], s67 offen offset:1024 sc1 lds
    s_add_u32 s66, s66, 1
    s_and_b32 s66, s66, 15
    s_add_u32 s45, s45, 8192
    s_cmp_ge_u32 s45, 139264
    s_cselect_b32 s45, 65536, s45
    s_add_u32 m0, s44, s40
    s_lshl_b32 s67, s65, s69
    s_add_u32 s67, s67, s42
    buffer_load_dwordx4 v2, s[12:15], s67 offen offset:0 sc1 lds
    buffer_load_dwordx4 v3, s[12:15], s67 offen offset:1024 sc1 lds
    buffer_load_dwordx4 v4, s[12:15], s67 offen offset:2048 sc1 lds
    buffer_load_dwordx4 v5, s[12:15], s67 offen offset:3072 sc1 lds
    s_add_u32 s65, s65, 1
    s_and_b32 s65, s65, 15
    s_add_u32 s44, s44, 16384
    s_cmp_ge_u32 s44, 65536
    s_cselect_b32 s44, 0, s44
    s_waitcnt vmcnt(12)
    s_barrier
    s_add_u32 m0, s45, s41
    s_lshl_b32 s67, s66, s39
    s_add_u32 s67, s67, s43
    buffer_load_dwordx4 v6, s[20:23], s67 offen sc1 lds
    buffer_load_dwordx4 v7, s[20:23], s67 offen offset:1024 sc1 lds
    s_add_u32 s66, s66, 1
    s_and_b32 s66, s66, 15
    s_add_u32 s45, s45, 8192
    s_cmp_ge_u32 s45, 139264
    s_cselect_b32 s45, 65536, s45
    s_add_u32 m0, s44, s40
    s_lshl_b32 s67, s65, s69
    s_add_u32 s67, s67, s42
    buffer_load_dwordx4 v2, s[12:15], s67 offen offset:0 sc1 lds
    buffer_load_dwordx4 v3, s[12:15], s67 offen offset:1024 sc1 lds
    buffer_load_dwordx4 v4, s[12:15], s67 offen offset:2048 sc1 lds
    buffer_load_dwordx4 v5, s[12:15], s67 offen offset:3072 sc1 lds
    s_add_u32 s65, s65, 1
    s_and_b32 s65, s65, 15
    s_add_u32 s44, s44, 16384
    s_cmp_ge_u32 s44, 65536
    s_cselect_b32 s44, 0, s44
    s_cmp_lg_u32 s7, 0
    s_cbranch_scc1 kvfl_2
    v_mov_b32 v21, 1
    s_mov_b64 exec, 1
    buffer_store_dword v21, off, s[8:11], s53 sc0 sc1
    s_mov_b64 exec, -1
kvfl_2:
    s_mov_b32 s46, 2
qkv_ld_3:
    s_waitcnt vmcnt(12)
    s_barrier
    s_add_u32 m0, s45, s41
    s_lshl_b32 s67, s66, s39
    s_add_u32 s67, s67, s43
    buffer_load_dwordx4 v6, s[20:23], s67 offen sc1 lds
    buffer_load_dwordx4 v7, s[20:23], s67 offen offset:1024 sc1 lds
    s_add_u32 s66, s66, 1
    s_and_b32 s66, s66, 15
    s_add_u32 s45, s45, 8192
    s_cmp_ge_u32 s45, 139264
    s_cselect_b32 s45, 65536, s45
    s_add_u32 m0, s44, s40
    s_lshl_b32 s67, s65, s69
    s_add_u32 s67, s67, s42
    buffer_load_dwordx4 v2, s[12:15], s67 offen offset:0 sc1 lds
    buffer_load_dwordx4 v3, s[12:15], s67 offen offset:1024 sc1 lds
    buffer_load_dwordx4 v4, s[12:15], s67 offen offset:2048 sc1 lds
    buffer_load_dwordx4 v5, s[12:15], s67 offen offset:3072 sc1 lds
    s_add_u32 s65, s65, 1
    s_and_b32 s65, s65, 15
    s_add_u32 s44, s44, 16384
    s_cmp_ge_u32 s44, 65536
    s_cselect_b32 s44, 0, s44
    s_sub_u32 s46, s46, 1
    s_cmp_lg_u32 s46, 0
    s_cbranch_scc1 qkv_ld_3
    s_waitcnt vmcnt(12)
    s_barrier
    s_add_u32 m0, s45, s41
    s_lshl_b32 s67, s66, s39
    s_add_u32 s67, s67, s43
    buffer_load_dwordx4 v6, s[20:23], s67 offen sc1 lds
    buffer_load_dwordx4 v7, s[20:23], s67 offen offset:1024 sc1 lds
    s_add_u32 s66, s66, 1
    s_and_b32 s66, s66, 15
    s_add_u32 s45, s45, 8192
    s_cmp_ge_u32 s45, 139264
    s_cselect_b32 s45, 65536, s45
    s_add_u32 m0, s44, s40
    s_lshl_b32 s67, s65, s69
    s_add_u32 s67, s67, s42
    buffer_load_dwordx4 v2, s[12:15], s67 offen offset:0 sc1 lds
    buffer_load_dwordx4 v3, s[12:15], s67 offen offset:1024 sc1 lds
    buffer_load_dwordx4 v4, s[12:15], s67 offen offset:2048 sc1 lds
    buffer_load_dwordx4 v5, s[12:15], s67 offen offset:3072 sc1 lds
    s_add_u32 s65, s65, 1
    s_and_b32 s65, s65, 15
    s_add_u32 s44, s44, 16384
    s_cmp_ge_u32 s44, 65536
    s_cselect_b32 s44, 0, s44
    v_lshl_add_u32 v12, v0, 4, s41
    v_add_u32 v13, 114688, v12
    ds_read_b128 v[96:99], v13
    ds_read_b128 v[100:103], v13 offset:1024
    s_add_u32 s47, s4, 6
    s_and_b32 s47, s47, 15
    s_lshl_b32 s47, s47, 13
    s_lshl_b32 s55, s5, 17
    s_add_u32 s47, s47, s55
    s_add_u32 s47, s47, 0x6200000
    s_waitcnt lgkmcnt(0)
    buffer_store_dwordx4 v[96:99], v12, s[8:11], s47 offen sc0 sc1
    buffer_store_dwordx4 v[100:103], v12, s[8:11], s47 offen offset:1024 sc0 sc1
    s_mov_b32 s46, 2
qkv_ld_4:
    s_waitcnt vmcnt(12)
    s_barrier
    s_add_u32 m0, s45, s41
    s_lshl_b32 s67, s66, s39
    s_add_u32 s67, s67, s43
    buffer_load_dwordx4 v6, s[20:23], s67 offen sc1 lds
    buffer_load_dwordx4 v7, s[20:23], s67 offen offset:1024 sc1 lds
    s_add_u32 s66, s66, 1
    s_and_b32 s66, s66, 15
    s_add_u32 s45, s45, 8192
    s_cmp_ge_u32 s45, 139264
    s_cselect_b32 s45, 65536, s45
    s_add_u32 m0, s44, s40
    s_lshl_b32 s67, s65, s69
    s_add_u32 s67, s67, s42
    buffer_load_dwordx4 v2, s[12:15], s67 offen offset:0 sc1 lds
    buffer_load_dwordx4 v3, s[12:15], s67 offen offset:1024 sc1 lds
    buffer_load_dwordx4 v4, s[12:15], s67 offen offset:2048 sc1 lds
    buffer_load_dwordx4 v5, s[12:15], s67 offen offset:3072 sc1 lds
    s_add_u32 s65, s65, 1
    s_and_b32 s65, s65, 15
    s_add_u32 s44, s44, 16384
    s_cmp_ge_u32 s44, 65536
    s_cselect_b32 s44, 0, s44
    s_sub_u32 s46, s46, 1
    s_cmp_lg_u32 s46, 0
    s_cbranch_scc1 qkv_ld_4
    s_waitcnt vmcnt(12)
    s_barrier
    s_add_u32 m0, s45, s41
    s_lshl_b32 s67, s66, s39
    s_add_u32 s67, s67, s43
    buffer_load_dwordx4 v6, s[20:23], s67 offen sc1 lds
    buffer_load_dwordx4 v7, s[20:23], s67 offen offset:1024 sc1 lds
    s_add_u32 s66, s66, 1
    s_and_b32 s66, s66, 15
    s_add_u32 s45, s45, 8192
    s_cmp_ge_u32 s45, 139264
    s_cselect_b32 s45, 65536, s45
    s_add_u32 m0, s44, s40
    s_lshl_b32 s67, s65, s69
    s_add_u32 s67, s67, s42
    buffer_load_dwordx4 v2, s[12:15], s67 offen offset:0 sc1 lds
    buffer_load_dwordx4 v3, s[12:15], s67 offen offset:1024 sc1 lds
    buffer_load_dwordx4 v4, s[12:15], s67 offen offset:2048 sc1 lds
    buffer_load_dwordx4 v5, s[12:15], s67 offen offset:3072 sc1 lds
    s_add_u32 s65, s65, 1
    s_and_b32 s65, s65, 15
    s_add_u32 s44, s44, 16384
    s_cmp_ge_u32 s44, 65536
    s_cselect_b32 s44, 0, s44
    buffer_load_dword v22, v19, s[32:35], 0 offen sc1
    s_mov_b32 s46, 3
qkv_ld_5:
    s_waitcnt vmcnt(12)
    s_barrier
    s_add_u32 m0, s45, s41
    s_lshl_b32 s67, s66, s39
    s_add_u32 s67, s67, s43
    buffer_load_dwordx4 v6, s[20:23], s67 offen sc1 lds
    buffer_load_dwordx4 v7, s[20:23], s67 offen offset:1024 sc1 lds
    s_add_u32 s66, s66, 1
    s_and_b32 s66, s66, 15
    s_add_u32 s45, s45, 8192
    s_cmp_ge_u32 s45, 139264
    s_cselect_b32 s45, 65536, s45
    s_add_u32 m0, s44, s40
    s_lshl_b32 s67, s65, s69
    s_add_u32 s67, s67, s42
    buffer_load_dwordx4 v2, s[12:15], s67 offen offset:0 sc1 lds
    buffer_load_dwordx4 v3, s[12:15], s67 offen offset:1024 sc1 lds
    buffer_load_dwordx4 v4, s[12:15], s67 offen offset:2048 sc1 lds
    buffer_load_dwordx4 v5, s[12:15], s67 offen offset:3072 sc1 lds
    s_add_u32 s65, s65, 1
    s_and_b32 s65, s65, 15
    s_add_u32 s44, s44, 16384
    s_cmp_ge_u32 s44, 65536
    s_cselect_b32 s44, 0, s44
    s_sub_u32 s46, s46, 1
    s_cmp_lg_u32 s46, 0
    s_cbranch_scc1 qkv_ld_5
    s_waitcnt vmcnt(12)
    s_barrier
    s_waitcnt vmcnt(6)
    s_barrier
    v_cmp_gt_u32 vcc, 16, v22
    s_mov_b32 s56, 0
    buffer_load_dwordx4 v[24:27], v20, s[8:11], s48 offen sc1
    s_mov_b64 s[58:59], vcc
    s_waitcnt vmcnt(0)
    s_barrier
    s_waitcnt vmcnt(0)
    v_min_u32 v24, v24, v25
    v_min_u32 v26, v26, v27
    v_min_u32 v24, v24, v26
    v_cmp_eq_u32 vcc, 0, v24
    s_nop 1
    s_or_b64 s[58:59], s[58:59], vcc
    s_cbranch_scc1 kvchk_6
    s_mov_b32 s56, 1
    s_cmp_lg_u32 s7, 0
    s_cbranch_scc1 lnc_7
    s_lshl_b32 s55, s4, 10
    s_add_u32 s55, s55, s36
    s_mov_b32 m0, 158720
    s_add_u32 s55, s55, 0x1f00000
    buffer_load_dwordx4 v23, s[8:11], s55 offen sc1 lds
lnc_7:
    s_lshl_b32 s54, s7, 12
    s_add_u32 s55, s54, s36
    s_add_u32 s55, s55, 0x1e00000
    s_add_u32 m0, s54, 0
    s_nop 0
    buffer_load_dwordx4 v23, s[8:11], s55 offen offset:0 sc1 lds
    buffer_load_dwordx4 v23, s[8:11], s55 offen offset:1024 sc1 lds
    buffer_load_dwordx4 v23, s[8:11], s55 offen offset:2048 sc1 lds
    buffer_load_dwordx4 v23, s[8:11], s55 offen offset:3072 sc1 lds
    s_add_u32 s55, s55, 16384
    s_add_u32 m0, s54, 16384
    s_nop 0
    buffer_load_dwordx4 v23, s[8:11], s55 offen offset:0 sc1 lds
    buffer_load_dwordx4 v23, s[8:11], s55 offen offset:1024 sc1 lds
    buffer_load_dwordx4 v23, s[8:11], s55 offen offset:2048 sc1 lds
    buffer_load_dwordx4 v23, s[8:11], s55 offen offset:3072 sc1 lds
kvchk_6:
    s_barrier
    s_branch qkv_ldj
qkv_ld1:
    s_mov_b32 s44, 0
    s_mov_b32 s45, 65536
    v_and_b32 v12, 3, v0
    v_cmp_eq_u32 s[80:81], 1, v12
    v_cmp_eq_u32 s[82:83], 2, v12
    v_cmp_eq_u32 s[84:85], 3, v12
    v_bfe_u32 v12, v0, 2, 2
    v_lshrrev_b32 v13, 4, v0
    v_cmp_eq_u32 s[62:63], v12, v13
    s_and_b32 s57, s7, 1
    v_and_b32 v12, 0x33, v0
    v_bfe_u32 v13, v0, 2, 1
    v_lshl_add_u32 v12, v13, 3, v12
    v_bfe_u32 v13, v0, 3, 1
    v_lshl_add_u32 v12, v13, 2, v12
    s_lshl_b32 s47, s57, 3
    v_lshl_add_u32 v28, v12, 4, s47
    v_bfe_u32 v12, v0, 3, 1
    v_lshlrev_b32 v12, 5, v12
    v_lshrrev_b32 v13, 5, v0
    v_lshl_add_u32 v12, v13, 4, v12
    v_bfe_u32 v13, v0, 4, 1
    v_lshl_add_u32 v12, v13, 2, v12
    v_lshlrev_b32 v12, 4, v12
    v_and_b32 v13, 7, v0
    v_lshl_add_u32 v12, v13, 1, v12
    s_lshl_b32 s47, s57, 7
    v_add_u32 v12, s47, v12
    s_lshl_b32 s64, s4, 2
    s_lshr_b32 s53, s5, 2
    s_add_u32 s64, s64, s53
    s_lshl_b32 s64, s64, 12
    s_add_u32 s64, s64, s36
    s_add_u32 s64, s64, 0x1e00000
    s_bfe_u32 s53, s5, 0x10001
    v_lshlrev_b32 v23, 4, v0
    v_lshrrev_b32 v17, 4, v0
    v_lshl_add_u32 v17, v17, 8, v23
    s_lshl_b32 s54, s53, 8
    s_lshl_b32 s55, s53, 10
    s_add_u32 s55, s55, 2048
    s_bitcmp1_b32 s5, 0
    s_cselect_b32 s54, s55, s54
    s_cselect_b32 s47, 16, 2
    s_cselect_b64 vcc, -1, 0
    s_add_u32 s64, s64, s54
    v_add_u32 v18, 157696, v23
    v_cndmask_b32 v17, v17, v23, vcc
    v_cndmask_b32 v28, v28, v12, vcc
    v_add_u32 v28, 157696, v28
    v_add_u32 v29, s47, v28
    v_add_u32 v30, s47, v29
    v_add_u32 v31, s47, v30
    s_lshl_b32 s48, s3, 11
    s_add_u32 s48, s48, 0x4550000
    s_lshl_b32 s53, s4, 7
    s_lshl_b32 s54, s5, 2
    s_add_u32 s53, s53, s54
    s_add_u32 s53, s53, s48
    v_and_b32 v19, 15, v0
    v_lshlrev_b32 v19, 4, v19
    v_lshrrev_b32 v20, 2, v0
    v_lshlrev_b32 v20, 7, v20
    v_and_b32 v21, 3, v0
    v_lshl_add_u32 v20, v21, 4, v20
    s_waitcnt vmcnt(0)
    ds_read_b64_tr_b16 v[32:33], v10 offset:0
    ds_read_b64_tr_b16 v[34:35], v10 offset:1024
    ds_read_b64_tr_b16 v[36:37], v11 offset:0
    ds_read_b64_tr_b16 v[38:39], v11 offset:1024
    ds_read_b64_tr_b16 v[40:41], v10 offset:2048
    ds_read_b64_tr_b16 v[42:43], v10 offset:3072
    ds_read_b64_tr_b16 v[44:45], v11 offset:2048
    ds_read_b64_tr_b16 v[46:47], v11 offset:3072
    s_waitcnt lgkmcnt(0)
    v_mfma_f32_16x16x32_bf16 v[136:139], v[32:35], v[152:155], 0
    v_mfma_f32_16x16x32_bf16 v[140:143], v[36:39], v[152:155], 0
    v_mfma_f32_16x16x32_bf16 v[136:139], v[40:43], v[152:155], v[136:139]
    v_mfma_f32_16x16x32_bf16 v[140:143], v[44:47], v[152:155], v[140:143]
    ds_read_b64_tr_b16 v[48:49], v10 offset:4096
    ds_read_b64_tr_b16 v[50:51], v10 offset:5120
    ds_read_b64_tr_b16 v[52:53], v11 offset:4096
    ds_read_b64_tr_b16 v[54:55], v11 offset:5120
    ds_read_b64_tr_b16 v[56:57], v10 offset:6144
    ds_read_b64_tr_b16 v[58:59], v10 offset:7168
    ds_read_b64_tr_b16 v[60:61], v11 offset:6144
    ds_read_b64_tr_b16 v[62:63], v11 offset:7168
    s_waitcnt lgkmcnt(0)
    v_mfma_f32_16x16x32_bf16 v[136:139], v[48:51], v[152:155], v[136:139]
    v_mfma_f32_16x16x32_bf16 v[140:143], v[52:55], v[152:155], v[140:143]
    v_mfma_f32_16x16x32_bf16 v[136:139], v[56:59], v[152:155], v[136:139]
    v_mfma_f32_16x16x32_bf16 v[140:143], v[60:63], v[152:155], v[140:143]
    ds_read_b64_tr_b16 v[64:65], v10 offset:8192
    ds_read_b64_tr_b16 v[66:67], v10 offset:9216
    ds_read_b64_tr_b16 v[68:69], v11 offset:8192
    ds_read_b64_tr_b16 v[70:71], v11 offset:9216
    ds_read_b64_tr_b16 v[72:73], v10 offset:10240
    ds_read_b64_tr_b16 v[74:75], v10 offset:11264
    ds_read_b64_tr_b16 v[76:77], v11 offset:10240
    ds_read_b64_tr_b16 v[78:79], v11 offset:11264
    s_waitcnt lgkmcnt(0)
    v_mfma_f32_16x16x32_bf16 v[136:139], v[64:67], v[152:155], v[136:139]
    v_mfma_f32_16x16x32_bf16 v[140:143], v[68:71], v[152:155], v[140:143]
    v_mfma_f32_16x16x32_bf16 v[136:139], v[72:75], v[152:155], v[136:139]
    v_mfma_f32_16x16x32_bf16 v[140:143], v[76:79], v[152:155], v[140:143]
    ds_read_b64_tr_b16 v[80:81], v10 offset:12288
    ds_read_b64_tr_b16 v[82:83], v10 offset:13312
    ds_read_b64_tr_b16 v[84:85], v11 offset:12288
    ds_read_b64_tr_b16 v[86:87], v11 offset:13312
    ds_read_b64_tr_b16 v[88:89], v10 offset:14336
    ds_read_b64_tr_b16 v[90:91], v10 offset:15360
    ds_read_b64_tr_b16 v[92:93], v11 offset:14336
    ds_read_b64_tr_b16 v[94:95], v11 offset:15360
    s_waitcnt lgkmcnt(0)
    v_mfma_f32_16x16x32_bf16 v[136:139], v[80:83], v[152:155], v[136:139]
    v_mfma_f32_16x16x32_bf16 v[140:143], v[84:87], v[152:155], v[140:143]
    v_mfma_f32_16x16x32_bf16 v[136:139], v[88:91], v[152:155], v[136:139]
    v_mfma_f32_16x16x32_bf16 v[140:143], v[92:95], v[152:155], v[140:143]
    s_barrier
    s_mov_b32 s46, 4
qkv_wpre_8:
    s_add_u32 m0, s45, s41
    s_lshl_b32 s67, s66, s39
    s_add_u32 s67, s67, s43
    buffer_load_dwordx4 v6, s[20:23], s67 offen sc1 lds
    buffer_load_dwordx4 v7, s[20:23], s67 offen offset:1024 sc1 lds
    s_add_u32 s66, s66, 1
    s_and_b32 s66, s66, 15
    s_add_u32 s45, s45, 8192
    s_cmp_ge_u32 s45, 139264
    s_cselect_b32 s45, 65536, s45
    s_sub_u32 s46, s46, 1
    s_cmp_lg_u32 s46, 0
    s_cbranch_scc1 qkv_wpre_8
    s_cmp_lg_u32 s6, 4
    s_cbranch_scc1 go_9
    s_lshl_b32 s60, s4, 11
    s_add_u32 s60, s60, 0x4518000
    v_and_b32 v14, 15, v0
    v_lshlrev_b32 v14, 2, v14
    s_sleep 14
    s_mov_b32 s61, 100000
poll_10:
    buffer_load_dword v15, v14, s[8:11], s60 offen sc1
    s_waitcnt vmcnt(0)
    v_cmp_eq_u32 vcc, 0, v15
    s_sub_u32 s61, s61, 1
    s_cbranch_scc1 polld_11
    s_nop 1
    s_cbranch_vccz polld_11
    s_sleep 2
    s_branch poll_10
polld_11:
go_9:
    s_barrier
    s_add_u32 m0, s68, 0
    s_nop 0
    buffer_load_dwordx4 v156, s[12:15], s52 offen sc1 lds
    s_add_u32 m0, s68, 1024
    s_nop 0
    buffer_load_dwordx4 v157, s[12:15], s52 offen sc1 lds
    s_add_u32 m0, s68, 2048
    s_nop 0
    buffer_load_dwordx4 v158, s[12:15], s52 offen sc1 lds
    s_add_u32 m0, s68, 3072
    s_nop 0
    buffer_load_dwordx4 v159, s[12:15], s52 offen sc1 lds
    s_add_u32 s52, s52, s59
    s_add_u32 m0, s68, 16384
    s_nop 0
    buffer_load_dwordx4 v156, s[12:15], s52 offen sc1 lds
    s_add_u32 m0, s68, 17408
    s_nop 0
    buffer_load_dwordx4 v157, s[12:15], s52 offen sc1 lds
    s_add_u32 m0, s68, 18432
    s_nop 0
    buffer_load_dwordx4 v158, s[12:15], s52 offen sc1 lds
    s_add_u32 m0, s68, 19456
    s_nop 0
    buffer_load_dwordx4 v159, s[12:15], s52 offen sc1 lds
    s_add_u32 m0, s44, s40
    s_lshl_b32 s67, s65, s69
    s_add_u32 s67, s67, s42
    buffer_load_dwordx4 v2, s[12:15], s67 offen offset:0 sc1 lds
    buffer_load_dwordx4 v3, s[12:15], s67 offen offset:1024 sc1 lds
    buffer_load_dwordx4 v4, s[12:15], s67 offen offset:2048 sc1 lds
    buffer_load_dwordx4 v5, s[12:15], s67 offen offset:3072 sc1 lds
    s_add_u32 s65, s65, 1
    s_and_b32 s65, s65, 15
    s_add_u32 s44, s44, 16384
    s_cmp_ge_u32 s44, 65536
    s_cselect_b32 s44, 0, s44
    s_add_u32 m0, s44, s40
    s_lshl_b32 s67, s65, s69
    s_add_u32 s67, s67, s42
    buffer_load_dwordx4 v2, s[12:15], s67 offen offset:0 sc1 lds
    buffer_load_dwordx4 v3, s[12:15], s67 offen offset:1024 sc1 lds
    buffer_load_dwordx4 v4, s[12:15], s67 offen offset:2048 sc1 lds
    buffer_load_dwordx4 v5, s[12:15], s67 offen offset:3072 sc1 lds
    s_add_u32 s65, s65, 1
    s_and_b32 s65, s65, 15
    s_add_u32 s44, s44, 16384
    s_cmp_ge_u32 s44, 65536
    s_cselect_b32 s44, 0, s44
    s_mul_i32 s47, s7, 4608
    s_add_u32 s47, s47, 139264
    v_lshl_add_u32 v156, v0, 4, s47
    v_and_b32 v13, 15, v0
    v_lshl_add_u32 v157, v13, 3, s47
    s_and_b32 s47, s7, 1
    s_lshl_b32 s47, s47, 10
    s_add_u32 s47, s47, 139264
    v_lshl_add_u32 v158, v0, 4, s47
    v_lshlrev_b32 v13, 3, v13
    v_add_u32 v159, 143360, v13
    s_waitcnt vmcnt(8)
    ds_read_b128 v[96:99], v160 offset:0
    ds_read_b128 v[100:103], v161 offset:0
    ds_read_b128 v[104:107], v162 offset:0
    ds_read_b128 v[108:111], v163 offset:0
    ds_read_b128 v[112:115], v160 offset:16384
    ds_read_b128 v[116:119], v161 offset:16384
    ds_read_b128 v[120:123], v162 offset:16384
    ds_read_b128 v[124:127], v163 offset:16384
    s_waitcnt lgkmcnt(0)
    s_add_u32 m0, s44, s40
    s_lshl_b32 s67, s65, s69
    s_add_u32 s67, s67, s42
    buffer_load_dwordx4 v2, s[12:15], s67 offen offset:0 sc1 lds
    v_mfma_f32_16x16x32_bf16 v[128:131], v[32:35], v[96:99], 0
    v_mfma_f32_16x16x32_bf16 v[132:135], v[36:39], v[96:99], 0
    v_mfma_f32_16x16x32_bf16 v[144:147], v[152:155], v[96:99], 0
    v_mfma_f32_16x16x32_bf16 v[148:151], v[96:99], v[96:99], 0
    v_mfma_f32_16x16x32_bf16 v[128:131], v[40:43], v[100:103], v[128:131]
    v_mfma_f32_16x16x32_bf16 v[132:135], v[44:47], v[100:103], v[132:135]
    buffer_load_dwordx4 v3, s[12:15], s67 offen offset:1024 sc1 lds
    v_mfma_f32_16x16x32_bf16 v[144:147], v[152:155], v[100:103], v[144:147]
    v_mfma_f32_16x16x32_bf16 v[148:151], v[100:103], v[100:103], v[148:151]
    v_mfma_f32_16x16x32_bf16 v[128:131], v[48:51], v[104:107], v[128:131]
    v_mfma_f32_16x16x32_bf16 v[132:135], v[52:55], v[104:107], v[132:135]
    v_mfma_f32_16x16x32_bf16 v[144:147], v[152:155], v[104:107], v[144:147]
    v_mfma_f32_16x16x32_bf16 v[148:151], v[104:107], v[104:107], v[148:151]
    buffer_load_dwordx4 v4, s[12:15], s67 offen offset:2048 sc1 lds
    v_mfma_f32_16x16x32_bf16 v[128:131], v[56:59], v[108:111], v[128:131]
    v_mfma_f32_16x16x32_bf16 v[132:135], v[60:63], v[108:111], v[132:135]
    v_mfma_f32_16x16x32_bf16 v[144:147], v[152:155], v[108:111], v[144:147]
    v_mfma_f32_16x16x32_bf16 v[148:151], v[108:111], v[108:111], v[148:151]
    v_mfma_f32_16x16x32_bf16 v[128:131], v[64:67], v[112:115], v[128:131]
    v_mfma_f32_16x16x32_bf16 v[132:135], v[68:71], v[112:115], v[132:135]
    buffer_load_dwordx4 v5, s[12:15], s67 offen offset:3072 sc1 lds
    v_mfma_f32_16x16x32_bf16 v[144:147], v[152:155], v[112:115], v[144:147]
    v_mfma_f32_16x16x32_bf16 v[148:151], v[112:115], v[112:115], v[148:151]
    v_mfma_f32_16x16x32_bf16 v[128:131], v[72:75], v[116:119], v[128:131]
    v_mfma_f32_16x16x32_bf16 v[132:135], v[76:79], v[116:119], v[132:135]
    v_mfma_f32_16x16x32_bf16 v[144:147], v[152:155], v[116:119], v[144:147]
    v_mfma_f32_16x16x32_bf16 v[148:151], v[116:119], v[116:119], v[148:151]
    s_add_u32 s65, s65, 1
    s_and_b32 s65, s65, 15
    s_add_u32 s44, s44, 16384
    s_cmp_ge_u32 s44, 65536
    s_cselect_b32 s44, 0, s44
    s_add_u32 m0, s44, s40
    s_lshl_b32 s67, s65, s69
    s_add_u32 s67, s67, s42
    buffer_load_dwordx4 v2, s[12:15], s67 offen offset:0 sc1 lds
    v_mfma_f32_16x16x32_bf16 v[128:131], v[80:83], v[120:123], v[128:131]
    v_mfma_f32_16x16x32_bf16 v[132:135], v[84:87], v[120:123], v[132:135]
    v_mfma_f32_16x16x32_bf16 v[144:147], v[152:155], v[120:123], v[144:147]
    v_mfma_f32_16x16x32_bf16 v[148:151], v[120:123], v[120:123], v[148:151]
    v_mfma_f32_16x16x32_bf16 v[128:131], v[88:91], v[124:127], v[128:131]
    v_mfma_f32_16x16x32_bf16 v[132:135], v[92:95], v[124:127], v[132:135]
    buffer_load_dwordx4 v3, s[12:15], s67 offen offset:1024 sc1 lds
    v_mfma_f32_16x16x32_bf16 v[144:147], v[152:155], v[124:127], v[144:147]
    v_mfma_f32_16x16x32_bf16 v[148:151], v[124:127], v[124:127], v[148:151]
    s_nop 7
    ds_write_b128 v156, v[128:131] offset:0
    ds_write_b128 v156, v[132:135] offset:1024
    ds_write_b128 v156, v[136:139] offset:2048
    buffer_load_dwordx4 v4, s[12:15], s67 offen offset:2048 sc1 lds
    ds_write_b128 v156, v[140:143] offset:3072
    v_cndmask_b32 v148, v148, v149, s[80:81]
    v_cndmask_b32 v148, v148, v150, s[82:83]
    v_cndmask_b32 v145, v148, v151, s[84:85]
    s_mov_b64 exec, s[62:63]
    ds_write_b64 v157, v[144:145] offset:4096
    s_mov_b64 exec, -1
    s_waitcnt lgkmcnt(0)
    buffer_load_dwordx4 v5, s[12:15], s67 offen offset:3072 sc1 lds
    s_add_u32 s65, s65, 1
    s_and_b32 s65, s65, 15
    s_add_u32 s44, s44, 16384
    s_cmp_ge_u32 s44, 65536
    s_cselect_b32 s44, 0, s44
    s_waitcnt vmcnt(12)
    s_barrier
    ds_read_b64 v[32:33], v159 offset:0
    ds_read_b64 v[34:35], v159 offset:4608
    ds_read_b64 v[36:37], v159 offset:9216
    ds_read_b64 v[38:39], v159 offset:13824
    ds_read_b128 v[96:99], v158 offset:0
    ds_read_b128 v[100:103], v158 offset:2048
    ds_read_b128 v[104:107], v158 offset:4608
    ds_read_b128 v[108:111], v158 offset:6656
    ds_read_b128 v[112:115], v158 offset:9216
    ds_read_b128 v[116:119], v158 offset:11264
    ds_read_b128 v[120:123], v158 offset:13824
    ds_read_b128 v[124:127], v158 offset:15872
    s_waitcnt lgkmcnt(8)
    v_pk_add_f32 v[32:33], v[32:33], v[34:35]
    v_pk_add_f32 v[32:33], v[32:33], v[36:37]
    v_pk_add_f32 v[32:33], v[32:33], v[38:39]
    v_mul_f32 v32, 0x3a800000, v32
    v_mul_f32 v33, 0x3a800000, v33
    v_fma_f32 v33, -v32, v32, v33
    v_max_f32 v33, 0, v33
    v_cvt_pk_bf16_f32 v34, v32, v33
    v_lshlrev_b32 v32, 16, v34
    v_and_b32 v33, 0xffff0000, v34
    v_add_f32 v33, 0x3727c5ac, v33
    v_cvt_pk_bf16_f32 v34, v33, v33
    v_lshlrev_b32 v33, 16, v34
    v_sqrt_f32 v33, v33
    s_nop 0
    v_cvt_pk_bf16_f32 v34, v33, v33
    v_lshlrev_b32 v33, 16, v34
    v_rcp_f32 v33, v33
    s_waitcnt lgkmcnt(0)
    v_pk_add_f32 v[96:97], v[96:97], v[104:105]
    v_pk_add_f32 v[98:99], v[98:99], v[106:107]
    v_pk_add_f32 v[100:101], v[100:101], v[108:109]
    v_pk_add_f32 v[102:103], v[102:103], v[110:111]
    v_pk_add_f32 v[96:97], v[96:97], v[112:113]
    v_pk_add_f32 v[98:99], v[98:99], v[114:115]
    v_pk_add_f32 v[100:101], v[100:101], v[116:117]
    v_pk_add_f32 v[102:103], v[102:103], v[118:119]
    v_pk_add_f32 v[96:97], v[96:97], v[120:121]
    v_pk_add_f32 v[98:99], v[98:99], v[122:123]
    v_pk_add_f32 v[100:101], v[100:101], v[124:125]
    v_pk_add_f32 v[102:103], v[102:103], v[126:127]
    v_pk_fma_f32 v[96:97], v[100:101], v[32:33], v[96:97] op_sel:[0,0,0] op_sel_hi:[1,0,1] neg_lo:[0,1,0] neg_hi:[0,1,0]
    v_pk_fma_f32 v[98:99], v[102:103], v[32:33], v[98:99] op_sel:[0,0,0] op_sel_hi:[1,0,1] neg_lo:[0,1,0] neg_hi:[0,1,0]
    v_pk_mul_f32 v[96:97], v[96:97], v[32:33] op_sel:[0,1] op_sel_hi:[1,1]
    v_pk_mul_f32 v[98:99], v[98:99], v[32:33] op_sel:[0,1] op_sel_hi:[1,1]
    v_cvt_pk_bf16_f32 v96, v96, v97
    v_cvt_pk_bf16_f32 v97, v98, v99
    ds_write_b16 v28, v96
    ds_write_b16_d16_hi v29, v96
    ds_write_b16 v30, v97
    ds_write_b16_d16_hi v31, v97
    s_waitcnt lgkmcnt(0)
    s_waitcnt vmcnt(8)
    s_barrier
    s_cmp_lg_u32 s7, 0
    s_cbranch_scc1 kvst_12
    ds_read_b128 v[24:27], v18
    s_lshl_b32 s47, s4, 10
    s_lshr_b32 s55, s5, 1
    s_lshl_b32 s55, s55, 7
    s_add_u32 s47, s47, s55
    s_add_u32 s47, s47, s36
    s_add_u32 s47, s47, 0x1f00000
    v_lshlrev_b32 v12, 3, v0
    s_waitcnt lgkmcnt(0)
    buffer_store_dwordx4 v[24:27], v17, s[8:11], s64 offen sc0 sc1
    s_bitcmp1_b32 s5, 0
    s_cbranch_scc1 kvst_12
    s_mov_b64 exec, 0xffff
    buffer_store_dwordx2 v[32:33], v12, s[8:11], s47 offen sc0 sc1
    s_mov_b64 exec, -1
kvst_12:
    s_add_u32 m0, s45, s41
    s_lshl_b32 s67, s66, s39
    s_add_u32 s67, s67, s43
    buffer_load_dwordx4 v6, s[20:23], s67 offen sc1 lds
    buffer_load_dwordx4 v7, s[20:23], s67 offen offset:1024 sc1 lds
    s_add_u32 s66, s66, 1
    s_and_b32 s66, s66, 15
    s_add_u32 s45, s45, 8192
    s_cmp_ge_u32 s45, 139264
    s_cselect_b32 s45, 65536, s45
    s_add_u32 m0, s44, s40
    s_lshl_b32 s67, s65, s69
    s_add_u32 s67, s67, s42
    buffer_load_dwordx4 v2, s[12:15], s67 offen offset:0 sc1 lds
    buffer_load_dwordx4 v3, s[12:15], s67 offen offset:1024 sc1 lds
    buffer_load_dwordx4 v4, s[12:15], s67 offen offset:2048 sc1 lds
    buffer_load_dwordx4 v5, s[12:15], s67 offen offset:3072 sc1 lds
    s_add_u32 s65, s65, 1
    s_and_b32 s65, s65, 15
    s_add_u32 s44, s44, 16384
    s_cmp_ge_u32 s44, 65536
    s_cselect_b32 s44, 0, s44
    s_waitcnt vmcnt(10)
    s_barrier
    s_add_u32 m0, s45, s41
    s_lshl_b32 s67, s66, s39
    s_add_u32 s67, s67, s43
    buffer_load_dwordx4 v6, s[20:23], s67 offen sc1 lds
    buffer_load_dwordx4 v7, s[20:23], s67 offen offset:1024 sc1 lds
    s_add_u32 s66, s66, 1
    s_and_b32 s66, s66, 15
    s_add_u32 s45, s45, 8192
    s_cmp_ge_u32 s45, 139264
    s_cselect_b32 s45, 65536, s45
    s_add_u32 m0, s44, s40
    s_lshl_b32 s67, s65, s69
    s_add_u32 s67, s67, s42
    buffer_load_dwordx4 v2, s[12:15], s67 offen offset:0 sc1 lds
    buffer_load_dwordx4 v3, s[12:15], s67 offen offset:1024 sc1 lds
    buffer_load_dwordx4 v4, s[12:15], s67 offen offset:2048 sc1 lds
    buffer_load_dwordx4 v5, s[12:15], s67 offen offset:3072 sc1 lds
    s_add_u32 s65, s65, 1
    s_and_b32 s65, s65, 15
    s_add_u32 s44, s44, 16384
    s_cmp_ge_u32 s44, 65536
    s_cselect_b32 s44, 0, s44
    s_waitcnt vmcnt(12)
    s_barrier
    s_add_u32 m0, s45, s41
    s_lshl_b32 s67, s66, s39
    s_add_u32 s67, s67, s43
    buffer_load_dwordx4 v6, s[20:23], s67 offen sc1 lds
    buffer_load_dwordx4 v7, s[20:23], s67 offen offset:1024 sc1 lds
    s_add_u32 s66, s66, 1
    s_and_b32 s66, s66, 15
    s_add_u32 s45, s45, 8192
    s_cmp_ge_u32 s45, 139264
    s_cselect_b32 s45, 65536, s45
    s_add_u32 m0, s44, s40
    s_lshl_b32 s67, s65, s69
    s_add_u32 s67, s67, s42
    buffer_load_dwordx4 v2, s[12:15], s67 offen offset:0 sc1 lds
    buffer_load_dwordx4 v3, s[12:15], s67 offen offset:1024 sc1 lds
    buffer_load_dwordx4 v4, s[12:15], s67 offen offset:2048 sc1 lds
    buffer_load_dwordx4 v5, s[12:15], s67 offen offset:3072 sc1 lds
    s_add_u32 s65, s65, 1
    s_and_b32 s65, s65, 15
    s_add_u32 s44, s44, 16384
    s_cmp_ge_u32 s44, 65536
    s_cselect_b32 s44, 0, s44
    s_cmp_lg_u32 s7, 0
    s_cbranch_scc1 kvfl_13
    v_mov_b32 v21, 1
    s_mov_b64 exec, 1
    buffer_store_dword v21, off, s[8:11], s53 sc0 sc1
    s_mov_b64 exec, -1
kvfl_13:
    s_mov_b32 s46, 5
qkv_ld_14:
    s_waitcnt vmcnt(12)
    s_barrier
    s_add_u32 m0, s45, s41
    s_lshl_b32 s67, s66, s39
    s_add_u32 s67, s67, s43
    buffer_load_dwordx4 v6, s[20:23], s67 offen sc1 lds
    buffer_load_dwordx4 v7, s[20:23], s67 offen offset:1024 sc1 lds
    s_add_u32 s66, s66, 1
    s_and_b32 s66, s66, 15
    s_add_u32 s45, s45, 8192
    s_cmp_ge_u32 s45, 139264
    s_cselect_b32 s45, 65536, s45
    s_add_u32 m0, s44, s40
    s_lshl_b32 s67, s65, s69
    s_add_u32 s67, s67, s42
    buffer_load_dwordx4 v2, s[12:15], s67 offen offset:0 sc1 lds
    buffer_load_dwordx4 v3, s[12:15], s67 offen offset:1024 sc1 lds
    buffer_load_dwordx4 v4, s[12:15], s67 offen offset:2048 sc1 lds
    buffer_load_dwordx4 v5, s[12:15], s67 offen offset:3072 sc1 lds
    s_add_u32 s65, s65, 1
    s_and_b32 s65, s65, 15
    s_add_u32 s44, s44, 16384
    s_cmp_ge_u32 s44, 65536
    s_cselect_b32 s44, 0, s44
    s_sub_u32 s46, s46, 1
    s_cmp_lg_u32 s46, 0
    s_cbranch_scc1 qkv_ld_14
    s_waitcnt vmcnt(12)
    s_barrier
    s_add_u32 m0, s45, s41
    s_lshl_b32 s67, s66, s39
    s_add_u32 s67, s67, s43
    buffer_load_dwordx4 v6, s[20:23], s67 offen sc1 lds
    buffer_load_dwordx4 v7, s[20:23], s67 offen offset:1024 sc1 lds
    s_add_u32 s66, s66, 1
    s_and_b32 s66, s66, 15
    s_add_u32 s45, s45, 8192
    s_cmp_ge_u32 s45, 139264
    s_cselect_b32 s45, 65536, s45
    s_add_u32 m0, s44, s40
    s_lshl_b32 s67, s65, s69
    s_add_u32 s67, s67, s42
    buffer_load_dwordx4 v2, s[12:15], s67 offen offset:0 sc1 lds
    buffer_load_dwordx4 v3, s[12:15], s67 offen offset:1024 sc1 lds
    buffer_load_dwordx4 v4, s[12:15], s67 offen offset:2048 sc1 lds
    buffer_load_dwordx4 v5, s[12:15], s67 offen offset:3072 sc1 lds
    s_add_u32 s65, s65, 1
    s_and_b32 s65, s65, 15
    s_add_u32 s44, s44, 16384
    s_cmp_ge_u32 s44, 65536
    s_cselect_b32 s44, 0, s44
    buffer_load_dword v22, v19, s[32:35], 0 offen sc1
    s_mov_b32 s46, 3
qkv_ld_15:
    s_waitcnt vmcnt(12)
    s_barrier
    s_add_u32 m0, s45, s41
    s_lshl_b32 s67, s66, s39
    s_add_u32 s67, s67, s43
    buffer_load_dwordx4 v6, s[20:23], s67 offen sc1 lds
    buffer_load_dwordx4 v7, s[20:23], s67 offen offset:1024 sc1 lds
    s_add_u32 s66, s66, 1
    s_and_b32 s66, s66, 15
    s_add_u32 s45, s45, 8192
    s_cmp_ge_u32 s45, 139264
    s_cselect_b32 s45, 65536, s45
    s_add_u32 m0, s44, s40
    s_lshl_b32 s67, s65, s69
    s_add_u32 s67, s67, s42
    buffer_load_dwordx4 v2, s[12:15], s67 offen offset:0 sc1 lds
    buffer_load_dwordx4 v3, s[12:15], s67 offen offset:1024 sc1 lds
    buffer_load_dwordx4 v4, s[12:15], s67 offen offset:2048 sc1 lds
    buffer_load_dwordx4 v5, s[12:15], s67 offen offset:3072 sc1 lds
    s_add_u32 s65, s65, 1
    s_and_b32 s65, s65, 15
    s_add_u32 s44, s44, 16384
    s_cmp_ge_u32 s44, 65536
    s_cselect_b32 s44, 0, s44
    s_sub_u32 s46, s46, 1
    s_cmp_lg_u32 s46, 0
    s_cbranch_scc1 qkv_ld_15
    s_waitcnt vmcnt(12)
    s_barrier
    s_waitcnt vmcnt(6)
    s_barrier
    v_cmp_gt_u32 vcc, 16, v22
    s_mov_b32 s56, 0
    buffer_load_dwordx4 v[24:27], v20, s[8:11], s48 offen sc1
    s_mov_b64 s[58:59], vcc
    s_waitcnt vmcnt(0)
    s_barrier
    s_waitcnt vmcnt(0)
    v_min_u32 v24, v24, v25
    v_min_u32 v26, v26, v27
    v_min_u32 v24, v24, v26
    v_cmp_eq_u32 vcc, 0, v24
    s_nop 1
    s_or_b64 s[58:59], s[58:59], vcc
    s_cbranch_scc1 kvchk_16
    s_mov_b32 s56, 1
    s_cmp_lg_u32 s7, 0
    s_cbranch_scc1 lnc_17
    s_lshl_b32 s55, s4, 10
    s_add_u32 s55, s55, s36
    s_mov_b32 m0, 158720
    s_add_u32 s55, s55, 0x1f00000
    buffer_load_dwordx4 v23, s[8:11], s55 offen sc1 lds
lnc_17:
    s_lshl_b32 s54, s7, 12
    s_add_u32 s55, s54, s36
    s_add_u32 s55, s55, 0x1e00000
    s_add_u32 m0, s54, 0
    s_nop 0
    buffer_load_dwordx4 v23, s[8:11], s55 offen offset:0 sc1 lds
    buffer_load_dwordx4 v23, s[8:11], s55 offen offset:1024 sc1 lds
    buffer_load_dwordx4 v23, s[8:11], s55 offen offset:2048 sc1 lds
    buffer_load_dwordx4 v23, s[8:11], s55 offen offset:3072 sc1 lds
    s_add_u32 s55, s55, 16384
    s_add_u32 m0, s54, 16384
    s_nop 0
    buffer_load_dwordx4 v23, s[8:11], s55 offen offset:0 sc1 lds
    buffer_load_dwordx4 v23, s[8:11], s55 offen offset:1024 sc1 lds
    buffer_load_dwordx4 v23, s[8:11], s55 offen offset:2048 sc1 lds
    buffer_load_dwordx4 v23, s[8:11], s55 offen offset:3072 sc1 lds
kvchk_16:
    s_barrier
qkv_ldj:
    s_cmp_lg_u32 s56, 0
    s_cbranch_scc1 qkv_havekv
    s_mov_b32 s49, 100000
poll_18:
    buffer_load_dword v22, v19, s[32:35], 0 offen sc1
    s_waitcnt vmcnt(0)
    v_cmp_gt_u32 vcc, 16, v22
    s_sub_u32 s49, s49, 1
    s_cbranch_scc1 polld_19
    s_nop 1
    s_cbranch_vccz polld_19
    s_sleep 2
    s_branch poll_18
polld_19:
    s_mov_b32 s49, 100000
poll_20:
    buffer_load_dwordx4 v[24:27], v20, s[8:11], s48 offen sc1
    s_waitcnt vmcnt(0)
    v_min_u32 v24, v24, v25
    v_min_u32 v24, v24, v26
    v_min_u32 v24, v24, v27
    v_cmp_eq_u32 vcc, 0, v24
    s_sub_u32 s49, s49, 1
    s_cbranch_scc1 polld_21
    s_nop 1
    s_cbranch_vccz polld_21
    s_sleep 16
    s_branch poll_20
polld_21:
    s_cmp_lg_u32 s7, 0
    s_cbranch_scc1 lnc_22
    s_lshl_b32 s55, s4, 10
    s_add_u32 s55, s55, s36
    s_mov_b32 m0, 158720
    s_add_u32 s55, s55, 0x1f00000
    buffer_load_dwordx4 v23, s[8:11], s55 offen sc1 lds
lnc_22:
    s_lshl_b32 s54, s7, 12
    s_add_u32 s55, s54, s36
    s_add_u32 s55, s55, 0x1e00000
    s_add_u32 m0, s54, 0
    s_nop 0
    buffer_load_dwordx4 v23, s[8:11], s55 offen offset:0 sc1 lds
    buffer_load_dwordx4 v23, s[8:11], s55 offen offset:1024 sc1 lds
    buffer_load_dwordx4 v23, s[8:11], s55 offen offset:2048 sc1 lds
    buffer_load_dwordx4 v23, s[8:11], s55 offen offset:3072 sc1 lds
    s_add_u32 s55, s55, 16384
    s_add_u32 m0, s54, 16384
    s_nop 0
    buffer_load_dwordx4 v23, s[8:11], s55 offen offset:0 sc1 lds
    buffer_load_dwordx4 v23, s[8:11], s55 offen offset:1024 sc1 lds
    buffer_load_dwordx4 v23, s[8:11], s55 offen offset:2048 sc1 lds
    buffer_load_dwordx4 v23, s[8:11], s55 offen offset:3072 sc1 lds
qkv_havekv:
    s_waitcnt vmcnt(8)
    s_barrier
    s_add_u32 m0, s54, 32768
    s_add_u32 s55, s55, 16384
    buffer_load_dwordx4 v23, s[8:11], s55 offen offset:0 sc1 lds
    buffer_load_dwordx4 v23, s[8:11], s55 offen offset:1024 sc1 lds
    buffer_load_dwordx4 v23, s[8:11], s55 offen offset:2048 sc1 lds
    buffer_load_dwordx4 v23, s[8:11], s55 offen offset:3072 sc1 lds
    s_add_u32 m0, s54, 49152
    s_add_u32 s55, s55, 16384
    buffer_load_dwordx4 v23, s[8:11], s55 offen offset:0 sc1 lds
    buffer_load_dwordx4 v23, s[8:11], s55 offen offset:1024 sc1 lds
    buffer_load_dwordx4 v23, s[8:11], s55 offen offset:2048 sc1 lds
    buffer_load_dwordx4 v23, s[8:11], s55 offen offset:3072 sc1 lds
    s_cmp_lg_u32 s3, 0
    s_cbranch_scc1 att_common
    s_call_b64 s[88:89], att_setup
    s_branch att_common
k_comp:
    s_cmp_lg_u32 s6, 1
    s_cbranch_scc1 k_notouch
    s_bfe_u32 s40, s2, 0x30003
    s_getpc_b64 s[86:87]
tc_23:
    s_sub_u32 s86, s86, tc_23-qkv_loader
    s_subb_u32 s87, s87, 0
    v_lshlrev_b32 v230, 7, v0
    v_lshl_add_u32 v230, s40, 13, v230
    v_min_u32 v230, k_exit-qkv_loader-4, v230
    global_load_dword v231, v230, s[86:87]
k_notouch:
    s_cmp_lg_u32 s6, 0
    s_cbranch_scc1 k_setup
    v_mov_b32 v4, 0
    v_lshlrev_b32 v2, 15, v0
    v_lshlrev_b32 v3, 11, v0
    s_lshl_b32 s40, s4, 11
    s_lshl_b32 s41, s5, 2
    s_add_u32 s40, s40, s41
    s_add_u32 s40, s40, 0x4500000
    s_lshl_b32 s41, s4, 7
    s_lshl_b32 s42, s5, 2
    s_add_u32 s41, s41, s42
    s_add_u32 s41, s41, 0x4550000
    s_lshl_b32 s43, s4, 4
    s_mov_b64 exec, 0x3ff
    buffer_store_dword v4, v2, s[8:11], s40 offen sc0 sc1
    v_and_b32 v5, 3, v0
    v_lshlrev_b32 v5, 2, v5
    v_lshrrev_b32 v6, 2, v0
    v_mul_u32_u24 v6, 163840, v6
    v_add_u32 v5, v5, v6
    s_lshl_b32 s42, s4, 11
    s_lshl_b32 s43, s5, 4
    s_add_u32 s42, s42, s43
    s_add_u32 s42, s42, 0x4500400
    s_mov_b64 exec, 0xff
    buffer_store_dword v4, v5, s[8:11], s42 offen sc0 sc1
    s_mov_b64 exec, 15
    buffer_store_dword v4, v3, s[8:11], s41 offen sc0 sc1
    s_mov_b64 exec, -1
k_setup:
    s_call_b64 s[88:89], att_setup
qkv_compute:
    s_cmp_eq_u32 s3, 0
    s_cbranch_scc1 qkv_nogo
    s_cmp_lg_u32 s6, 0
    s_cbranch_scc1 pub_24
    s_lshl_b32 s60, s4, 11
    s_add_u32 s60, s60, 0x4518000
    s_lshl_b32 s61, s5, 2
    s_add_u32 s61, s61, s60
    v_mov_b32 v3, 1
    s_mov_b64 exec, 1
    buffer_store_dword v3, off, s[8:11], s61 sc0 sc1
    s_mov_b64 exec, -1
pub_24:
qkv_nogo:
    s_lshr_b32 s48, s7, 1
    s_and_b32 s49, s7, 1
    v_and_b32 v2, 15, v0
    v_lshrrev_b32 v3, 4, v0
    v_and_b32 v4, 7, v0
    v_xor_b32 v3, v3, v4
    v_lshlrev_b32 v2, 7, v2
    v_lshl_add_u32 v2, v3, 4, v2
    v_xor_b32 v3, 64, v2
    s_lshl_b32 s42, s48, 13
    v_add_u32 v8, s42, v2
    v_add_u32 v9, s42, v3
    v_lshrrev_b32 v4, 2, v0
    v_lshlrev_b32 v2, 7, v4
    v_and_b32 v3, 3, v0
    v_lshl_add_u32 v2, v3, 3, v2
    v_lshrrev_b32 v3, 3, v0
    v_and_b32 v3, 3, v3
    v_lshlrev_b32 v3, 5, v3
    s_lshl_b32 s40, s49, 6
    v_xor_b32 v3, s40, v3
    v_add_u32 v2, 65536, v2
    v_xor_b32 v4, 0, v3
    v_add_u32 v10, v2, v4
    v_xor_b32 v4, 32, v3
    v_add_u32 v11, v2, v4
    v_mov_b32 v12, 0x3f803f80
    v_mov_b32 v13, 0x3f803f80
    v_mov_b32 v14, 0x3f803f80
    v_mov_b32 v15, 0x3f803f80
    v_mov_b32 v16, 0
    v_mov_b32 v17, 0
    v_mov_b32 v18, 0
    v_mov_b32 v19, 0
    v_mov_b32 v20, 0
    v_mov_b32 v21, 0
    v_mov_b32 v22, 0
    v_mov_b32 v23, 0
    v_mov_b32 v24, 0
    v_mov_b32 v25, 0
    v_mov_b32 v26, 0
    v_mov_b32 v27, 0
    v_mov_b32 v28, 0
    v_mov_b32 v29, 0
    v_mov_b32 v30, 0
    v_mov_b32 v31, 0
    v_mov_b32 v32, 0
    v_mov_b32 v33, 0
    v_mov_b32 v34, 0
    v_mov_b32 v35, 0
    v_mov_b32 v36, 0
    v_mov_b32 v37, 0
    v_mov_b32 v38, 0
    v_mov_b32 v39, 0
    v_mov_b32 v40, 0
    v_mov_b32 v41, 0
    v_mov_b32 v42, 0
    v_mov_b32 v43, 0
    v_mov_b32 v44, 0
    v_mov_b32 v45, 0
    v_mov_b32 v46, 0
    v_mov_b32 v47, 0
    v_mov_b32 v48, 0
    v_mov_b32 v49, 0
    v_mov_b32 v50, 0
    v_mov_b32 v51, 0
    v_mov_b32 v52, 0
    v_mov_b32 v53, 0
    v_mov_b32 v54, 0
    v_mov_b32 v55, 0
    v_and_b32 v2, 15, v0
    v_lshlrev_b32 v2, 3, v2
    s_lshr_b32 s40, s42, 4
    s_add_u32 s40, s40, 158720
    v_add_u32 v3, s40, v2
    v_and_b32 v6, 15, v0
    v_lshlrev_b32 v6, 4, v6
    v_bfe_u32 v7, v0, 4, 1
    v_lshl_add_u32 v6, v7, 9, v6
    v_lshrrev_b32 v7, 5, v0
    v_lshl_add_u32 v6, v7, 10, v6
    s_lshl_b32 s40, s49, 11
    s_add_u32 s40, s40, 98304
    s_add_u32 s40, s40, s42
    v_add_u32 v6, s40, v6
    s_barrier
    s_or_b32 s40, s3, s6
    s_cbranch_scc1 qkv_noat
    s_lshl_b32 s40, s4, 4
    s_mov_b64 exec, 1
    v_mov_b32 v2, 1
    s_waitcnt vmcnt(0)
    buffer_atomic_add v2, off, s[32:35], s40 sc1
    s_mov_b64 exec, -1
qkv_noat:
    s_mov_b32 s50, 0
    s_mov_b32 s51, 0
    s_mov_b32 s52, 4
    s_add_u32 s50, s50, 1
    s_mov_b32 s53, 16384
    s_cmp_eq_u32 s50, 4
    s_cselect_b32 s53, -49152, s53
    s_cselect_b32 s50, 0, s50
    s_add_u32 s51, s51, 1
    s_mov_b32 s54, 8192
    s_cmp_eq_u32 s51, 9
    s_cselect_b32 s54, -65536, s54
    s_cselect_b32 s51, 0, s51
    s_barrier
    ds_read_b64_tr_b16 v[120:121], v10 offset:0
    ds_read_b64_tr_b16 v[122:123], v10 offset:2048
    ds_read_b64_tr_b16 v[124:125], v11 offset:0
    ds_read_b64_tr_b16 v[126:127], v11 offset:2048
    ds_read_b128 v[56:59], v8 offset:0
    ds_read_b128 v[60:63], v8 offset:2048
    ds_read_b128 v[64:67], v8 offset:4096
    ds_read_b128 v[68:71], v8 offset:6144
    .p2align 6
qkv_loop:
    s_waitcnt lgkmcnt(0)
    v_mfma_f32_16x16x32_bf16 v[48:51], v[120:123], v[12:15], v[48:51]
    ds_read_b64_tr_b16 v[128:129], v10 offset:4096
    ds_read_b64_tr_b16 v[130:131], v10 offset:6144
    v_mfma_f32_16x16x32_bf16 v[52:55], v[124:127], v[12:15], v[52:55]
    ds_read_b64_tr_b16 v[132:133], v11 offset:4096
    ds_read_b64_tr_b16 v[134:135], v11 offset:6144
    v_mfma_f32_16x16x32_bf16 v[16:19], v[120:123], v[56:59], v[16:19]
    ds_read_b128 v[72:75], v9 offset:0
    ds_read_b128 v[76:79], v9 offset:2048
    v_mfma_f32_16x16x32_bf16 v[20:23], v[124:127], v[56:59], v[20:23]
    ds_read_b128 v[80:83], v9 offset:4096
    ds_read_b128 v[84:87], v9 offset:6144
    v_mfma_f32_16x16x32_bf16 v[24:27], v[120:123], v[60:63], v[24:27]
    v_add_u32 v8, s53, v8
    v_add_u32 v9, s53, v9
    v_mfma_f32_16x16x32_bf16 v[28:31], v[124:127], v[60:63], v[28:31]
    v_add_u32 v10, s54, v10
    v_add_u32 v11, s54, v11
    v_mfma_f32_16x16x32_bf16 v[32:35], v[120:123], v[64:67], v[32:35]
    v_mfma_f32_16x16x32_bf16 v[36:39], v[124:127], v[64:67], v[36:39]
    v_mfma_f32_16x16x32_bf16 v[40:43], v[120:123], v[68:71], v[40:43]
    v_mfma_f32_16x16x32_bf16 v[44:47], v[124:127], v[68:71], v[44:47]
    s_waitcnt lgkmcnt(0)
    s_barrier
    v_mfma_f32_16x16x32_bf16 v[48:51], v[128:131], v[12:15], v[48:51]
    ds_read_b64_tr_b16 v[120:121], v10 offset:0
    ds_read_b64_tr_b16 v[122:123], v10 offset:2048
    v_mfma_f32_16x16x32_bf16 v[52:55], v[132:135], v[12:15], v[52:55]
    ds_read_b64_tr_b16 v[124:125], v11 offset:0
    ds_read_b64_tr_b16 v[126:127], v11 offset:2048
    v_mfma_f32_16x16x32_bf16 v[16:19], v[128:131], v[72:75], v[16:19]
    ds_read_b128 v[56:59], v8 offset:0
    ds_read_b128 v[60:63], v8 offset:2048
    v_mfma_f32_16x16x32_bf16 v[20:23], v[132:135], v[72:75], v[20:23]
    ds_read_b128 v[64:67], v8 offset:4096
    ds_read_b128 v[68:71], v8 offset:6144
    v_mfma_f32_16x16x32_bf16 v[24:27], v[128:131], v[76:79], v[24:27]
    s_add_u32 s50, s50, 1
    s_mov_b32 s53, 16384
    s_cmp_eq_u32 s50, 4
    s_cselect_b32 s53, -49152, s53
    v_mfma_f32_16x16x32_bf16 v[28:31], v[132:135], v[76:79], v[28:31]
    s_cselect_b32 s50, 0, s50
    s_add_u32 s51, s51, 1
    s_mov_b32 s54, 8192
    v_mfma_f32_16x16x32_bf16 v[32:35], v[128:131], v[80:83], v[32:35]
    s_cmp_eq_u32 s51, 9
    s_cselect_b32 s54, -65536, s54
    s_cselect_b32 s51, 0, s51
    v_mfma_f32_16x16x32_bf16 v[36:39], v[132:135], v[80:83], v[36:39]
    v_mfma_f32_16x16x32_bf16 v[40:43], v[128:131], v[84:87], v[40:43]
    v_mfma_f32_16x16x32_bf16 v[44:47], v[132:135], v[84:87], v[44:47]
    s_waitcnt lgkmcnt(0)
    v_mfma_f32_16x16x32_bf16 v[48:51], v[120:123], v[12:15], v[48:51]
    ds_read_b64_tr_b16 v[128:129], v10 offset:4096
    ds_read_b64_tr_b16 v[130:131], v10 offset:6144
    v_mfma_f32_16x16x32_bf16 v[52:55], v[124:127], v[12:15], v[52:55]
    ds_read_b64_tr_b16 v[132:133], v11 offset:4096
    ds_read_b64_tr_b16 v[134:135], v11 offset:6144
    v_mfma_f32_16x16x32_bf16 v[16:19], v[120:123], v[56:59], v[16:19]
    ds_read_b128 v[72:75], v9 offset:0
    ds_read_b128 v[76:79], v9 offset:2048
    v_mfma_f32_16x16x32_bf16 v[20:23], v[124:127], v[56:59], v[20:23]
    ds_read_b128 v[80:83], v9 offset:4096
    ds_read_b128 v[84:87], v9 offset:6144
    v_mfma_f32_16x16x32_bf16 v[24:27], v[120:123], v[60:63], v[24:27]
    v_add_u32 v8, s53, v8
    v_add_u32 v9, s53, v9
    v_mfma_f32_16x16x32_bf16 v[28:31], v[124:127], v[60:63], v[28:31]
    v_add_u32 v10, s54, v10
    v_add_u32 v11, s54, v11
    v_mfma_f32_16x16x32_bf16 v[32:35], v[120:123], v[64:67], v[32:35]
    v_mfma_f32_16x16x32_bf16 v[36:39], v[124:127], v[64:67], v[36:39]
    v_mfma_f32_16x16x32_bf16 v[40:43], v[120:123], v[68:71], v[40:43]
    v_mfma_f32_16x16x32_bf16 v[44:47], v[124:127], v[68:71], v[44:47]
    s_waitcnt lgkmcnt(0)
    s_barrier
    v_mfma_f32_16x16x32_bf16 v[48:51], v[128:131], v[12:15], v[48:51]
    ds_read_b64_tr_b16 v[120:121], v10 offset:0
    ds_read_b64_tr_b16 v[122:123], v10 offset:2048
    v_mfma_f32_16x16x32_bf16 v[52:55], v[132:135], v[12:15], v[52:55]
    ds_read_b64_tr_b16 v[124:125], v11 offset:0
    ds_read_b64_tr_b16 v[126:127], v11 offset:2048
    v_mfma_f32_16x16x32_bf16 v[16:19], v[128:131], v[72:75], v[16:19]
    ds_read_b128 v[56:59], v8 offset:0
    ds_read_b128 v[60:63], v8 offset:2048
    v_mfma_f32_16x16x32_bf16 v[20:23], v[132:135], v[72:75], v[20:23]
    ds_read_b128 v[64:67], v8 offset:4096
    ds_read_b128 v[68:71], v8 offset:6144
    v_mfma_f32_16x16x32_bf16 v[24:27], v[128:131], v[76:79], v[24:27]
    s_add_u32 s50, s50, 1
    s_mov_b32 s53, 16384
    s_cmp_eq_u32 s50, 4
    s_cselect_b32 s53, -49152, s53
    v_mfma_f32_16x16x32_bf16 v[28:31], v[132:135], v[76:79], v[28:31]
    s_cselect_b32 s50, 0, s50
    s_add_u32 s51, s51, 1
    s_mov_b32 s54, 8192
    v_mfma_f32_16x16x32_bf16 v[32:35], v[128:131], v[80:83], v[32:35]
    s_cmp_eq_u32 s51, 9
    s_cselect_b32 s54, -65536, s54
    s_cselect_b32 s51, 0, s51
    v_mfma_f32_16x16x32_bf16 v[36:39], v[132:135], v[80:83], v[36:39]
    v_mfma_f32_16x16x32_bf16 v[40:43], v[128:131], v[84:87], v[40:43]
    v_mfma_f32_16x16x32_bf16 v[44:47], v[132:135], v[84:87], v[44:47]
    s_waitcnt lgkmcnt(0)
    v_mfma_f32_16x16x32_bf16 v[48:51], v[120:123], v[12:15], v[48:51]
    ds_read_b64_tr_b16 v[128:129], v10 offset:4096
    ds_read_b64_tr_b16 v[130:131], v10 offset:6144
    v_mfma_f32_16x16x32_bf16 v[52:55], v[124:127], v[12:15], v[52:55]
    ds_read_b64_tr_b16 v[132:133], v11 offset:4096
    ds_read_b64_tr_b16 v[134:135], v11 offset:6144
    v_mfma_f32_16x16x32_bf16 v[16:19], v[120:123], v[56:59], v[16:19]
    ds_read_b128 v[72:75], v9 offset:0
    ds_read_b128 v[76:79], v9 offset:2048
    v_mfma_f32_16x16x32_bf16 v[20:23], v[124:127], v[56:59], v[20:23]
    ds_read_b128 v[80:83], v9 offset:4096
    ds_read_b128 v[84:87], v9 offset:6144
    v_mfma_f32_16x16x32_bf16 v[24:27], v[120:123], v[60:63], v[24:27]
    v_add_u32 v8, s53, v8
    v_add_u32 v9, s53, v9
    v_mfma_f32_16x16x32_bf16 v[28:31], v[124:127], v[60:63], v[28:31]
    v_add_u32 v10, s54, v10
    v_add_u32 v11, s54, v11
    v_mfma_f32_16x16x32_bf16 v[32:35], v[120:123], v[64:67], v[32:35]
    v_mfma_f32_16x16x32_bf16 v[36:39], v[124:127], v[64:67], v[36:39]
    v_mfma_f32_16x16x32_bf16 v[40:43], v[120:123], v[68:71], v[40:43]
    v_mfma_f32_16x16x32_bf16 v[44:47], v[124:127], v[68:71], v[44:47]
    s_waitcnt lgkmcnt(0)
    s_barrier
    v_mfma_f32_16x16x32_bf16 v[48:51], v[128:131], v[12:15], v[48:51]
    ds_read_b64_tr_b16 v[120:121], v10 offset:0
    ds_read_b64_tr_b16 v[122:123], v10 offset:2048
    v_mfma_f32_16x16x32_bf16 v[52:55], v[132:135], v[12:15], v[52:55]
    ds_read_b64_tr_b16 v[124:125], v11 offset:0
    ds_read_b64_tr_b16 v[126:127], v11 offset:2048
    v_mfma_f32_16x16x32_bf16 v[16:19], v[128:131], v[72:75], v[16:19]
    ds_read_b128 v[56:59], v8 offset:0
    ds_read_b128 v[60:63], v8 offset:2048
    v_mfma_f32_16x16x32_bf16 v[20:23], v[132:135], v[72:75], v[20:23]
    ds_read_b128 v[64:67], v8 offset:4096
    ds_read_b128 v[68:71], v8 offset:6144
    v_mfma_f32_16x16x32_bf16 v[24:27], v[128:131], v[76:79], v[24:27]
    s_add_u32 s50, s50, 1
    s_mov_b32 s53, 16384
    s_cmp_eq_u32 s50, 4
    s_cselect_b32 s53, -49152, s53
    v_mfma_f32_16x16x32_bf16 v[28:31], v[132:135], v[76:79], v[28:31]
    s_cselect_b32 s50, 0, s50
    s_add_u32 s51, s51, 1
    s_mov_b32 s54, 8192
    v_mfma_f32_16x16x32_bf16 v[32:35], v[128:131], v[80:83], v[32:35]
    s_cmp_eq_u32 s51, 9
    s_cselect_b32 s54, -65536, s54
    s_cselect_b32 s51, 0, s51
    v_mfma_f32_16x16x32_bf16 v[36:39], v[132:135], v[80:83], v[36:39]
    v_mfma_f32_16x16x32_bf16 v[40:43], v[128:131], v[84:87], v[40:43]
    v_mfma_f32_16x16x32_bf16 v[44:47], v[132:135], v[84:87], v[44:47]
    s_waitcnt lgkmcnt(0)
    v_mfma_f32_16x16x32_bf16 v[48:51], v[120:123], v[12:15], v[48:51]
    ds_read_b64_tr_b16 v[128:129], v10 offset:4096
    ds_read_b64_tr_b16 v[130:131], v10 offset:6144
    v_mfma_f32_16x16x32_bf16 v[52:55], v[124:127], v[12:15], v[52:55]
    ds_read_b64_tr_b16 v[132:133], v11 offset:4096
    ds_read_b64_tr_b16 v[134:135], v11 offset:6144
    v_mfma_f32_16x16x32_bf16 v[16:19], v[120:123], v[56:59], v[16:19]
    ds_read_b128 v[72:75], v9 offset:0
    ds_read_b128 v[76:79], v9 offset:2048
    v_mfma_f32_16x16x32_bf16 v[20:23], v[124:127], v[56:59], v[20:23]
    ds_read_b128 v[80:83], v9 offset:4096
    ds_read_b128 v[84:87], v9 offset:6144
    v_mfma_f32_16x16x32_bf16 v[24:27], v[120:123], v[60:63], v[24:27]
    v_add_u32 v8, s53, v8
    v_add_u32 v9, s53, v9
    v_mfma_f32_16x16x32_bf16 v[28:31], v[124:127], v[60:63], v[28:31]
    v_add_u32 v10, s54, v10
    v_add_u32 v11, s54, v11
    v_mfma_f32_16x16x32_bf16 v[32:35], v[120:123], v[64:67], v[32:35]
    v_mfma_f32_16x16x32_bf16 v[36:39], v[124:127], v[64:67], v[36:39]
    v_mfma_f32_16x16x32_bf16 v[40:43], v[120:123], v[68:71], v[40:43]
    v_mfma_f32_16x16x32_bf16 v[44:47], v[124:127], v[68:71], v[44:47]
    s_waitcnt lgkmcnt(0)
    s_barrier
    v_mfma_f32_16x16x32_bf16 v[48:51], v[128:131], v[12:15], v[48:51]
    ds_read_b64_tr_b16 v[120:121], v10 offset:0
    ds_read_b64_tr_b16 v[122:123], v10 offset:2048
    v_mfma_f32_16x16x32_bf16 v[52:55], v[132:135], v[12:15], v[52:55]
    ds_read_b64_tr_b16 v[124:125], v11 offset:0
    ds_read_b64_tr_b16 v[126:127], v11 offset:2048
    v_mfma_f32_16x16x32_bf16 v[16:19], v[128:131], v[72:75], v[16:19]
    ds_read_b128 v[56:59], v8 offset:0
    ds_read_b128 v[60:63], v8 offset:2048
    v_mfma_f32_16x16x32_bf16 v[20:23], v[132:135], v[72:75], v[20:23]
    ds_read_b128 v[64:67], v8 offset:4096
    ds_read_b128 v[68:71], v8 offset:6144
    v_mfma_f32_16x16x32_bf16 v[24:27], v[128:131], v[76:79], v[24:27]
    s_add_u32 s50, s50, 1
    s_mov_b32 s53, 16384
    s_cmp_eq_u32 s50, 4
    s_cselect_b32 s53, -49152, s53
    v_mfma_f32_16x16x32_bf16 v[28:31], v[132:135], v[76:79], v[28:31]
    s_cselect_b32 s50, 0, s50
    s_add_u32 s51, s51, 1
    s_mov_b32 s54, 8192
    v_mfma_f32_16x16x32_bf16 v[32:35], v[128:131], v[80:83], v[32:35]
    s_cmp_eq_u32 s51, 9
    s_cselect_b32 s54, -65536, s54
    s_cselect_b32 s51, 0, s51
    v_mfma_f32_16x16x32_bf16 v[36:39], v[132:135], v[80:83], v[36:39]
    s_sub_u32 s52, s52, 1
    s_cmp_lg_u32 s52, 0
    v_mfma_f32_16x16x32_bf16 v[40:43], v[128:131], v[84:87], v[40:43]
    v_mfma_f32_16x16x32_bf16 v[44:47], v[132:135], v[84:87], v[44:47]
    s_cbranch_scc1 qkv_loop
    s_nop 1
    s_waitcnt lgkmcnt(0)
    s_barrier
    ds_read_b64 v[56:57], v3 offset:0
    ds_read_b64 v[58:59], v3 offset:128
    ds_read_b64 v[60:61], v3 offset:256
    ds_read_b64 v[62:63], v3 offset:384
    s_waitcnt lgkmcnt(3)
    v_mul_f32 v57, 0x3e8293ee, v57
    v_pk_fma_f32 v[16:17], v[48:49], v[56:57], v[16:17] op_sel:[0,0,0] op_sel_hi:[1,0,1] neg_lo:[0,1,0] neg_hi:[0,1,0]
    v_pk_fma_f32 v[18:19], v[50:51], v[56:57], v[18:19] op_sel:[0,0,0] op_sel_hi:[1,0,1] neg_lo:[0,1,0] neg_hi:[0,1,0]
    v_pk_fma_f32 v[20:21], v[52:53], v[56:57], v[20:21] op_sel:[0,0,0] op_sel_hi:[1,0,1] neg_lo:[0,1,0] neg_hi:[0,1,0]
    v_pk_fma_f32 v[22:23], v[54:55], v[56:57], v[22:23] op_sel:[0,0,0] op_sel_hi:[1,0,1] neg_lo:[0,1,0] neg_hi:[0,1,0]
    v_pk_mul_f32 v[16:17], v[16:17], v[56:57] op_sel:[0,1] op_sel_hi:[1,1]
    v_pk_mul_f32 v[18:19], v[18:19], v[56:57] op_sel:[0,1] op_sel_hi:[1,1]
    v_pk_mul_f32 v[20:21], v[20:21], v[56:57] op_sel:[0,1] op_sel_hi:[1,1]
    v_pk_mul_f32 v[22:23], v[22:23], v[56:57] op_sel:[0,1] op_sel_hi:[1,1]
    v_cvt_pk_bf16_f32 v68, v16, v17
    v_cvt_pk_bf16_f32 v69, v18, v19
    v_cvt_pk_bf16_f32 v70, v20, v21
    v_cvt_pk_bf16_f32 v71, v22, v23
    ds_write_b128 v6, v[68:71] offset:0
    s_waitcnt lgkmcnt(3)
    v_mul_f32 v59, 0x3e8293ee, v59
    v_pk_fma_f32 v[24:25], v[48:49], v[58:59], v[24:25] op_sel:[0,0,0] op_sel_hi:[1,0,1] neg_lo:[0,1,0] neg_hi:[0,1,0]
    v_pk_fma_f32 v[26:27], v[50:51], v[58:59], v[26:27] op_sel:[0,0,0] op_sel_hi:[1,0,1] neg_lo:[0,1,0] neg_hi:[0,1,0]
    v_pk_fma_f32 v[28:29], v[52:53], v[58:59], v[28:29] op_sel:[0,0,0] op_sel_hi:[1,0,1] neg_lo:[0,1,0] neg_hi:[0,1,0]
    v_pk_fma_f32 v[30:31], v[54:55], v[58:59], v[30:31] op_sel:[0,0,0] op_sel_hi:[1,0,1] neg_lo:[0,1,0] neg_hi:[0,1,0]
    v_pk_mul_f32 v[24:25], v[24:25], v[58:59] op_sel:[0,1] op_sel_hi:[1,1]
    v_pk_mul_f32 v[26:27], v[26:27], v[58:59] op_sel:[0,1] op_sel_hi:[1,1]
    v_pk_mul_f32 v[28:29], v[28:29], v[58:59] op_sel:[0,1] op_sel_hi:[1,1]
    v_pk_mul_f32 v[30:31], v[30:31], v[58:59] op_sel:[0,1] op_sel_hi:[1,1]
    v_cvt_pk_bf16_f32 v72, v24, v25
    v_cvt_pk_bf16_f32 v73, v26, v27
    v_cvt_pk_bf16_f32 v74, v28, v29
    v_cvt_pk_bf16_f32 v75, v30, v31
    ds_write_b128 v6, v[72:75] offset:256
    s_waitcnt lgkmcnt(3)
    v_mul_f32 v61, 0x3e8293ee, v61
    v_pk_fma_f32 v[32:33], v[48:49], v[60:61], v[32:33] op_sel:[0,0,0] op_sel_hi:[1,0,1] neg_lo:[0,1,0] neg_hi:[0,1,0]
    v_pk_fma_f32 v[34:35], v[50:51], v[60:61], v[34:35] op_sel:[0,0,0] op_sel_hi:[1,0,1] neg_lo:[0,1,0] neg_hi:[0,1,0]
    v_pk_fma_f32 v[36:37], v[52:53], v[60:61], v[36:37] op_sel:[0,0,0] op_sel_hi:[1,0,1] neg_lo:[0,1,0] neg_hi:[0,1,0]
    v_pk_fma_f32 v[38:39], v[54:55], v[60:61], v[38:39] op_sel:[0,0,0] op_sel_hi:[1,0,1] neg_lo:[0,1,0] neg_hi:[0,1,0]
    v_pk_mul_f32 v[32:33], v[32:33], v[60:61] op_sel:[0,1] op_sel_hi:[1,1]
    v_pk_mul_f32 v[34:35], v[34:35], v[60:61] op_sel:[0,1] op_sel_hi:[1,1]
    v_pk_mul_f32 v[36:37], v[36:37], v[60:61] op_sel:[0,1] op_sel_hi:[1,1]
    v_pk_mul_f32 v[38:39], v[38:39], v[60:61] op_sel:[0,1] op_sel_hi:[1,1]
    v_cvt_pk_bf16_f32 v76, v32, v33
    v_cvt_pk_bf16_f32 v77, v34, v35
    v_cvt_pk_bf16_f32 v78, v36, v37
    v_cvt_pk_bf16_f32 v79, v38, v39
    ds_write_b128 v6, v[76:79] offset:4096
    s_waitcnt lgkmcnt(3)
    v_mul_f32 v63, 0x3e8293ee, v63
    v_pk_fma_f32 v[40:41], v[48:49], v[62:63], v[40:41] op_sel:[0,0,0] op_sel_hi:[1,0,1] neg_lo:[0,1,0] neg_hi:[0,1,0]
    v_pk_fma_f32 v[42:43], v[50:51], v[62:63], v[42:43] op_sel:[0,0,0] op_sel_hi:[1,0,1] neg_lo:[0,1,0] neg_hi:[0,1,0]
    v_pk_fma_f32 v[44:45], v[52:53], v[62:63], v[44:45] op_sel:[0,0,0] op_sel_hi:[1,0,1] neg_lo:[0,1,0] neg_hi:[0,1,0]
    v_pk_fma_f32 v[46:47], v[54:55], v[62:63], v[46:47] op_sel:[0,0,0] op_sel_hi:[1,0,1] neg_lo:[0,1,0] neg_hi:[0,1,0]
    v_pk_mul_f32 v[40:41], v[40:41], v[62:63] op_sel:[0,1] op_sel_hi:[1,1]
    v_pk_mul_f32 v[42:43], v[42:43], v[62:63] op_sel:[0,1] op_sel_hi:[1,1]
    v_pk_mul_f32 v[44:45], v[44:45], v[62:63] op_sel:[0,1] op_sel_hi:[1,1]
    v_pk_mul_f32 v[46:47], v[46:47], v[62:63] op_sel:[0,1] op_sel_hi:[1,1]
    v_cvt_pk_bf16_f32 v80, v40, v41
    v_cvt_pk_bf16_f32 v81, v42, v43
    v_cvt_pk_bf16_f32 v82, v44, v45
    v_cvt_pk_bf16_f32 v83, v46, v47
    ds_write_b128 v6, v[80:83] offset:4352
att_common:
    s_setprio 0
    s_lshr_b32 s45, s6, 2
    v_lshlrev_b32 v8, 4, v0
    s_lshl_b32 s52, s6, 12
    s_add_u32 s53, s52, s36
    s_add_u32 s53, s53, 0x1e10000
    v_bfe_u32 v2, v0, 4, 1
    v_bfe_u32 v3, v0, 2, 1
    v_cmp_eq_u32 vcc, 0, v3
    v_mov_b32 v140, 0x3f803f80
    v_mov_b32 v141, 0x3f803f80
    v_mov_b32 v142, 0x3f803f80
    v_mov_b32 v143, 0x3f803f80
    v_cndmask_b32 v12, 0, v140, vcc
    v_xor_b32 v14, v12, v140
    v_cndmask_b32 v13, 0, v140, vcc
    v_xor_b32 v15, v13, v140
    v_and_b32 v10, 1, v0
    v_mul_u32_u24 v10, 0xaaaa, v10
    v_add_u32 v10, 0x4444, v10
    v_pk_mul_f32 v[40:41], 0, 0
    v_pk_mul_f32 v[42:43], 0, 0
    v_pk_mul_f32 v[44:45], 0, 0
    v_pk_mul_f32 v[46:47], 0, 0
    v_pk_mul_f32 v[48:49], 0, 0
    v_pk_mul_f32 v[50:51], 0, 0
    v_pk_mul_f32 v[52:53], 0, 0
    v_pk_mul_f32 v[54:55], 0, 0
    v_pk_mul_f32 v[56:57], 0, 0
    v_pk_mul_f32 v[58:59], 0, 0
    v_pk_mul_f32 v[104:105], 0, 0
    v_pk_mul_f32 v[100:101], 0, 0
    v_pk_mul_f32 v[120:121], 0, 0
    v_pk_mul_f32 v[106:107], 0, 0
    v_pk_mul_f32 v[102:103], 0, 0
    v_pk_mul_f32 v[122:123], 0, 0
    v_add_u32 v9, 0x10000, v8
    s_lshl_b32 s41, s7, 12
    s_lshl_b32 s40, s45, 11
    s_add_u32 s41, s41, s40
    s_add_u32 s41, s41, 98304
    v_add_u32 v6, s41, v8
    s_cmp_eq_u32 s45, 0
    s_cbranch_scc1 att_nowt
    s_waitcnt vmcnt(8)
att_nowt:
    s_waitcnt lgkmcnt(0)
    s_barrier
    ds_read_b128 v[108:111], v8 offset:0
    ds_read_b128 v[16:19], v6
    ds_read_b128 v[112:115], v8 offset:1024
    ds_read_b128 v[20:23], v6 offset:1024
    s_waitcnt lgkmcnt(2)
    v_mfma_f32_32x32x16_bf16 v[60:75], v[108:111], v[16:19], 0
    s_waitcnt lgkmcnt(0)
    v_mfma_f32_32x32x16_bf16 v[60:75], v[112:115], v[20:23], v[60:75]
    ds_read_b128 v[108:111], v8 offset:4096
    ds_read_b128 v[112:115], v8 offset:5120
    ds_read_b128 v[116:119], v8 offset:2048
    s_nop 8
    v_max3_f32 v2, v60, v61, v62
    v_max_f32 v2, v2, v63
    v_max3_f32 v2, v2, v64, v65
    v_max3_f32 v2, v2, v66, v67
    v_max3_f32 v2, v2, v68, v69
    v_max3_f32 v2, v2, v70, v71
    v_max3_f32 v2, v2, v72, v73
    v_max3_f32 v2, v2, v74, v75
    v_mov_b32 v3, v2
    s_nop 1
    v_permlane32_swap_b32 v2, v3
    s_nop 1
    v_max_f32 v2, v2, v3
    v_pk_mul_f32 v[24:25], v[2:3], -1.0 op_sel:[0,0] op_sel_hi:[0,0]
    v_pk_mul_f32 v[26:27], v[2:3], -1.0 op_sel:[0,0] op_sel_hi:[0,0]
    v_pk_mul_f32 v[28:29], v[2:3], -1.0 op_sel:[0,0] op_sel_hi:[0,0]
    v_pk_mul_f32 v[30:31], v[2:3], -1.0 op_sel:[0,0] op_sel_hi:[0,0]
    v_pk_mul_f32 v[32:33], v[2:3], -1.0 op_sel:[0,0] op_sel_hi:[0,0]
    v_pk_mul_f32 v[34:35], v[2:3], -1.0 op_sel:[0,0] op_sel_hi:[0,0]
    v_pk_mul_f32 v[36:37], v[2:3], -1.0 op_sel:[0,0] op_sel_hi:[0,0]
    v_pk_mul_f32 v[38:39], v[2:3], -1.0 op_sel:[0,0] op_sel_hi:[0,0]
    v_pk_add_f32 v[60:61], v[60:61], v[24:25]
    v_pk_add_f32 v[62:63], v[62:63], v[24:25]
    v_pk_add_f32 v[64:65], v[64:65], v[24:25]
    v_pk_add_f32 v[66:67], v[66:67], v[24:25]
    v_pk_add_f32 v[68:69], v[68:69], v[24:25]
    v_pk_add_f32 v[70:71], v[70:71], v[24:25]
    v_pk_add_f32 v[72:73], v[72:73], v[24:25]
    v_pk_add_f32 v[74:75], v[74:75], v[24:25]
    s_setprio 3
    s_waitcnt lgkmcnt(2)
    v_cmp_eq_u32 vcc, s3, v56
    s_cmp_lg_u32 s3, 0
    s_cbranch_scc1 att_steps0
    v_exp_f32 v60, v60
    v_exp_f32 v61, v61
    v_mfma_f32_32x32x16_bf16 v[40:55], v[120:123], v[104:107], v[40:55]
    ds_read_b128 v[120:123], v8 offset:3072
    v_exp_f32 v62, v62
    v_exp_f32 v63, v63
    v_exp_f32 v64, v64
    v_mfma_f32_32x32x16_bf16 v[76:91], v[108:111], v[16:19], v[24:39]
    ds_read_b128 v[108:111], v8 offset:8192
    s_add_u32 m0, s52, 65536
    v_cvt_pk_bf16_f32 v92, v60, v61
    v_exp_f32 v65, v65
    v_cvt_pk_bf16_f32 v93, v62, v63
    v_exp_f32 v66, v66
    v_smfmac_f32_16x16x64_bf16 v[56:59], v[12:15], v[100:107], v10
    s_waitcnt lgkmcnt(2)
    buffer_load_dwordx4 v8, s[8:11], s53 offen offset:1024 sc1 lds
    v_exp_f32 v67, v67
    v_cvt_pk_bf16_f32 v94, v64, v65
    v_exp_f32 v68, v68
    v_mfma_f32_32x32x16_bf16 v[76:91], v[112:115], v[20:23], v[76:91]
    ds_read_b128 v[112:115], v8 offset:9216
    v_cvt_pk_bf16_f32 v95, v66, v67
    v_exp_f32 v69, v69
    v_exp_f32 v70, v70
    v_exp_f32 v71, v71
    v_mfma_f32_32x32x16_bf16 v[40:55], v[116:119], v[92:95], v[40:55]
    s_waitcnt lgkmcnt(1)
    ds_read_b128 v[116:119], v8 offset:6144
    v_cvt_pk_bf16_f32 v96, v68, v69
    v_exp_f32 v72, v72
    v_exp_f32 v73, v73
    v_cvt_pk_bf16_f32 v97, v70, v71
    v_exp_f32 v74, v74
    v_exp_f32 v75, v75
    v_cvt_pk_bf16_f32 v98, v72, v73
    v_cvt_pk_bf16_f32 v99, v74, v75
    v_exp_f32 v76, v76
    v_exp_f32 v77, v77
    v_mfma_f32_32x32x16_bf16 v[40:55], v[120:123], v[96:99], v[40:55]
    ds_read_b128 v[120:123], v8 offset:7168
    v_exp_f32 v78, v78
    v_exp_f32 v79, v79
    v_exp_f32 v80, v80
    v_mfma_f32_32x32x16_bf16 v[60:75], v[108:111], v[16:19], v[24:39]
    ds_read_b128 v[108:111], v8 offset:12288
    v_cvt_pk_bf16_f32 v100, v76, v77
    v_exp_f32 v81, v81
    v_cvt_pk_bf16_f32 v101, v78, v79
    v_exp_f32 v82, v82
    v_smfmac_f32_16x16x64_bf16 v[56:59], v[12:15], v[92:99], v10
    s_waitcnt lgkmcnt(2)
    buffer_load_dwordx4 v8, s[8:11], s53 offen offset:0 sc1 lds
    v_exp_f32 v83, v83
    v_cvt_pk_bf16_f32 v102, v80, v81
    v_exp_f32 v84, v84
    v_mfma_f32_32x32x16_bf16 v[60:75], v[112:115], v[20:23], v[60:75]
    ds_read_b128 v[112:115], v8 offset:13312
    v_cvt_pk_bf16_f32 v103, v82, v83
    v_exp_f32 v85, v85
    v_exp_f32 v86, v86
    v_exp_f32 v87, v87
    v_mfma_f32_32x32x16_bf16 v[40:55], v[116:119], v[100:103], v[40:55]
    s_waitcnt lgkmcnt(1)
    ds_read_b128 v[116:119], v8 offset:10240
    v_cvt_pk_bf16_f32 v104, v84, v85
    v_exp_f32 v88, v88
    v_exp_f32 v89, v89
    v_cvt_pk_bf16_f32 v105, v86, v87
    s_mov_b32 m0, s69
    s_nop 0
    buffer_load_dwordx4 v192, s[28:31], s61 offen offset:0 lds
    s_add_u32 s61, s61, s68
    s_add_u32 m0, s52, 65536
    v_exp_f32 v90, v90
    v_exp_f32 v91, v91
    v_cvt_pk_bf16_f32 v106, v88, v89
    v_cvt_pk_bf16_f32 v107, v90, v91
    v_exp_f32 v60, v60
    v_exp_f32 v61, v61
    v_mfma_f32_32x32x16_bf16 v[40:55], v[120:123], v[104:107], v[40:55]
    ds_read_b128 v[120:123], v8 offset:11264
    v_exp_f32 v62, v62
    v_exp_f32 v63, v63
    v_exp_f32 v64, v64
    v_mfma_f32_32x32x16_bf16 v[76:91], v[108:111], v[16:19], v[24:39]
    ds_read_b128 v[108:111], v8 offset:16384
    v_cvt_pk_bf16_f32 v92, v60, v61
    v_exp_f32 v65, v65
    v_cvt_pk_bf16_f32 v93, v62, v63
    v_exp_f32 v66, v66
    v_smfmac_f32_16x16x64_bf16 v[56:59], v[12:15], v[100:107], v10
    s_waitcnt lgkmcnt(2)
    buffer_load_dwordx4 v8, s[8:11], s53 offen offset:2048 sc1 lds
    v_exp_f32 v67, v67
    v_cvt_pk_bf16_f32 v94, v64, v65
    v_exp_f32 v68, v68
    v_mfma_f32_32x32x16_bf16 v[76:91], v[112:115], v[20:23], v[76:91]
    ds_read_b128 v[112:115], v8 offset:17408
    v_cvt_pk_bf16_f32 v95, v66, v67
    v_exp_f32 v69, v69
    v_exp_f32 v70, v70
    v_exp_f32 v71, v71
    v_mfma_f32_32x32x16_bf16 v[40:55], v[116:119], v[92:95], v[40:55]
    s_waitcnt lgkmcnt(1)
    ds_read_b128 v[116:119], v8 offset:14336
    v_cvt_pk_bf16_f32 v96, v68, v69
    v_exp_f32 v72, v72
    v_exp_f32 v73, v73
    v_cvt_pk_bf16_f32 v97, v70, v71
    v_exp_f32 v74, v74
    v_exp_f32 v75, v75
    v_cvt_pk_bf16_f32 v98, v72, v73
    v_cvt_pk_bf16_f32 v99, v74, v75
    s_setprio 2
    v_exp_f32 v76, v76
    v_exp_f32 v77, v77
    v_mfma_f32_32x32x16_bf16 v[40:55], v[120:123], v[96:99], v[40:55]
    ds_read_b128 v[120:123], v8 offset:15360
    v_exp_f32 v78, v78
    v_exp_f32 v79, v79
    v_exp_f32 v80, v80
    v_mfma_f32_32x32x16_bf16 v[60:75], v[108:111], v[16:19], v[24:39]
    ds_read_b128 v[108:111], v8 offset:20480
    v_cvt_pk_bf16_f32 v100, v76, v77
    v_exp_f32 v81, v81
    v_cvt_pk_bf16_f32 v101, v78, v79
    v_exp_f32 v82, v82
    v_smfmac_f32_16x16x64_bf16 v[56:59], v[12:15], v[92:99], v10
    s_waitcnt lgkmcnt(2)
    s_waitcnt vmcnt(4)
    v_exp_f32 v83, v83
    v_cvt_pk_bf16_f32 v102, v80, v81
    v_exp_f32 v84, v84
    v_mfma_f32_32x32x16_bf16 v[60:75], v[112:115], v[20:23], v[60:75]
    ds_read_b128 v[112:115], v8 offset:21504
    v_cvt_pk_bf16_f32 v103, v82, v83
    v_exp_f32 v85, v85
    v_exp_f32 v86, v86
    v_exp_f32 v87, v87
    v_mfma_f32_32x32x16_bf16 v[40:55], v[116:119], v[100:103], v[40:55]
    s_waitcnt lgkmcnt(1)
    ds_read_b128 v[116:119], v8 offset:18432
    v_cvt_pk_bf16_f32 v104, v84, v85
    v_exp_f32 v88, v88
    v_exp_f32 v89, v89
    v_cvt_pk_bf16_f32 v105, v86, v87
    s_mov_b32 m0, s69
    s_nop 0
    buffer_load_dwordx4 v192, s[28:31], s61 offen offset:1024 lds
    s_add_u32 s61, s61, s68
    s_add_u32 m0, s52, 65536
    v_exp_f32 v90, v90
    v_exp_f32 v91, v91
    v_cvt_pk_bf16_f32 v106, v88, v89
    v_cvt_pk_bf16_f32 v107, v90, v91
    s_setprio 1
    v_exp_f32 v60, v60
    v_exp_f32 v61, v61
    v_mfma_f32_32x32x16_bf16 v[40:55], v[120:123], v[104:107], v[40:55]
    ds_read_b128 v[120:123], v8 offset:19456
    v_exp_f32 v62, v62
    v_exp_f32 v63, v63
    v_exp_f32 v64, v64
    v_mfma_f32_32x32x16_bf16 v[76:91], v[108:111], v[16:19], v[24:39]
    ds_read_b128 v[108:111], v8 offset:24576
    v_cvt_pk_bf16_f32 v92, v60, v61
    v_exp_f32 v65, v65
    v_cvt_pk_bf16_f32 v93, v62, v63
    v_exp_f32 v66, v66
    v_smfmac_f32_16x16x64_bf16 v[56:59], v[12:15], v[100:107], v10
    s_waitcnt lgkmcnt(2)
    buffer_load_dwordx4 v8, s[8:11], s53 offen offset:3072 sc1 lds
    v_exp_f32 v67, v67
    v_cvt_pk_bf16_f32 v94, v64, v65
    v_exp_f32 v68, v68
    v_mfma_f32_32x32x16_bf16 v[76:91], v[112:115], v[20:23], v[76:91]
    ds_read_b128 v[112:115], v8 offset:25600
    v_cvt_pk_bf16_f32 v95, v66, v67
    v_exp_f32 v69, v69
    v_exp_f32 v70, v70
    v_exp_f32 v71, v71
    v_mfma_f32_32x32x16_bf16 v[40:55], v[116:119], v[92:95], v[40:55]
    s_waitcnt lgkmcnt(1)
    ds_read_b128 v[116:119], v8 offset:22528
    v_cvt_pk_bf16_f32 v96, v68, v69
    v_exp_f32 v72, v72
    v_exp_f32 v73, v73
    v_cvt_pk_bf16_f32 v97, v70, v71
    v_exp_f32 v74, v74
    v_exp_f32 v75, v75
    v_cvt_pk_bf16_f32 v98, v72, v73
    v_cvt_pk_bf16_f32 v99, v74, v75
    s_setprio 0
    v_exp_f32 v76, v76
    v_exp_f32 v77, v77
    v_mfma_f32_32x32x16_bf16 v[40:55], v[120:123], v[96:99], v[40:55]
    ds_read_b128 v[120:123], v8 offset:23552
    v_exp_f32 v78, v78
    v_exp_f32 v79, v79
    v_exp_f32 v80, v80
    v_mfma_f32_32x32x16_bf16 v[60:75], v[108:111], v[16:19], v[24:39]
    ds_read_b128 v[108:111], v8 offset:28672
    v_cvt_pk_bf16_f32 v100, v76, v77
    v_exp_f32 v81, v81
    v_cvt_pk_bf16_f32 v101, v78, v79
    v_exp_f32 v82, v82
    v_smfmac_f32_16x16x64_bf16 v[56:59], v[12:15], v[92:99], v10
    s_waitcnt lgkmcnt(2)
    v_exp_f32 v83, v83
    v_cvt_pk_bf16_f32 v102, v80, v81
    v_exp_f32 v84, v84
    v_mfma_f32_32x32x16_bf16 v[60:75], v[112:115], v[20:23], v[60:75]
    ds_read_b128 v[112:115], v8 offset:29696
    v_cvt_pk_bf16_f32 v103, v82, v83
    v_exp_f32 v85, v85
    v_exp_f32 v86, v86
    v_exp_f32 v87, v87
    v_mfma_f32_32x32x16_bf16 v[40:55], v[116:119], v[100:103], v[40:55]
    s_waitcnt lgkmcnt(1)
    ds_read_b128 v[116:119], v8 offset:26624
    v_cvt_pk_bf16_f32 v104, v84, v85
    v_exp_f32 v88, v88
    v_exp_f32 v89, v89
    v_cvt_pk_bf16_f32 v105, v86, v87
    s_mov_b32 m0, s69
    s_nop 0
    buffer_load_dwordx4 v192, s[28:31], s61 offen offset:2048 lds
    s_add_u32 s61, s61, s68
    s_add_u32 m0, s52, 65536
    v_exp_f32 v90, v90
    v_exp_f32 v91, v91
    v_cvt_pk_bf16_f32 v106, v88, v89
    v_cvt_pk_bf16_f32 v107, v90, v91
    v_exp_f32 v60, v60
    v_exp_f32 v61, v61
    v_mfma_f32_32x32x16_bf16 v[40:55], v[120:123], v[104:107], v[40:55]
    ds_read_b128 v[120:123], v8 offset:27648
    s_barrier
    s_setprio 3
    v_exp_f32 v62, v62
    v_exp_f32 v63, v63
    v_exp_f32 v64, v64
    v_mfma_f32_32x32x16_bf16 v[76:91], v[108:111], v[16:19], v[24:39]
    ds_read_b128 v[108:111], v8 offset:32768
    s_add_u32 s53, s53, 32768
    s_add_u32 m0, s52, 98304
    v_cvt_pk_bf16_f32 v92, v60, v61
    v_exp_f32 v65, v65
    v_cvt_pk_bf16_f32 v93, v62, v63
    v_exp_f32 v66, v66
    v_smfmac_f32_16x16x64_bf16 v[56:59], v[12:15], v[100:107], v10
    s_waitcnt lgkmcnt(2)
    buffer_load_dwordx4 v8, s[8:11], s53 offen offset:0 sc1 lds
    v_exp_f32 v67, v67
    v_cvt_pk_bf16_f32 v94, v64, v65
    v_exp_f32 v68, v68
    v_mfma_f32_32x32x16_bf16 v[76:91], v[112:115], v[20:23], v[76:91]
    ds_read_b128 v[112:115], v8 offset:33792
    v_cvt_pk_bf16_f32 v95, v66, v67
    v_exp_f32 v69, v69
    v_exp_f32 v70, v70
    v_exp_f32 v71, v71
    v_mfma_f32_32x32x16_bf16 v[40:55], v[116:119], v[92:95], v[40:55]
    s_waitcnt lgkmcnt(1)
    ds_read_b128 v[116:119], v8 offset:30720
    v_cvt_pk_bf16_f32 v96, v68, v69
    v_exp_f32 v72, v72
    v_exp_f32 v73, v73
    v_cvt_pk_bf16_f32 v97, v70, v71
    v_exp_f32 v74, v74
    v_exp_f32 v75, v75
    v_cvt_pk_bf16_f32 v98, v72, v73
    v_cvt_pk_bf16_f32 v99, v74, v75
    v_exp_f32 v76, v76
    v_exp_f32 v77, v77
    v_mfma_f32_32x32x16_bf16 v[40:55], v[120:123], v[96:99], v[40:55]
    ds_read_b128 v[120:123], v8 offset:31744
    v_exp_f32 v78, v78
    v_exp_f32 v79, v79
    v_exp_f32 v80, v80
    v_mfma_f32_32x32x16_bf16 v[60:75], v[108:111], v[16:19], v[24:39]
    ds_read_b128 v[108:111], v8 offset:36864
    v_cvt_pk_bf16_f32 v100, v76, v77
    v_exp_f32 v81, v81
    v_cvt_pk_bf16_f32 v101, v78, v79
    v_exp_f32 v82, v82
    v_smfmac_f32_16x16x64_bf16 v[56:59], v[12:15], v[92:99], v10
    s_waitcnt lgkmcnt(2)
    v_exp_f32 v83, v83
    v_cvt_pk_bf16_f32 v102, v80, v81
    v_exp_f32 v84, v84
    v_mfma_f32_32x32x16_bf16 v[60:75], v[112:115], v[20:23], v[60:75]
    ds_read_b128 v[112:115], v8 offset:37888
    v_cvt_pk_bf16_f32 v103, v82, v83
    v_exp_f32 v85, v85
    v_exp_f32 v86, v86
    v_exp_f32 v87, v87
    v_mfma_f32_32x32x16_bf16 v[40:55], v[116:119], v[100:103], v[40:55]
    s_waitcnt lgkmcnt(1)
    ds_read_b128 v[116:119], v8 offset:34816
    v_cvt_pk_bf16_f32 v104, v84, v85
    v_exp_f32 v88, v88
    v_exp_f32 v89, v89
    v_cvt_pk_bf16_f32 v105, v86, v87
    s_mov_b32 m0, s69
    s_nop 0
    buffer_load_dwordx4 v192, s[28:31], s61 offen offset:3072 lds
    s_add_u32 s61, s61, s68
    s_add_u32 m0, s52, 98304
    s_mov_b32 s61, s56
    s_cmp_lt_u32 s37, 112
    s_cselect_b32 s28, s76, s78
    s_cselect_b32 s29, s77, s79
    s_mov_b32 s30, 7340032
    v_exp_f32 v90, v90
    v_exp_f32 v91, v91
    v_cvt_pk_bf16_f32 v106, v88, v89
    v_cvt_pk_bf16_f32 v107, v90, v91
    v_exp_f32 v60, v60
    v_exp_f32 v61, v61
    v_mfma_f32_32x32x16_bf16 v[40:55], v[120:123], v[104:107], v[40:55]
    ds_read_b128 v[120:123], v8 offset:35840
    v_exp_f32 v62, v62
    v_exp_f32 v63, v63
    v_exp_f32 v64, v64
    v_mfma_f32_32x32x16_bf16 v[76:91], v[108:111], v[16:19], v[24:39]
    ds_read_b128 v[108:111], v8 offset:40960
    v_cvt_pk_bf16_f32 v92, v60, v61
    v_exp_f32 v65, v65
    v_cvt_pk_bf16_f32 v93, v62, v63
    v_exp_f32 v66, v66
    v_smfmac_f32_16x16x64_bf16 v[56:59], v[12:15], v[100:107], v10
    s_waitcnt lgkmcnt(2)
    buffer_load_dwordx4 v8, s[8:11], s53 offen offset:1024 sc1 lds
    v_exp_f32 v67, v67
    v_cvt_pk_bf16_f32 v94, v64, v65
    v_exp_f32 v68, v68
    v_mfma_f32_32x32x16_bf16 v[76:91], v[112:115], v[20:23], v[76:91]
    ds_read_b128 v[112:115], v8 offset:41984
    v_cvt_pk_bf16_f32 v95, v66, v67
    v_exp_f32 v69, v69
    v_exp_f32 v70, v70
    v_exp_f32 v71, v71
    v_mfma_f32_32x32x16_bf16 v[40:55], v[116:119], v[92:95], v[40:55]
    s_waitcnt lgkmcnt(1)
    ds_read_b128 v[116:119], v8 offset:38912
    v_cvt_pk_bf16_f32 v96, v68, v69
    v_exp_f32 v72, v72
    v_exp_f32 v73, v73
    v_cvt_pk_bf16_f32 v97, v70, v71
    v_exp_f32 v74, v74
    v_exp_f32 v75, v75
    v_cvt_pk_bf16_f32 v98, v72, v73
    v_cvt_pk_bf16_f32 v99, v74, v75
    v_exp_f32 v76, v76
    v_exp_f32 v77, v77
    v_mfma_f32_32x32x16_bf16 v[40:55], v[120:123], v[96:99], v[40:55]
    ds_read_b128 v[120:123], v8 offset:39936
    v_exp_f32 v78, v78
    v_exp_f32 v79, v79
    v_exp_f32 v80, v80
    v_mfma_f32_32x32x16_bf16 v[60:75], v[108:111], v[16:19], v[24:39]
    ds_read_b128 v[108:111], v8 offset:45056
    v_cvt_pk_bf16_f32 v100, v76, v77
    v_exp_f32 v81, v81
    v_cvt_pk_bf16_f32 v101, v78, v79
    v_exp_f32 v82, v82
    v_smfmac_f32_16x16x64_bf16 v[56:59], v[12:15], v[92:99], v10
    s_waitcnt lgkmcnt(2)
    v_exp_f32 v83, v83
    v_cvt_pk_bf16_f32 v102, v80, v81
    v_exp_f32 v84, v84
    v_mfma_f32_32x32x16_bf16 v[60:75], v[112:115], v[20:23], v[60:75]
    ds_read_b128 v[112:115], v8 offset:46080
    v_cvt_pk_bf16_f32 v103, v82, v83
    v_exp_f32 v85, v85
    v_exp_f32 v86, v86
    v_exp_f32 v87, v87
    v_mfma_f32_32x32x16_bf16 v[40:55], v[116:119], v[100:103], v[40:55]
    s_waitcnt lgkmcnt(1)
    ds_read_b128 v[116:119], v8 offset:43008
    v_cvt_pk_bf16_f32 v104, v84, v85
    v_exp_f32 v88, v88
    v_exp_f32 v89, v89
    v_cvt_pk_bf16_f32 v105, v86, v87
    v_exp_f32 v90, v90
    v_exp_f32 v91, v91
    v_cvt_pk_bf16_f32 v106, v88, v89
    v_cvt_pk_bf16_f32 v107, v90, v91
    v_exp_f32 v60, v60
    v_exp_f32 v61, v61
    v_mfma_f32_32x32x16_bf16 v[40:55], v[120:123], v[104:107], v[40:55]
    ds_read_b128 v[120:123], v8 offset:44032
    v_exp_f32 v62, v62
    v_exp_f32 v63, v63
    v_exp_f32 v64, v64
    v_mfma_f32_32x32x16_bf16 v[76:91], v[108:111], v[16:19], v[24:39]
    ds_read_b128 v[108:111], v8 offset:49152
    v_cvt_pk_bf16_f32 v92, v60, v61
    v_exp_f32 v65, v65
    v_cvt_pk_bf16_f32 v93, v62, v63
    v_exp_f32 v66, v66
    v_smfmac_f32_16x16x64_bf16 v[56:59], v[12:15], v[100:107], v10
    s_waitcnt lgkmcnt(2)
    buffer_load_dwordx4 v8, s[8:11], s53 offen offset:2048 sc1 lds
    v_exp_f32 v67, v67
    v_cvt_pk_bf16_f32 v94, v64, v65
    v_exp_f32 v68, v68
    v_mfma_f32_32x32x16_bf16 v[76:91], v[112:115], v[20:23], v[76:91]
    ds_read_b128 v[112:115], v8 offset:50176
    v_cvt_pk_bf16_f32 v95, v66, v67
    v_exp_f32 v69, v69
    v_exp_f32 v70, v70
    v_exp_f32 v71, v71
    v_mfma_f32_32x32x16_bf16 v[40:55], v[116:119], v[92:95], v[40:55]
    s_waitcnt lgkmcnt(1)
    ds_read_b128 v[116:119], v8 offset:47104
    v_cvt_pk_bf16_f32 v96, v68, v69
    v_exp_f32 v72, v72
    v_exp_f32 v73, v73
    v_cvt_pk_bf16_f32 v97, v70, v71
    v_exp_f32 v74, v74
    v_exp_f32 v75, v75
    v_cvt_pk_bf16_f32 v98, v72, v73
    v_cvt_pk_bf16_f32 v99, v74, v75
    s_setprio 2
    v_exp_f32 v76, v76
    v_exp_f32 v77, v77
    v_mfma_f32_32x32x16_bf16 v[40:55], v[120:123], v[96:99], v[40:55]
    ds_read_b128 v[120:123], v8 offset:48128
    v_exp_f32 v78, v78
    v_exp_f32 v79, v79
    v_exp_f32 v80, v80
    v_mfma_f32_32x32x16_bf16 v[60:75], v[108:111], v[16:19], v[24:39]
    ds_read_b128 v[108:111], v8 offset:53248
    v_cvt_pk_bf16_f32 v100, v76, v77
    v_exp_f32 v81, v81
    v_cvt_pk_bf16_f32 v101, v78, v79
    v_exp_f32 v82, v82
    v_smfmac_f32_16x16x64_bf16 v[56:59], v[12:15], v[92:99], v10
    s_waitcnt lgkmcnt(2)
    s_waitcnt vmcnt(5)
    v_exp_f32 v83, v83
    v_cvt_pk_bf16_f32 v102, v80, v81
    v_exp_f32 v84, v84
    v_mfma_f32_32x32x16_bf16 v[60:75], v[112:115], v[20:23], v[60:75]
    ds_read_b128 v[112:115], v8 offset:54272
    v_cvt_pk_bf16_f32 v103, v82, v83
    v_exp_f32 v85, v85
    v_exp_f32 v86, v86
    v_exp_f32 v87, v87
    v_mfma_f32_32x32x16_bf16 v[40:55], v[116:119], v[100:103], v[40:55]
    s_waitcnt lgkmcnt(1)
    ds_read_b128 v[116:119], v8 offset:51200
    v_cvt_pk_bf16_f32 v104, v84, v85
    v_exp_f32 v88, v88
    v_exp_f32 v89, v89
    v_cvt_pk_bf16_f32 v105, v86, v87
    v_exp_f32 v90, v90
    v_exp_f32 v91, v91
    v_cvt_pk_bf16_f32 v106, v88, v89
    v_cvt_pk_bf16_f32 v107, v90, v91
    s_setprio 1
    v_exp_f32 v60, v60
    v_exp_f32 v61, v61
    v_mfma_f32_32x32x16_bf16 v[40:55], v[120:123], v[104:107], v[40:55]
    ds_read_b128 v[120:123], v8 offset:52224
    v_exp_f32 v62, v62
    v_exp_f32 v63, v63
    v_exp_f32 v64, v64
    v_mfma_f32_32x32x16_bf16 v[76:91], v[108:111], v[16:19], v[24:39]
    ds_read_b128 v[108:111], v8 offset:57344
    v_cvt_pk_bf16_f32 v92, v60, v61
    v_exp_f32 v65, v65
    v_cvt_pk_bf16_f32 v93, v62, v63
    v_exp_f32 v66, v66
    v_smfmac_f32_16x16x64_bf16 v[56:59], v[12:15], v[100:107], v10
    s_waitcnt lgkmcnt(2)
    buffer_load_dwordx4 v8, s[8:11], s53 offen offset:3072 sc1 lds
    v_exp_f32 v67, v67
    v_cvt_pk_bf16_f32 v94, v64, v65
    v_exp_f32 v68, v68
    v_mfma_f32_32x32x16_bf16 v[76:91], v[112:115], v[20:23], v[76:91]
    ds_read_b128 v[112:115], v8 offset:58368
    v_cvt_pk_bf16_f32 v95, v66, v67
    v_exp_f32 v69, v69
    v_exp_f32 v70, v70
    v_exp_f32 v71, v71
    v_mfma_f32_32x32x16_bf16 v[40:55], v[116:119], v[92:95], v[40:55]
    s_waitcnt lgkmcnt(1)
    ds_read_b128 v[116:119], v8 offset:55296
    v_cvt_pk_bf16_f32 v96, v68, v69
    v_exp_f32 v72, v72
    v_exp_f32 v73, v73
    v_cvt_pk_bf16_f32 v97, v70, v71
    v_exp_f32 v74, v74
    v_exp_f32 v75, v75
    v_cvt_pk_bf16_f32 v98, v72, v73
    v_cvt_pk_bf16_f32 v99, v74, v75
    s_setprio 0
    v_exp_f32 v76, v76
    v_exp_f32 v77, v77
    v_mfma_f32_32x32x16_bf16 v[40:55], v[120:123], v[96:99], v[40:55]
    ds_read_b128 v[120:123], v8 offset:56320
    v_exp_f32 v78, v78
    v_exp_f32 v79, v79
    v_exp_f32 v80, v80
    v_mfma_f32_32x32x16_bf16 v[60:75], v[108:111], v[16:19], v[24:39]
    ds_read_b128 v[108:111], v8 offset:61440
    v_cvt_pk_bf16_f32 v100, v76, v77
    v_exp_f32 v81, v81
    v_cvt_pk_bf16_f32 v101, v78, v79
    v_exp_f32 v82, v82
    v_smfmac_f32_16x16x64_bf16 v[56:59], v[12:15], v[92:99], v10
    s_waitcnt lgkmcnt(2)
    v_exp_f32 v83, v83
    v_cvt_pk_bf16_f32 v102, v80, v81
    v_exp_f32 v84, v84
    v_mfma_f32_32x32x16_bf16 v[60:75], v[112:115], v[20:23], v[60:75]
    ds_read_b128 v[112:115], v8 offset:62464
    v_cvt_pk_bf16_f32 v103, v82, v83
    v_exp_f32 v85, v85
    v_exp_f32 v86, v86
    v_exp_f32 v87, v87
    v_mfma_f32_32x32x16_bf16 v[40:55], v[116:119], v[100:103], v[40:55]
    s_waitcnt lgkmcnt(1)
    ds_read_b128 v[116:119], v8 offset:59392
    v_cvt_pk_bf16_f32 v104, v84, v85
    v_exp_f32 v88, v88
    v_exp_f32 v89, v89
    v_cvt_pk_bf16_f32 v105, v86, v87
    v_exp_f32 v90, v90
    v_exp_f32 v91, v91
    v_cvt_pk_bf16_f32 v106, v88, v89
    v_cvt_pk_bf16_f32 v107, v90, v91
    v_exp_f32 v60, v60
    v_exp_f32 v61, v61
    v_mfma_f32_32x32x16_bf16 v[40:55], v[120:123], v[104:107], v[40:55]
    ds_read_b128 v[120:123], v8 offset:60416
    s_barrier
    s_setprio 3
    v_exp_f32 v62, v62
    v_exp_f32 v63, v63
    v_exp_f32 v64, v64
    v_mfma_f32_32x32x16_bf16 v[76:91], v[108:111], v[16:19], v[24:39]
    ds_read_b128 v[108:111], v9 offset:0
    s_add_u32 s53, s53, 32768
    s_add_u32 m0, s52, 0
    v_cvt_pk_bf16_f32 v92, v60, v61
    v_exp_f32 v65, v65
    v_cvt_pk_bf16_f32 v93, v62, v63
    v_exp_f32 v66, v66
    v_smfmac_f32_16x16x64_bf16 v[56:59], v[12:15], v[100:107], v10
    s_waitcnt lgkmcnt(2)
    buffer_load_dwordx4 v8, s[8:11], s53 offen offset:0 sc1 lds
    v_exp_f32 v67, v67
    v_cvt_pk_bf16_f32 v94, v64, v65
    v_exp_f32 v68, v68
    v_mfma_f32_32x32x16_bf16 v[76:91], v[112:115], v[20:23], v[76:91]
    ds_read_b128 v[112:115], v9 offset:1024
    v_cvt_pk_bf16_f32 v95, v66, v67
    v_exp_f32 v69, v69
    v_exp_f32 v70, v70
    v_exp_f32 v71, v71
    v_mfma_f32_32x32x16_bf16 v[40:55], v[116:119], v[92:95], v[40:55]
    s_waitcnt lgkmcnt(1)
    ds_read_b128 v[116:119], v8 offset:63488
    v_cvt_pk_bf16_f32 v96, v68, v69
    v_exp_f32 v72, v72
    v_exp_f32 v73, v73
    v_cvt_pk_bf16_f32 v97, v70, v71
    v_exp_f32 v74, v74
    v_exp_f32 v75, v75
    v_cvt_pk_bf16_f32 v98, v72, v73
    v_cvt_pk_bf16_f32 v99, v74, v75
    v_exp_f32 v76, v76
    v_exp_f32 v77, v77
    v_mfma_f32_32x32x16_bf16 v[40:55], v[120:123], v[96:99], v[40:55]
    ds_read_b128 v[120:123], v8 offset:64512
    v_exp_f32 v78, v78
    v_exp_f32 v79, v79
    v_exp_f32 v80, v80
    v_mfma_f32_32x32x16_bf16 v[60:75], v[108:111], v[16:19], v[24:39]
    ds_read_b128 v[108:111], v9 offset:4096
    v_cvt_pk_bf16_f32 v100, v76, v77
    v_exp_f32 v81, v81
    v_cvt_pk_bf16_f32 v101, v78, v79
    v_exp_f32 v82, v82
    v_smfmac_f32_16x16x64_bf16 v[56:59], v[12:15], v[92:99], v10
    s_waitcnt lgkmcnt(2)
    v_exp_f32 v83, v83
    v_cvt_pk_bf16_f32 v102, v80, v81
    v_exp_f32 v84, v84
    v_mfma_f32_32x32x16_bf16 v[60:75], v[112:115], v[20:23], v[60:75]
    ds_read_b128 v[112:115], v9 offset:5120
    v_cvt_pk_bf16_f32 v103, v82, v83
    v_exp_f32 v85, v85
    v_exp_f32 v86, v86
    v_exp_f32 v87, v87
    v_mfma_f32_32x32x16_bf16 v[40:55], v[116:119], v[100:103], v[40:55]
    s_waitcnt lgkmcnt(1)
    ds_read_b128 v[116:119], v9 offset:2048
    v_cvt_pk_bf16_f32 v104, v84, v85
    v_exp_f32 v88, v88
    v_exp_f32 v89, v89
    v_cvt_pk_bf16_f32 v105, v86, v87
    v_exp_f32 v90, v90
    v_exp_f32 v91, v91
    v_cvt_pk_bf16_f32 v106, v88, v89
    v_cvt_pk_bf16_f32 v107, v90, v91
    v_exp_f32 v60, v60
    v_exp_f32 v61, v61
    v_mfma_f32_32x32x16_bf16 v[40:55], v[120:123], v[104:107], v[40:55]
    ds_read_b128 v[120:123], v9 offset:3072
    v_exp_f32 v62, v62
    v_exp_f32 v63, v63
    v_exp_f32 v64, v64
    v_mfma_f32_32x32x16_bf16 v[76:91], v[108:111], v[16:19], v[24:39]
    ds_read_b128 v[108:111], v9 offset:8192
    v_cvt_pk_bf16_f32 v92, v60, v61
    v_exp_f32 v65, v65
    v_cvt_pk_bf16_f32 v93, v62, v63
    v_exp_f32 v66, v66
    v_smfmac_f32_16x16x64_bf16 v[56:59], v[12:15], v[100:107], v10
    s_waitcnt lgkmcnt(2)
    buffer_load_dwordx4 v8, s[8:11], s53 offen offset:1024 sc1 lds
    v_exp_f32 v67, v67
    v_cvt_pk_bf16_f32 v94, v64, v65
    v_exp_f32 v68, v68
    v_mfma_f32_32x32x16_bf16 v[76:91], v[112:115], v[20:23], v[76:91]
    ds_read_b128 v[112:115], v9 offset:9216
    v_cvt_pk_bf16_f32 v95, v66, v67
    v_exp_f32 v69, v69
    v_exp_f32 v70, v70
    v_exp_f32 v71, v71
    v_mfma_f32_32x32x16_bf16 v[40:55], v[116:119], v[92:95], v[40:55]
    s_waitcnt lgkmcnt(1)
    ds_read_b128 v[116:119], v9 offset:6144
    v_cvt_pk_bf16_f32 v96, v68, v69
    v_exp_f32 v72, v72
    v_exp_f32 v73, v73
    v_cvt_pk_bf16_f32 v97, v70, v71
    v_exp_f32 v74, v74
    v_exp_f32 v75, v75
    v_cvt_pk_bf16_f32 v98, v72, v73
    v_cvt_pk_bf16_f32 v99, v74, v75
    v_exp_f32 v76, v76
    v_exp_f32 v77, v77
    v_mfma_f32_32x32x16_bf16 v[40:55], v[120:123], v[96:99], v[40:55]
    s_waitcnt vmcnt(5)
    ds_read_b64_tr_b16 v[124:125], v194 offset:0
    ds_read_b64_tr_b16 v[126:127], v194 offset:2048
    ds_read_b64_tr_b16 v[128:129], v195 offset:0
    ds_read_b64_tr_b16 v[130:131], v195 offset:2048
    ds_read_b64_tr_b16 v[132:133], v196 offset:0
    ds_read_b64_tr_b16 v[134:135], v196 offset:2048
    ds_read_b64_tr_b16 v[136:137], v197 offset:0
    ds_read_b64_tr_b16 v[138:139], v197 offset:2048
    ds_read_b128 v[120:123], v9 offset:7168
    v_exp_f32 v78, v78
    v_exp_f32 v79, v79
    v_exp_f32 v80, v80
    v_mfma_f32_32x32x16_bf16 v[60:75], v[108:111], v[16:19], v[24:39]
    ds_read_b128 v[108:111], v9 offset:12288
    v_cvt_pk_bf16_f32 v100, v76, v77
    v_exp_f32 v81, v81
    v_cvt_pk_bf16_f32 v101, v78, v79
    v_exp_f32 v82, v82
    v_smfmac_f32_16x16x64_bf16 v[56:59], v[12:15], v[92:99], v10
    s_waitcnt lgkmcnt(2)
    v_exp_f32 v83, v83
    v_cvt_pk_bf16_f32 v102, v80, v81
    v_exp_f32 v84, v84
    v_mfma_f32_32x32x16_bf16 v[60:75], v[112:115], v[20:23], v[60:75]
    ds_read_b128 v[112:115], v9 offset:13312
    v_cvt_pk_bf16_f32 v103, v82, v83
    v_exp_f32 v85, v85
    v_exp_f32 v86, v86
    v_exp_f32 v87, v87
    v_mfma_f32_32x32x16_bf16 v[40:55], v[116:119], v[100:103], v[40:55]
    s_waitcnt lgkmcnt(1)
    ds_read_b128 v[116:119], v9 offset:10240
    v_cvt_pk_bf16_f32 v104, v84, v85
    v_exp_f32 v88, v88
    v_exp_f32 v89, v89
    v_cvt_pk_bf16_f32 v105, v86, v87
    buffer_store_dwordx4 v[124:127], v8, s[8:11], s62 offen sc0 sc1
    v_mfma_f32_16x16x32_bf16 v[176:179], v[124:127], v[140:143], v[176:179]
    s_add_u32 s62, s62, s66
    v_exp_f32 v90, v90
    v_exp_f32 v91, v91
    v_cvt_pk_bf16_f32 v106, v88, v89
    v_cvt_pk_bf16_f32 v107, v90, v91
    v_exp_f32 v60, v60
    v_exp_f32 v61, v61
    v_mfma_f32_32x32x16_bf16 v[40:55], v[120:123], v[104:107], v[40:55]
    ds_read_b128 v[120:123], v9 offset:11264
    v_exp_f32 v62, v62
    v_exp_f32 v63, v63
    v_exp_f32 v64, v64
    v_mfma_f32_32x32x16_bf16 v[76:91], v[108:111], v[16:19], v[24:39]
    ds_read_b128 v[108:111], v9 offset:16384
    v_cvt_pk_bf16_f32 v92, v60, v61
    v_exp_f32 v65, v65
    v_cvt_pk_bf16_f32 v93, v62, v63
    v_exp_f32 v66, v66
    v_smfmac_f32_16x16x64_bf16 v[56:59], v[12:15], v[100:107], v10
    s_waitcnt lgkmcnt(2)
    buffer_load_dwordx4 v8, s[8:11], s53 offen offset:2048 sc1 lds
    v_exp_f32 v67, v67
    v_cvt_pk_bf16_f32 v94, v64, v65
    v_exp_f32 v68, v68
    v_mfma_f32_32x32x16_bf16 v[76:91], v[112:115], v[20:23], v[76:91]
    ds_read_b128 v[112:115], v9 offset:17408
    v_cvt_pk_bf16_f32 v95, v66, v67
    v_exp_f32 v69, v69
    v_exp_f32 v70, v70
    v_exp_f32 v71, v71
    v_mfma_f32_32x32x16_bf16 v[40:55], v[116:119], v[92:95], v[40:55]
    s_waitcnt lgkmcnt(1)
    ds_read_b128 v[116:119], v9 offset:14336
    v_cvt_pk_bf16_f32 v96, v68, v69
    v_exp_f32 v72, v72
    v_exp_f32 v73, v73
    v_cvt_pk_bf16_f32 v97, v70, v71
    buffer_store_dwordx4 v[128:131], v8, s[8:11], s63 offen sc0 sc1
    v_mfma_f32_16x16x32_bf16 v[180:183], v[128:131], v[140:143], v[180:183]
    s_add_u32 s63, s63, s66
    v_exp_f32 v74, v74
    v_exp_f32 v75, v75
    v_cvt_pk_bf16_f32 v98, v72, v73
    v_cvt_pk_bf16_f32 v99, v74, v75
    s_setprio 2
    v_exp_f32 v76, v76
    v_exp_f32 v77, v77
    v_mfma_f32_32x32x16_bf16 v[40:55], v[120:123], v[96:99], v[40:55]
    ds_read_b128 v[120:123], v9 offset:15360
    v_exp_f32 v78, v78
    v_exp_f32 v79, v79
    v_exp_f32 v80, v80
    v_mfma_f32_32x32x16_bf16 v[60:75], v[108:111], v[16:19], v[24:39]
    ds_read_b128 v[108:111], v9 offset:20480
    v_cvt_pk_bf16_f32 v100, v76, v77
    v_exp_f32 v81, v81
    v_cvt_pk_bf16_f32 v101, v78, v79
    v_exp_f32 v82, v82
    v_smfmac_f32_16x16x64_bf16 v[56:59], v[12:15], v[92:99], v10
    s_waitcnt lgkmcnt(2)
    s_waitcnt vmcnt(5)
    v_exp_f32 v83, v83
    v_cvt_pk_bf16_f32 v102, v80, v81
    v_exp_f32 v84, v84
    v_mfma_f32_32x32x16_bf16 v[60:75], v[112:115], v[20:23], v[60:75]
    ds_read_b128 v[112:115], v9 offset:21504
    v_cvt_pk_bf16_f32 v103, v82, v83
    v_exp_f32 v85, v85
    v_exp_f32 v86, v86
    v_exp_f32 v87, v87
    v_mfma_f32_32x32x16_bf16 v[40:55], v[116:119], v[100:103], v[40:55]
    s_waitcnt lgkmcnt(1)
    ds_read_b128 v[116:119], v9 offset:18432
    v_cvt_pk_bf16_f32 v104, v84, v85
    v_exp_f32 v88, v88
    v_exp_f32 v89, v89
    v_cvt_pk_bf16_f32 v105, v86, v87
    buffer_store_dwordx4 v[132:135], v8, s[8:11], s64 offen sc0 sc1
    v_mfma_f32_16x16x32_bf16 v[184:187], v[132:135], v[140:143], v[184:187]
    s_add_u32 s64, s64, s66
    v_exp_f32 v90, v90
    v_exp_f32 v91, v91
    v_cvt_pk_bf16_f32 v106, v88, v89
    v_cvt_pk_bf16_f32 v107, v90, v91
    s_setprio 1
    v_exp_f32 v60, v60
    v_exp_f32 v61, v61
    v_mfma_f32_32x32x16_bf16 v[40:55], v[120:123], v[104:107], v[40:55]
    ds_read_b128 v[120:123], v9 offset:19456
    v_exp_f32 v62, v62
    v_exp_f32 v63, v63
    v_exp_f32 v64, v64
    v_mfma_f32_32x32x16_bf16 v[76:91], v[108:111], v[16:19], v[24:39]
    ds_read_b128 v[108:111], v9 offset:24576
    v_cvt_pk_bf16_f32 v92, v60, v61
    v_exp_f32 v65, v65
    v_cvt_pk_bf16_f32 v93, v62, v63
    v_exp_f32 v66, v66
    v_smfmac_f32_16x16x64_bf16 v[56:59], v[12:15], v[100:107], v10
    s_waitcnt lgkmcnt(2)
    buffer_load_dwordx4 v8, s[8:11], s53 offen offset:3072 sc1 lds
    v_exp_f32 v67, v67
    v_cvt_pk_bf16_f32 v94, v64, v65
    v_exp_f32 v68, v68
    v_mfma_f32_32x32x16_bf16 v[76:91], v[112:115], v[20:23], v[76:91]
    ds_read_b128 v[112:115], v9 offset:25600
    v_cvt_pk_bf16_f32 v95, v66, v67
    v_exp_f32 v69, v69
    v_exp_f32 v70, v70
    v_exp_f32 v71, v71
    v_mfma_f32_32x32x16_bf16 v[40:55], v[116:119], v[92:95], v[40:55]
    s_waitcnt lgkmcnt(1)
    ds_read_b128 v[116:119], v9 offset:22528
    v_cvt_pk_bf16_f32 v96, v68, v69
    v_exp_f32 v72, v72
    v_exp_f32 v73, v73
    v_cvt_pk_bf16_f32 v97, v70, v71
    buffer_store_dwordx4 v[136:139], v8, s[8:11], s65 offen sc0 sc1
    v_mfma_f32_16x16x32_bf16 v[188:191], v[136:139], v[140:143], v[188:191]
    s_add_u32 s65, s65, s66
    v_exp_f32 v74, v74
    v_exp_f32 v75, v75
    v_cvt_pk_bf16_f32 v98, v72, v73
    v_cvt_pk_bf16_f32 v99, v74, v75
    s_setprio 0
    v_exp_f32 v76, v76
    v_exp_f32 v77, v77
    v_mfma_f32_32x32x16_bf16 v[40:55], v[120:123], v[96:99], v[40:55]
    ds_read_b128 v[120:123], v9 offset:23552
    v_exp_f32 v78, v78
    v_exp_f32 v79, v79
    v_exp_f32 v80, v80
    v_mfma_f32_32x32x16_bf16 v[60:75], v[108:111], v[16:19], v[24:39]
    ds_read_b128 v[108:111], v9 offset:28672
    v_cvt_pk_bf16_f32 v100, v76, v77
    v_exp_f32 v81, v81
    v_cvt_pk_bf16_f32 v101, v78, v79
    v_exp_f32 v82, v82
    v_smfmac_f32_16x16x64_bf16 v[56:59], v[12:15], v[92:99], v10
    s_waitcnt lgkmcnt(2)
    v_exp_f32 v83, v83
    v_cvt_pk_bf16_f32 v102, v80, v81
    v_exp_f32 v84, v84
    v_mfma_f32_32x32x16_bf16 v[60:75], v[112:115], v[20:23], v[60:75]
    ds_read_b128 v[112:115], v9 offset:29696
    v_cvt_pk_bf16_f32 v103, v82, v83
    v_exp_f32 v85, v85
    v_exp_f32 v86, v86
    v_exp_f32 v87, v87
    v_mfma_f32_32x32x16_bf16 v[40:55], v[116:119], v[100:103], v[40:55]
    s_waitcnt lgkmcnt(1)
    ds_read_b128 v[116:119], v9 offset:26624
    v_cvt_pk_bf16_f32 v104, v84, v85
    v_exp_f32 v88, v88
    v_exp_f32 v89, v89
    v_cvt_pk_bf16_f32 v105, v86, v87
    s_cmp_lg_u32 s45, 0
    s_cbranch_scc1 att_nr21
    buffer_load_dwordx2 v[232:233], v193, s[12:15], s47 offen offset:0
    buffer_load_dwordx2 v[234:235], v193, s[12:15], s47 offen offset:32
    s_add_u32 s47, s47, 32768
att_nr21:
    v_exp_f32 v90, v90
    v_exp_f32 v91, v91
    v_cvt_pk_bf16_f32 v106, v88, v89
    v_cvt_pk_bf16_f32 v107, v90, v91
    v_exp_f32 v60, v60
    v_exp_f32 v61, v61
    v_mfma_f32_32x32x16_bf16 v[40:55], v[120:123], v[104:107], v[40:55]
    ds_read_b128 v[120:123], v9 offset:27648
    s_barrier
    s_setprio 3
    v_exp_f32 v62, v62
    v_exp_f32 v63, v63
    v_exp_f32 v64, v64
    v_mfma_f32_32x32x16_bf16 v[76:91], v[108:111], v[16:19], v[24:39]
    ds_read_b128 v[108:111], v9 offset:32768
    s_add_u32 s53, s53, 32768
    s_add_u32 m0, s52, 32768
    v_cvt_pk_bf16_f32 v92, v60, v61
    v_exp_f32 v65, v65
    v_cvt_pk_bf16_f32 v93, v62, v63
    v_exp_f32 v66, v66
    v_smfmac_f32_16x16x64_bf16 v[56:59], v[12:15], v[100:107], v10
    s_waitcnt lgkmcnt(2)
    buffer_load_dwordx4 v8, s[8:11], s53 offen offset:0 sc1 lds
    v_exp_f32 v67, v67
    v_cvt_pk_bf16_f32 v94, v64, v65
    v_exp_f32 v68, v68
    v_mfma_f32_32x32x16_bf16 v[76:91], v[112:115], v[20:23], v[76:91]
    ds_read_b128 v[112:115], v9 offset:33792
    v_cvt_pk_bf16_f32 v95, v66, v67
    v_exp_f32 v69, v69
    v_exp_f32 v70, v70
    v_exp_f32 v71, v71
    v_mfma_f32_32x32x16_bf16 v[40:55], v[116:119], v[92:95], v[40:55]
    s_waitcnt lgkmcnt(1)
    ds_read_b128 v[116:119], v9 offset:30720
    v_cvt_pk_bf16_f32 v96, v68, v69
    v_exp_f32 v72, v72
    v_exp_f32 v73, v73
    v_cvt_pk_bf16_f32 v97, v70, v71
    v_exp_f32 v74, v74
    v_exp_f32 v75, v75
    v_cvt_pk_bf16_f32 v98, v72, v73
    v_cvt_pk_bf16_f32 v99, v74, v75
    v_exp_f32 v76, v76
    v_exp_f32 v77, v77
    v_mfma_f32_32x32x16_bf16 v[40:55], v[120:123], v[96:99], v[40:55]
    ds_read_b128 v[120:123], v9 offset:31744
    v_exp_f32 v78, v78
    v_exp_f32 v79, v79
    v_exp_f32 v80, v80
    v_mfma_f32_32x32x16_bf16 v[60:75], v[108:111], v[16:19], v[24:39]
    ds_read_b128 v[108:111], v9 offset:36864
    v_cvt_pk_bf16_f32 v100, v76, v77
    v_exp_f32 v81, v81
    v_cvt_pk_bf16_f32 v101, v78, v79
    v_exp_f32 v82, v82
    v_smfmac_f32_16x16x64_bf16 v[56:59], v[12:15], v[92:99], v10
    s_waitcnt lgkmcnt(2)
    v_exp_f32 v83, v83
    v_cvt_pk_bf16_f32 v102, v80, v81
    v_exp_f32 v84, v84
    v_mfma_f32_32x32x16_bf16 v[60:75], v[112:115], v[20:23], v[60:75]
    ds_read_b128 v[112:115], v9 offset:37888
    v_cvt_pk_bf16_f32 v103, v82, v83
    v_exp_f32 v85, v85
    v_exp_f32 v86, v86
    v_exp_f32 v87, v87
    v_mfma_f32_32x32x16_bf16 v[40:55], v[116:119], v[100:103], v[40:55]
    s_waitcnt lgkmcnt(1)
    ds_read_b128 v[116:119], v9 offset:34816
    v_cvt_pk_bf16_f32 v104, v84, v85
    v_exp_f32 v88, v88
    v_exp_f32 v89, v89
    v_cvt_pk_bf16_f32 v105, v86, v87
    s_mov_b32 m0, s69
    s_nop 0
    buffer_load_dwordx4 v192, s[28:31], s61 offen offset:0 lds
    s_add_u32 s61, s61, s68
    s_add_u32 m0, s52, 32768
    v_exp_f32 v90, v90
    v_exp_f32 v91, v91
    v_cvt_pk_bf16_f32 v106, v88, v89
    v_cvt_pk_bf16_f32 v107, v90, v91
    v_exp_f32 v60, v60
    v_exp_f32 v61, v61
    v_mfma_f32_32x32x16_bf16 v[40:55], v[120:123], v[104:107], v[40:55]
    ds_read_b128 v[120:123], v9 offset:35840
    v_exp_f32 v62, v62
    v_exp_f32 v63, v63
    v_exp_f32 v64, v64
    v_mfma_f32_32x32x16_bf16 v[76:91], v[108:111], v[16:19], v[24:39]
    ds_read_b128 v[108:111], v9 offset:40960
    v_cvt_pk_bf16_f32 v92, v60, v61
    v_exp_f32 v65, v65
    v_cvt_pk_bf16_f32 v93, v62, v63
    v_exp_f32 v66, v66
    v_smfmac_f32_16x16x64_bf16 v[56:59], v[12:15], v[100:107], v10
    s_waitcnt lgkmcnt(2)
    buffer_load_dwordx4 v8, s[8:11], s53 offen offset:1024 sc1 lds
    v_exp_f32 v67, v67
    v_cvt_pk_bf16_f32 v94, v64, v65
    v_exp_f32 v68, v68
    v_mfma_f32_32x32x16_bf16 v[76:91], v[112:115], v[20:23], v[76:91]
    ds_read_b128 v[112:115], v9 offset:41984
    v_cvt_pk_bf16_f32 v95, v66, v67
    v_exp_f32 v69, v69
    v_exp_f32 v70, v70
    v_exp_f32 v71, v71
    v_mfma_f32_32x32x16_bf16 v[40:55], v[116:119], v[92:95], v[40:55]
    s_waitcnt lgkmcnt(1)
    ds_read_b128 v[116:119], v9 offset:38912
    v_cvt_pk_bf16_f32 v96, v68, v69
    v_exp_f32 v72, v72
    v_exp_f32 v73, v73
    v_cvt_pk_bf16_f32 v97, v70, v71
    v_exp_f32 v74, v74
    v_exp_f32 v75, v75
    v_cvt_pk_bf16_f32 v98, v72, v73
    v_cvt_pk_bf16_f32 v99, v74, v75
    v_exp_f32 v76, v76
    v_exp_f32 v77, v77
    v_mfma_f32_32x32x16_bf16 v[40:55], v[120:123], v[96:99], v[40:55]
    ds_read_b128 v[120:123], v9 offset:39936
    v_exp_f32 v78, v78
    v_exp_f32 v79, v79
    v_exp_f32 v80, v80
    v_mfma_f32_32x32x16_bf16 v[60:75], v[108:111], v[16:19], v[24:39]
    ds_read_b128 v[108:111], v9 offset:45056
    v_cvt_pk_bf16_f32 v100, v76, v77
    v_exp_f32 v81, v81
    v_cvt_pk_bf16_f32 v101, v78, v79
    v_exp_f32 v82, v82
    v_smfmac_f32_16x16x64_bf16 v[56:59], v[12:15], v[92:99], v10
    s_waitcnt lgkmcnt(2)
    v_exp_f32 v83, v83
    v_cvt_pk_bf16_f32 v102, v80, v81
    v_exp_f32 v84, v84
    v_mfma_f32_32x32x16_bf16 v[60:75], v[112:115], v[20:23], v[60:75]
    ds_read_b128 v[112:115], v9 offset:46080
    v_cvt_pk_bf16_f32 v103, v82, v83
    v_exp_f32 v85, v85
    v_exp_f32 v86, v86
    v_exp_f32 v87, v87
    v_mfma_f32_32x32x16_bf16 v[40:55], v[116:119], v[100:103], v[40:55]
    s_waitcnt lgkmcnt(1)
    ds_read_b128 v[116:119], v9 offset:43008
    v_cvt_pk_bf16_f32 v104, v84, v85
    v_exp_f32 v88, v88
    v_exp_f32 v89, v89
    v_cvt_pk_bf16_f32 v105, v86, v87
    s_mov_b32 m0, s69
    s_nop 0
    buffer_load_dwordx4 v192, s[28:31], s61 offen offset:1024 lds
    s_add_u32 s61, s61, s68
    s_add_u32 m0, s52, 32768
    v_exp_f32 v90, v90
    v_exp_f32 v91, v91
    v_cvt_pk_bf16_f32 v106, v88, v89
    v_cvt_pk_bf16_f32 v107, v90, v91
    v_exp_f32 v60, v60
    v_exp_f32 v61, v61
    v_mfma_f32_32x32x16_bf16 v[40:55], v[120:123], v[104:107], v[40:55]
    ds_read_b128 v[120:123], v9 offset:44032
    v_exp_f32 v62, v62
    v_exp_f32 v63, v63
    v_exp_f32 v64, v64
    v_mfma_f32_32x32x16_bf16 v[76:91], v[108:111], v[16:19], v[24:39]
    ds_read_b128 v[108:111], v9 offset:49152
    v_cvt_pk_bf16_f32 v92, v60, v61
    v_exp_f32 v65, v65
    v_cvt_pk_bf16_f32 v93, v62, v63
    v_exp_f32 v66, v66
    v_smfmac_f32_16x16x64_bf16 v[56:59], v[12:15], v[100:107], v10
    s_waitcnt lgkmcnt(2)
    buffer_load_dwordx4 v8, s[8:11], s53 offen offset:2048 sc1 lds
    v_exp_f32 v67, v67
    v_cvt_pk_bf16_f32 v94, v64, v65
    v_exp_f32 v68, v68
    v_mfma_f32_32x32x16_bf16 v[76:91], v[112:115], v[20:23], v[76:91]
    ds_read_b128 v[112:115], v9 offset:50176
    v_cvt_pk_bf16_f32 v95, v66, v67
    v_exp_f32 v69, v69
    v_exp_f32 v70, v70
    v_exp_f32 v71, v71
    v_mfma_f32_32x32x16_bf16 v[40:55], v[116:119], v[92:95], v[40:55]
    s_waitcnt lgkmcnt(1)
    ds_read_b128 v[116:119], v9 offset:47104
    v_cvt_pk_bf16_f32 v96, v68, v69
    v_exp_f32 v72, v72
    v_exp_f32 v73, v73
    v_cvt_pk_bf16_f32 v97, v70, v71
    v_exp_f32 v74, v74
    v_exp_f32 v75, v75
    v_cvt_pk_bf16_f32 v98, v72, v73
    v_cvt_pk_bf16_f32 v99, v74, v75
    s_setprio 2
    v_exp_f32 v76, v76
    v_exp_f32 v77, v77
    v_mfma_f32_32x32x16_bf16 v[40:55], v[120:123], v[96:99], v[40:55]
    ds_read_b128 v[120:123], v9 offset:48128
    v_exp_f32 v78, v78
    v_exp_f32 v79, v79
    v_exp_f32 v80, v80
    v_mfma_f32_32x32x16_bf16 v[60:75], v[108:111], v[16:19], v[24:39]
    ds_read_b128 v[108:111], v9 offset:53248
    v_cvt_pk_bf16_f32 v100, v76, v77
    v_exp_f32 v81, v81
    v_cvt_pk_bf16_f32 v101, v78, v79
    v_exp_f32 v82, v82
    v_smfmac_f32_16x16x64_bf16 v[56:59], v[12:15], v[92:99], v10
    s_waitcnt lgkmcnt(2)
    s_waitcnt vmcnt(6)
    v_exp_f32 v83, v83
    v_cvt_pk_bf16_f32 v102, v80, v81
    v_exp_f32 v84, v84
    v_mfma_f32_32x32x16_bf16 v[60:75], v[112:115], v[20:23], v[60:75]
    ds_read_b128 v[112:115], v9 offset:54272
    v_cvt_pk_bf16_f32 v103, v82, v83
    v_exp_f32 v85, v85
    v_exp_f32 v86, v86
    v_exp_f32 v87, v87
    v_mfma_f32_32x32x16_bf16 v[40:55], v[116:119], v[100:103], v[40:55]
    s_waitcnt lgkmcnt(1)
    ds_read_b128 v[116:119], v9 offset:51200
    v_cvt_pk_bf16_f32 v104, v84, v85
    v_exp_f32 v88, v88
    v_exp_f32 v89, v89
    v_cvt_pk_bf16_f32 v105, v86, v87
    s_mov_b32 m0, s69
    s_nop 0
    buffer_load_dwordx4 v192, s[28:31], s61 offen offset:2048 lds
    s_add_u32 s61, s61, s68
    s_add_u32 m0, s52, 32768
    v_exp_f32 v90, v90
    v_exp_f32 v91, v91
    v_cvt_pk_bf16_f32 v106, v88, v89
    v_cvt_pk_bf16_f32 v107, v90, v91
    s_setprio 1
    v_exp_f32 v60, v60
    v_exp_f32 v61, v61
    v_mfma_f32_32x32x16_bf16 v[40:55], v[120:123], v[104:107], v[40:55]
    ds_read_b128 v[120:123], v9 offset:52224
    v_exp_f32 v62, v62
    v_exp_f32 v63, v63
    v_exp_f32 v64, v64
    v_mfma_f32_32x32x16_bf16 v[76:91], v[108:111], v[16:19], v[24:39]
    ds_read_b128 v[108:111], v9 offset:57344
    v_cvt_pk_bf16_f32 v92, v60, v61
    v_exp_f32 v65, v65
    v_cvt_pk_bf16_f32 v93, v62, v63
    v_exp_f32 v66, v66
    v_smfmac_f32_16x16x64_bf16 v[56:59], v[12:15], v[100:107], v10
    s_waitcnt lgkmcnt(2)
    buffer_load_dwordx4 v8, s[8:11], s53 offen offset:3072 sc1 lds
    v_exp_f32 v67, v67
    v_cvt_pk_bf16_f32 v94, v64, v65
    v_exp_f32 v68, v68
    v_mfma_f32_32x32x16_bf16 v[76:91], v[112:115], v[20:23], v[76:91]
    ds_read_b128 v[112:115], v9 offset:58368
    v_cvt_pk_bf16_f32 v95, v66, v67
    v_exp_f32 v69, v69
    v_exp_f32 v70, v70
    v_exp_f32 v71, v71
    v_mfma_f32_32x32x16_bf16 v[40:55], v[116:119], v[92:95], v[40:55]
    s_waitcnt lgkmcnt(1)
    ds_read_b128 v[116:119], v9 offset:55296
    v_cvt_pk_bf16_f32 v96, v68, v69
    v_exp_f32 v72, v72
    v_exp_f32 v73, v73
    v_cvt_pk_bf16_f32 v97, v70, v71
    v_exp_f32 v74, v74
    v_exp_f32 v75, v75
    v_cvt_pk_bf16_f32 v98, v72, v73
    v_cvt_pk_bf16_f32 v99, v74, v75
    s_setprio 0
    v_exp_f32 v76, v76
    v_exp_f32 v77, v77
    v_mfma_f32_32x32x16_bf16 v[40:55], v[120:123], v[96:99], v[40:55]
    ds_read_b128 v[120:123], v9 offset:56320
    v_exp_f32 v78, v78
    v_exp_f32 v79, v79
    v_exp_f32 v80, v80
    v_mfma_f32_32x32x16_bf16 v[60:75], v[108:111], v[16:19], v[24:39]
    ds_read_b128 v[108:111], v9 offset:61440
    v_cvt_pk_bf16_f32 v100, v76, v77
    v_exp_f32 v81, v81
    v_cvt_pk_bf16_f32 v101, v78, v79
    v_exp_f32 v82, v82
    v_smfmac_f32_16x16x64_bf16 v[56:59], v[12:15], v[92:99], v10
    s_waitcnt lgkmcnt(2)
    v_exp_f32 v83, v83
    v_cvt_pk_bf16_f32 v102, v80, v81
    v_exp_f32 v84, v84
    v_mfma_f32_32x32x16_bf16 v[60:75], v[112:115], v[20:23], v[60:75]
    ds_read_b128 v[112:115], v9 offset:62464
    v_cvt_pk_bf16_f32 v103, v82, v83
    v_exp_f32 v85, v85
    v_exp_f32 v86, v86
    v_exp_f32 v87, v87
    v_mfma_f32_32x32x16_bf16 v[40:55], v[116:119], v[100:103], v[40:55]
    s_waitcnt lgkmcnt(1)
    ds_read_b128 v[116:119], v9 offset:59392
    v_cvt_pk_bf16_f32 v104, v84, v85
    v_exp_f32 v88, v88
    v_exp_f32 v89, v89
    v_cvt_pk_bf16_f32 v105, v86, v87
    s_mov_b32 m0, s69
    s_nop 0
    buffer_load_dwordx4 v192, s[28:31], s61 offen offset:3072 lds
    s_add_u32 s61, s61, s68
    s_add_u32 m0, s52, 32768
    v_exp_f32 v90, v90
    v_exp_f32 v91, v91
    v_cvt_pk_bf16_f32 v106, v88, v89
    v_cvt_pk_bf16_f32 v107, v90, v91
    v_exp_f32 v60, v60
    v_exp_f32 v61, v61
    v_mfma_f32_32x32x16_bf16 v[40:55], v[120:123], v[104:107], v[40:55]
    ds_read_b128 v[120:123], v9 offset:60416
    s_barrier
    s_setprio 3
    v_exp_f32 v62, v62
    v_exp_f32 v63, v63
    v_exp_f32 v64, v64
    v_mfma_f32_32x32x16_bf16 v[76:91], v[108:111], v[16:19], v[24:39]
    ds_read_b128 v[108:111], v8 offset:0
    s_add_u32 s53, s53, 32768
    s_add_u32 m0, s52, 65536
    v_cvt_pk_bf16_f32 v92, v60, v61
    v_exp_f32 v65, v65
    v_cvt_pk_bf16_f32 v93, v62, v63
    v_exp_f32 v66, v66
    v_smfmac_f32_16x16x64_bf16 v[56:59], v[12:15], v[100:107], v10
    s_waitcnt lgkmcnt(2)
    buffer_load_dwordx4 v8, s[8:11], s53 offen offset:0 sc1 lds
    v_exp_f32 v67, v67
    v_cvt_pk_bf16_f32 v94, v64, v65
    v_exp_f32 v68, v68
    v_mfma_f32_32x32x16_bf16 v[76:91], v[112:115], v[20:23], v[76:91]
    ds_read_b128 v[112:115], v8 offset:1024
    v_cvt_pk_bf16_f32 v95, v66, v67
    v_exp_f32 v69, v69
    v_exp_f32 v70, v70
    v_exp_f32 v71, v71
    v_mfma_f32_32x32x16_bf16 v[40:55], v[116:119], v[92:95], v[40:55]
    s_waitcnt lgkmcnt(1)
    ds_read_b128 v[116:119], v9 offset:63488
    v_cvt_pk_bf16_f32 v96, v68, v69
    v_exp_f32 v72, v72
    v_exp_f32 v73, v73
    v_cvt_pk_bf16_f32 v97, v70, v71
    v_exp_f32 v74, v74
    v_exp_f32 v75, v75
    v_cvt_pk_bf16_f32 v98, v72, v73
    v_cvt_pk_bf16_f32 v99, v74, v75
    v_exp_f32 v76, v76
    v_exp_f32 v77, v77
    v_mfma_f32_32x32x16_bf16 v[40:55], v[120:123], v[96:99], v[40:55]
    ds_read_b128 v[120:123], v9 offset:64512
    v_exp_f32 v78, v78
    v_exp_f32 v79, v79
    v_exp_f32 v80, v80
    v_mfma_f32_32x32x16_bf16 v[60:75], v[108:111], v[16:19], v[24:39]
    ds_read_b128 v[108:111], v8 offset:4096
    v_cvt_pk_bf16_f32 v100, v76, v77
    v_exp_f32 v81, v81
    v_cvt_pk_bf16_f32 v101, v78, v79
    v_exp_f32 v82, v82
    v_smfmac_f32_16x16x64_bf16 v[56:59], v[12:15], v[92:99], v10
    s_waitcnt lgkmcnt(2)
    v_exp_f32 v83, v83
    v_cvt_pk_bf16_f32 v102, v80, v81
    v_exp_f32 v84, v84
    v_mfma_f32_32x32x16_bf16 v[60:75], v[112:115], v[20:23], v[60:75]
    ds_read_b128 v[112:115], v8 offset:5120
    v_cvt_pk_bf16_f32 v103, v82, v83
    v_exp_f32 v85, v85
    v_exp_f32 v86, v86
    v_exp_f32 v87, v87
    v_mfma_f32_32x32x16_bf16 v[40:55], v[116:119], v[100:103], v[40:55]
    s_waitcnt lgkmcnt(1)
    ds_read_b128 v[116:119], v8 offset:2048
    v_cvt_pk_bf16_f32 v104, v84, v85
    v_exp_f32 v88, v88
    v_exp_f32 v89, v89
    v_cvt_pk_bf16_f32 v105, v86, v87
    s_cmp_lg_u32 s45, 0
    s_cbranch_scc1 att_nr31
    buffer_load_dwordx2 v[236:237], v193, s[12:15], s47 offen offset:0
    buffer_load_dwordx2 v[238:239], v193, s[12:15], s47 offen offset:32
    s_add_u32 s47, s47, 32768
att_nr31:
    v_exp_f32 v90, v90
    v_exp_f32 v91, v91
    v_cvt_pk_bf16_f32 v106, v88, v89
    v_cvt_pk_bf16_f32 v107, v90, v91
    v_exp_f32 v60, v60
    v_exp_f32 v61, v61
    v_mfma_f32_32x32x16_bf16 v[40:55], v[120:123], v[104:107], v[40:55]
    ds_read_b128 v[120:123], v8 offset:3072
    v_exp_f32 v62, v62
    v_exp_f32 v63, v63
    v_exp_f32 v64, v64
    v_mfma_f32_32x32x16_bf16 v[76:91], v[108:111], v[16:19], v[24:39]
    ds_read_b128 v[108:111], v8 offset:8192
    v_cvt_pk_bf16_f32 v92, v60, v61
    v_exp_f32 v65, v65
    v_cvt_pk_bf16_f32 v93, v62, v63
    v_exp_f32 v66, v66
    v_smfmac_f32_16x16x64_bf16 v[56:59], v[12:15], v[100:107], v10
    s_waitcnt lgkmcnt(2)
    buffer_load_dwordx4 v8, s[8:11], s53 offen offset:1024 sc1 lds
    v_exp_f32 v67, v67
    v_cvt_pk_bf16_f32 v94, v64, v65
    v_exp_f32 v68, v68
    v_mfma_f32_32x32x16_bf16 v[76:91], v[112:115], v[20:23], v[76:91]
    ds_read_b128 v[112:115], v8 offset:9216
    v_cvt_pk_bf16_f32 v95, v66, v67
    v_exp_f32 v69, v69
    v_exp_f32 v70, v70
    v_exp_f32 v71, v71
    v_mfma_f32_32x32x16_bf16 v[40:55], v[116:119], v[92:95], v[40:55]
    s_waitcnt lgkmcnt(1)
    ds_read_b128 v[116:119], v8 offset:6144
    v_cvt_pk_bf16_f32 v96, v68, v69
    v_exp_f32 v72, v72
    v_exp_f32 v73, v73
    v_cvt_pk_bf16_f32 v97, v70, v71
    v_exp_f32 v74, v74
    v_exp_f32 v75, v75
    v_cvt_pk_bf16_f32 v98, v72, v73
    v_cvt_pk_bf16_f32 v99, v74, v75
    v_exp_f32 v76, v76
    v_exp_f32 v77, v77
    v_mfma_f32_32x32x16_bf16 v[40:55], v[120:123], v[96:99], v[40:55]
    ds_read_b128 v[120:123], v8 offset:7168
    v_exp_f32 v78, v78
    v_exp_f32 v79, v79
    v_exp_f32 v80, v80
    v_mfma_f32_32x32x16_bf16 v[60:75], v[108:111], v[16:19], v[24:39]
    ds_read_b128 v[108:111], v8 offset:12288
    v_cvt_pk_bf16_f32 v100, v76, v77
    v_exp_f32 v81, v81
    v_cvt_pk_bf16_f32 v101, v78, v79
    v_exp_f32 v82, v82
    v_smfmac_f32_16x16x64_bf16 v[56:59], v[12:15], v[92:99], v10
    s_waitcnt lgkmcnt(2)
    v_exp_f32 v83, v83
    v_cvt_pk_bf16_f32 v102, v80, v81
    v_exp_f32 v84, v84
    v_mfma_f32_32x32x16_bf16 v[60:75], v[112:115], v[20:23], v[60:75]
    ds_read_b128 v[112:115], v8 offset:13312
    v_cvt_pk_bf16_f32 v103, v82, v83
    v_exp_f32 v85, v85
    v_exp_f32 v86, v86
    v_exp_f32 v87, v87
    v_mfma_f32_32x32x16_bf16 v[40:55], v[116:119], v[100:103], v[40:55]
    s_waitcnt lgkmcnt(1)
    ds_read_b128 v[116:119], v8 offset:10240
    v_cvt_pk_bf16_f32 v104, v84, v85
    v_exp_f32 v88, v88
    v_exp_f32 v89, v89
    v_cvt_pk_bf16_f32 v105, v86, v87
    s_cmp_lg_u32 s45, 0
    s_cbranch_scc1 att_nr33
    buffer_load_dwordx2 v[240:241], v193, s[12:15], s47 offen offset:0
    buffer_load_dwordx2 v[242:243], v193, s[12:15], s47 offen offset:32
    s_add_u32 s47, s47, 32768
att_nr33:
    v_exp_f32 v90, v90
    v_exp_f32 v91, v91
    v_cvt_pk_bf16_f32 v106, v88, v89
    v_cvt_pk_bf16_f32 v107, v90, v91
    v_exp_f32 v60, v60
    v_exp_f32 v61, v61
    v_mfma_f32_32x32x16_bf16 v[40:55], v[120:123], v[104:107], v[40:55]
    ds_read_b128 v[120:123], v8 offset:11264
    v_exp_f32 v62, v62
    v_exp_f32 v63, v63
    v_exp_f32 v64, v64
    v_mfma_f32_32x32x16_bf16 v[76:91], v[108:111], v[16:19], v[24:39]
    ds_read_b128 v[108:111], v8 offset:16384
    v_cvt_pk_bf16_f32 v92, v60, v61
    v_exp_f32 v65, v65
    v_cvt_pk_bf16_f32 v93, v62, v63
    v_exp_f32 v66, v66
    v_smfmac_f32_16x16x64_bf16 v[56:59], v[12:15], v[100:107], v10
    s_waitcnt lgkmcnt(2)
    buffer_load_dwordx4 v8, s[8:11], s53 offen offset:2048 sc1 lds
    v_exp_f32 v67, v67
    v_cvt_pk_bf16_f32 v94, v64, v65
    v_exp_f32 v68, v68
    v_mfma_f32_32x32x16_bf16 v[76:91], v[112:115], v[20:23], v[76:91]
    ds_read_b128 v[112:115], v8 offset:17408
    v_cvt_pk_bf16_f32 v95, v66, v67
    v_exp_f32 v69, v69
    v_exp_f32 v70, v70
    v_exp_f32 v71, v71
    v_mfma_f32_32x32x16_bf16 v[40:55], v[116:119], v[92:95], v[40:55]
    s_waitcnt lgkmcnt(1)
    ds_read_b128 v[116:119], v8 offset:14336
    v_cvt_pk_bf16_f32 v96, v68, v69
    v_exp_f32 v72, v72
    v_exp_f32 v73, v73
    v_cvt_pk_bf16_f32 v97, v70, v71
    v_exp_f32 v74, v74
    v_exp_f32 v75, v75
    v_cvt_pk_bf16_f32 v98, v72, v73
    v_cvt_pk_bf16_f32 v99, v74, v75
    s_setprio 2
    v_exp_f32 v76, v76
    v_exp_f32 v77, v77
    v_mfma_f32_32x32x16_bf16 v[40:55], v[120:123], v[96:99], v[40:55]
    ds_read_b128 v[120:123], v8 offset:15360
    v_exp_f32 v78, v78
    v_exp_f32 v79, v79
    v_exp_f32 v80, v80
    v_mfma_f32_32x32x16_bf16 v[60:75], v[108:111], v[16:19], v[24:39]
    ds_read_b128 v[108:111], v8 offset:20480
    v_cvt_pk_bf16_f32 v100, v76, v77
    v_exp_f32 v81, v81
    v_cvt_pk_bf16_f32 v101, v78, v79
    v_exp_f32 v82, v82
    v_smfmac_f32_16x16x64_bf16 v[56:59], v[12:15], v[92:99], v10
    s_waitcnt lgkmcnt(2)
    s_waitcnt vmcnt(4)
    v_exp_f32 v83, v83
    v_cvt_pk_bf16_f32 v102, v80, v81
    v_exp_f32 v84, v84
    v_mfma_f32_32x32x16_bf16 v[60:75], v[112:115], v[20:23], v[60:75]
    ds_read_b128 v[112:115], v8 offset:21504
    v_cvt_pk_bf16_f32 v103, v82, v83
    v_exp_f32 v85, v85
    v_exp_f32 v86, v86
    v_exp_f32 v87, v87
    v_mfma_f32_32x32x16_bf16 v[40:55], v[116:119], v[100:103], v[40:55]
    s_waitcnt lgkmcnt(1)
    ds_read_b128 v[116:119], v8 offset:18432
    v_cvt_pk_bf16_f32 v104, v84, v85
    v_exp_f32 v88, v88
    v_exp_f32 v89, v89
    v_cvt_pk_bf16_f32 v105, v86, v87
    v_exp_f32 v90, v90
    v_exp_f32 v91, v91
    v_cvt_pk_bf16_f32 v106, v88, v89
    v_cvt_pk_bf16_f32 v107, v90, v91
    s_setprio 1
    v_exp_f32 v60, v60
    v_exp_f32 v61, v61
    v_mfma_f32_32x32x16_bf16 v[40:55], v[120:123], v[104:107], v[40:55]
    ds_read_b128 v[120:123], v8 offset:19456
    v_exp_f32 v62, v62
    v_exp_f32 v63, v63
    v_exp_f32 v64, v64
    v_mfma_f32_32x32x16_bf16 v[76:91], v[108:111], v[16:19], v[24:39]
    ds_read_b128 v[108:111], v8 offset:24576
    v_cvt_pk_bf16_f32 v92, v60, v61
    v_exp_f32 v65, v65
    v_cvt_pk_bf16_f32 v93, v62, v63
    v_exp_f32 v66, v66
    v_smfmac_f32_16x16x64_bf16 v[56:59], v[12:15], v[100:107], v10
    s_waitcnt lgkmcnt(2)
    buffer_load_dwordx4 v8, s[8:11], s53 offen offset:3072 sc1 lds
    v_exp_f32 v67, v67
    v_cvt_pk_bf16_f32 v94, v64, v65
    v_exp_f32 v68, v68
    v_mfma_f32_32x32x16_bf16 v[76:91], v[112:115], v[20:23], v[76:91]
    ds_read_b128 v[112:115], v8 offset:25600
    v_cvt_pk_bf16_f32 v95, v66, v67
    v_exp_f32 v69, v69
    v_exp_f32 v70, v70
    v_exp_f32 v71, v71
    v_mfma_f32_32x32x16_bf16 v[40:55], v[116:119], v[92:95], v[40:55]
    s_waitcnt lgkmcnt(1)
    ds_read_b128 v[116:119], v8 offset:22528
    v_cvt_pk_bf16_f32 v96, v68, v69
    v_exp_f32 v72, v72
    v_exp_f32 v73, v73
    v_cvt_pk_bf16_f32 v97, v70, v71
    v_exp_f32 v74, v74
    v_exp_f32 v75, v75
    v_cvt_pk_bf16_f32 v98, v72, v73
    v_cvt_pk_bf16_f32 v99, v74, v75
    s_setprio 0
    v_exp_f32 v76, v76
    v_exp_f32 v77, v77
    v_mfma_f32_32x32x16_bf16 v[40:55], v[120:123], v[96:99], v[40:55]
    ds_read_b128 v[120:123], v8 offset:23552
    v_exp_f32 v78, v78
    v_exp_f32 v79, v79
    v_exp_f32 v80, v80
    v_mfma_f32_32x32x16_bf16 v[60:75], v[108:111], v[16:19], v[24:39]
    ds_read_b128 v[108:111], v8 offset:28672
    v_cvt_pk_bf16_f32 v100, v76, v77
    v_exp_f32 v81, v81
    v_cvt_pk_bf16_f32 v101, v78, v79
    v_exp_f32 v82, v82
    v_smfmac_f32_16x16x64_bf16 v[56:59], v[12:15], v[92:99], v10
    s_waitcnt lgkmcnt(2)
    v_exp_f32 v83, v83
    v_cvt_pk_bf16_f32 v102, v80, v81
    v_exp_f32 v84, v84
    v_mfma_f32_32x32x16_bf16 v[60:75], v[112:115], v[20:23], v[60:75]
    ds_read_b128 v[112:115], v8 offset:29696
    v_cvt_pk_bf16_f32 v103, v82, v83
    v_exp_f32 v85, v85
    v_exp_f32 v86, v86
    v_exp_f32 v87, v87
    v_mfma_f32_32x32x16_bf16 v[40:55], v[116:119], v[100:103], v[40:55]
    s_waitcnt lgkmcnt(1)
    ds_read_b128 v[116:119], v8 offset:26624
    v_cvt_pk_bf16_f32 v104, v84, v85
    v_exp_f32 v88, v88
    v_exp_f32 v89, v89
    v_cvt_pk_bf16_f32 v105, v86, v87
    s_cmp_lg_u32 s45, 0
    s_cbranch_scc1 att_nr37
    buffer_load_dwordx2 v[244:245], v193, s[12:15], s47 offen offset:0
    buffer_load_dwordx2 v[246:247], v193, s[12:15], s47 offen offset:32
    s_add_u32 s47, s47, 32768
att_nr37:
    v_exp_f32 v90, v90
    v_exp_f32 v91, v91
    v_cvt_pk_bf16_f32 v106, v88, v89
    v_cvt_pk_bf16_f32 v107, v90, v91
    v_exp_f32 v60, v60
    v_exp_f32 v61, v61
    v_mfma_f32_32x32x16_bf16 v[40:55], v[120:123], v[104:107], v[40:55]
    ds_read_b128 v[120:123], v8 offset:27648
    s_barrier
    s_cmp_eq_u32 s45, 0
    s_cbranch_scc1 att_lo1
    s_setprio 3
    s_lshl_b32 s40, s7, 12
    v_mov_b32 v2, s40
    v_mov_b32 v3, 0
    ds_write_b32 v2, v3
att_lo1:
    v_exp_f32 v62, v62
    v_exp_f32 v63, v63
    v_exp_f32 v64, v64
    v_mfma_f32_32x32x16_bf16 v[76:91], v[108:111], v[16:19], v[24:39]
    ds_read_b128 v[108:111], v8 offset:32768
    s_add_u32 s53, s53, 32768
    s_add_u32 m0, s52, 98304
    v_cvt_pk_bf16_f32 v92, v60, v61
    v_exp_f32 v65, v65
    v_cvt_pk_bf16_f32 v93, v62, v63
    v_exp_f32 v66, v66
    v_smfmac_f32_16x16x64_bf16 v[56:59], v[12:15], v[100:107], v10
    s_waitcnt lgkmcnt(2)
    buffer_load_dwordx4 v8, s[8:11], s53 offen offset:0 sc1 lds
    v_exp_f32 v67, v67
    v_cvt_pk_bf16_f32 v94, v64, v65
    v_exp_f32 v68, v68
    v_mfma_f32_32x32x16_bf16 v[76:91], v[112:115], v[20:23], v[76:91]
    buffer_load_dwordx4 v8, s[8:11], s53 offen offset:1024 sc1 lds
    ds_read_b128 v[112:115], v8 offset:33792
    v_cvt_pk_bf16_f32 v95, v66, v67
    v_exp_f32 v69, v69
    v_exp_f32 v70, v70
    v_exp_f32 v71, v71
    v_mfma_f32_32x32x16_bf16 v[40:55], v[116:119], v[92:95], v[40:55]
    s_waitcnt lgkmcnt(1)
    buffer_load_dwordx4 v8, s[8:11], s53 offen offset:2048 sc1 lds
    ds_read_b128 v[116:119], v8 offset:30720
    v_cvt_pk_bf16_f32 v96, v68, v69
    v_exp_f32 v72, v72
    v_exp_f32 v73, v73
    v_cvt_pk_bf16_f32 v97, v70, v71
    buffer_load_dwordx4 v8, s[8:11], s53 offen offset:3072 sc1 lds
    v_exp_f32 v74, v74
    v_exp_f32 v75, v75
    v_cvt_pk_bf16_f32 v98, v72, v73
    v_cvt_pk_bf16_f32 v99, v74, v75
    v_exp_f32 v76, v76
    v_exp_f32 v77, v77
    v_mfma_f32_32x32x16_bf16 v[40:55], v[120:123], v[96:99], v[40:55]
    s_waitcnt vmcnt(8)
    ds_read_b64_tr_b16 v[124:125], v194 offset:0
    ds_read_b64_tr_b16 v[126:127], v194 offset:2048
    ds_read_b64_tr_b16 v[128:129], v195 offset:0
    ds_read_b64_tr_b16 v[130:131], v195 offset:2048
    ds_read_b64_tr_b16 v[132:133], v196 offset:0
    ds_read_b64_tr_b16 v[134:135], v196 offset:2048
    ds_read_b64_tr_b16 v[136:137], v197 offset:0
    ds_read_b64_tr_b16 v[138:139], v197 offset:2048
    ds_read_b128 v[120:123], v8 offset:31744
    v_exp_f32 v78, v78
    v_exp_f32 v79, v79
    v_exp_f32 v80, v80
    v_mfma_f32_32x32x16_bf16 v[60:75], v[108:111], v[16:19], v[24:39]
    ds_read_b128 v[108:111], v8 offset:36864
    v_cvt_pk_bf16_f32 v100, v76, v77
    v_exp_f32 v81, v81
    v_cvt_pk_bf16_f32 v101, v78, v79
    v_exp_f32 v82, v82
    v_smfmac_f32_16x16x64_bf16 v[56:59], v[12:15], v[92:99], v10
    s_waitcnt lgkmcnt(2)
    v_exp_f32 v83, v83
    v_cvt_pk_bf16_f32 v102, v80, v81
    v_exp_f32 v84, v84
    v_mfma_f32_32x32x16_bf16 v[60:75], v[112:115], v[20:23], v[60:75]
    ds_read_b128 v[112:115], v8 offset:37888
    v_cvt_pk_bf16_f32 v103, v82, v83
    v_exp_f32 v85, v85
    v_exp_f32 v86, v86
    v_exp_f32 v87, v87
    v_mfma_f32_32x32x16_bf16 v[40:55], v[116:119], v[100:103], v[40:55]
    s_waitcnt lgkmcnt(1)
    ds_read_b128 v[116:119], v8 offset:34816
    v_cvt_pk_bf16_f32 v104, v84, v85
    v_exp_f32 v88, v88
    v_exp_f32 v89, v89
    v_cvt_pk_bf16_f32 v105, v86, v87
    buffer_store_dwordx4 v[124:127], v8, s[8:11], s62 offen sc0 sc1
    v_mfma_f32_16x16x32_bf16 v[176:179], v[124:127], v[140:143], v[176:179]
    s_add_u32 s62, s62, s66
    v_exp_f32 v90, v90
    v_exp_f32 v91, v91
    v_cvt_pk_bf16_f32 v106, v88, v89
    v_cvt_pk_bf16_f32 v107, v90, v91
    v_exp_f32 v60, v60
    v_exp_f32 v61, v61
    v_mfma_f32_32x32x16_bf16 v[40:55], v[120:123], v[104:107], v[40:55]
    ds_read_b128 v[120:123], v8 offset:35840
    v_exp_f32 v62, v62
    v_exp_f32 v63, v63
    v_exp_f32 v64, v64
    v_mfma_f32_32x32x16_bf16 v[76:91], v[108:111], v[16:19], v[24:39]
    ds_read_b128 v[108:111], v8 offset:40960
    v_cvt_pk_bf16_f32 v92, v60, v61
    v_exp_f32 v65, v65
    v_cvt_pk_bf16_f32 v93, v62, v63
    v_exp_f32 v66, v66
    v_smfmac_f32_16x16x64_bf16 v[56:59], v[12:15], v[100:107], v10
    s_waitcnt lgkmcnt(2)
    s_cmp_eq_u32 s6, 4
    s_cbranch_scc1 att_ssig
att_ssigret:
    v_exp_f32 v67, v67
    v_cvt_pk_bf16_f32 v94, v64, v65
    v_exp_f32 v68, v68
    v_mfma_f32_32x32x16_bf16 v[76:91], v[112:115], v[20:23], v[76:91]
    ds_read_b128 v[112:115], v8 offset:41984
    v_cvt_pk_bf16_f32 v95, v66, v67
    v_exp_f32 v69, v69
    v_exp_f32 v70, v70
    v_exp_f32 v71, v71
    v_mfma_f32_32x32x16_bf16 v[40:55], v[116:119], v[92:95], v[40:55]
    s_waitcnt lgkmcnt(1)
    ds_read_b128 v[116:119], v8 offset:38912
    v_cvt_pk_bf16_f32 v96, v68, v69
    v_exp_f32 v72, v72
    v_exp_f32 v73, v73
    v_cvt_pk_bf16_f32 v97, v70, v71
    v_exp_f32 v74, v74
    v_exp_f32 v75, v75
    v_cvt_pk_bf16_f32 v98, v72, v73
    v_cvt_pk_bf16_f32 v99, v74, v75
    v_exp_f32 v76, v76
    v_exp_f32 v77, v77
    s_cmp_lg_u32 s45, 0
    v_mfma_f32_32x32x16_bf16 v[40:55], v[120:123], v[96:99], v[40:55]
    ds_read_b128 v[120:123], v8 offset:39936
    s_cbranch_scc1 att_nb01
    s_waitcnt vmcnt(1)
    s_barrier
att_nb01:
    v_exp_f32 v78, v78
    v_exp_f32 v79, v79
    v_exp_f32 v80, v80
    v_mfma_f32_32x32x16_bf16 v[60:75], v[108:111], v[16:19], v[24:39]
    ds_read_b128 v[108:111], v8 offset:45056
    v_cvt_pk_bf16_f32 v100, v76, v77
    v_exp_f32 v81, v81
    v_cvt_pk_bf16_f32 v101, v78, v79
    v_exp_f32 v82, v82
    v_smfmac_f32_16x16x64_bf16 v[56:59], v[12:15], v[92:99], v10
    s_waitcnt lgkmcnt(2)
    v_exp_f32 v83, v83
    v_cvt_pk_bf16_f32 v102, v80, v81
    v_exp_f32 v84, v84
    v_mfma_f32_32x32x16_bf16 v[60:75], v[112:115], v[20:23], v[60:75]
    ds_read_b128 v[112:115], v8 offset:46080
    v_cvt_pk_bf16_f32 v103, v82, v83
    v_exp_f32 v85, v85
    v_exp_f32 v86, v86
    v_exp_f32 v87, v87
    v_mfma_f32_32x32x16_bf16 v[40:55], v[116:119], v[100:103], v[40:55]
    s_waitcnt lgkmcnt(1)
    ds_read_b128 v[116:119], v8 offset:43008
    v_cvt_pk_bf16_f32 v104, v84, v85
    v_exp_f32 v88, v88
    v_exp_f32 v89, v89
    v_cvt_pk_bf16_f32 v105, v86, v87
    buffer_store_dwordx4 v[128:131], v8, s[8:11], s63 offen sc0 sc1
    v_mfma_f32_16x16x32_bf16 v[180:183], v[128:131], v[140:143], v[180:183]
    s_add_u32 s63, s63, s66
    v_exp_f32 v90, v90
    v_exp_f32 v91, v91
    v_cvt_pk_bf16_f32 v106, v88, v89
    v_cvt_pk_bf16_f32 v107, v90, v91
    v_exp_f32 v60, v60
    v_exp_f32 v61, v61
    v_mfma_f32_32x32x16_bf16 v[40:55], v[120:123], v[104:107], v[40:55]
    ds_read_b128 v[120:123], v8 offset:44032
    v_exp_f32 v62, v62
    v_exp_f32 v63, v63
    v_exp_f32 v64, v64
    v_mfma_f32_32x32x16_bf16 v[76:91], v[108:111], v[16:19], v[24:39]
    ds_read_b128 v[108:111], v8 offset:49152
    v_cvt_pk_bf16_f32 v92, v60, v61
    v_exp_f32 v65, v65
    v_cvt_pk_bf16_f32 v93, v62, v63
    v_exp_f32 v66, v66
    v_smfmac_f32_16x16x64_bf16 v[56:59], v[12:15], v[100:107], v10
    s_waitcnt lgkmcnt(2)
    v_exp_f32 v67, v67
    v_cvt_pk_bf16_f32 v94, v64, v65
    v_exp_f32 v68, v68
    v_mfma_f32_32x32x16_bf16 v[76:91], v[112:115], v[20:23], v[76:91]
    ds_read_b128 v[112:115], v8 offset:50176
    v_cvt_pk_bf16_f32 v95, v66, v67
    v_exp_f32 v69, v69
    v_exp_f32 v70, v70
    v_exp_f32 v71, v71
    v_mfma_f32_32x32x16_bf16 v[40:55], v[116:119], v[92:95], v[40:55]
    s_waitcnt lgkmcnt(1)
    ds_read_b128 v[116:119], v8 offset:47104
    v_cvt_pk_bf16_f32 v96, v68, v69
    v_exp_f32 v72, v72
    v_exp_f32 v73, v73
    v_cvt_pk_bf16_f32 v97, v70, v71
    v_exp_f32 v74, v74
    v_exp_f32 v75, v75
    v_cvt_pk_bf16_f32 v98, v72, v73
    v_cvt_pk_bf16_f32 v99, v74, v75
    v_exp_f32 v76, v76
    v_exp_f32 v77, v77
    v_mfma_f32_32x32x16_bf16 v[40:55], v[120:123], v[96:99], v[40:55]
    ds_read_b128 v[120:123], v8 offset:48128
    v_exp_f32 v78, v78
    v_exp_f32 v79, v79
    v_exp_f32 v80, v80
    v_mfma_f32_32x32x16_bf16 v[60:75], v[108:111], v[16:19], v[24:39]
    ds_read_b128 v[108:111], v8 offset:53248
    v_cvt_pk_bf16_f32 v100, v76, v77
    v_exp_f32 v81, v81
    v_cvt_pk_bf16_f32 v101, v78, v79
    v_exp_f32 v82, v82
    v_smfmac_f32_16x16x64_bf16 v[56:59], v[12:15], v[92:99], v10
    s_waitcnt lgkmcnt(2)
    v_exp_f32 v83, v83
    v_cvt_pk_bf16_f32 v102, v80, v81
    v_exp_f32 v84, v84
    v_mfma_f32_32x32x16_bf16 v[60:75], v[112:115], v[20:23], v[60:75]
    ds_read_b128 v[112:115], v8 offset:54272
    v_cvt_pk_bf16_f32 v103, v82, v83
    v_exp_f32 v85, v85
    v_exp_f32 v86, v86
    v_exp_f32 v87, v87
    v_mfma_f32_32x32x16_bf16 v[40:55], v[116:119], v[100:103], v[40:55]
    s_waitcnt lgkmcnt(1)
    ds_read_b128 v[116:119], v8 offset:51200
    v_cvt_pk_bf16_f32 v104, v84, v85
    v_exp_f32 v88, v88
    v_exp_f32 v89, v89
    v_cvt_pk_bf16_f32 v105, v86, v87
    buffer_store_dwordx4 v[132:135], v8, s[8:11], s64 offen sc0 sc1
    v_mfma_f32_16x16x32_bf16 v[184:187], v[132:135], v[140:143], v[184:187]
    s_add_u32 s64, s64, s66
    v_exp_f32 v90, v90
    v_exp_f32 v91, v91
    v_cvt_pk_bf16_f32 v106, v88, v89
    v_cvt_pk_bf16_f32 v107, v90, v91
    v_exp_f32 v60, v60
    v_exp_f32 v61, v61
    v_mfma_f32_32x32x16_bf16 v[40:55], v[120:123], v[104:107], v[40:55]
    ds_read_b128 v[120:123], v8 offset:52224
    v_exp_f32 v62, v62
    v_exp_f32 v63, v63
    v_exp_f32 v64, v64
    v_mfma_f32_32x32x16_bf16 v[76:91], v[108:111], v[16:19], v[24:39]
    ds_read_b128 v[108:111], v8 offset:57344
    v_cvt_pk_bf16_f32 v92, v60, v61
    v_exp_f32 v65, v65
    v_cvt_pk_bf16_f32 v93, v62, v63
    v_exp_f32 v66, v66
    v_smfmac_f32_16x16x64_bf16 v[56:59], v[12:15], v[100:107], v10
    s_waitcnt lgkmcnt(2)
    v_exp_f32 v67, v67
    v_cvt_pk_bf16_f32 v94, v64, v65
    v_exp_f32 v68, v68
    v_mfma_f32_32x32x16_bf16 v[76:91], v[112:115], v[20:23], v[76:91]
    ds_read_b128 v[112:115], v8 offset:58368
    v_cvt_pk_bf16_f32 v95, v66, v67
    v_exp_f32 v69, v69
    v_exp_f32 v70, v70
    v_exp_f32 v71, v71
    v_mfma_f32_32x32x16_bf16 v[40:55], v[116:119], v[92:95], v[40:55]
    s_waitcnt lgkmcnt(1)
    ds_read_b128 v[116:119], v8 offset:55296
    v_cvt_pk_bf16_f32 v96, v68, v69
    v_exp_f32 v72, v72
    v_exp_f32 v73, v73
    v_cvt_pk_bf16_f32 v97, v70, v71
    v_exp_f32 v74, v74
    v_exp_f32 v75, v75
    v_cvt_pk_bf16_f32 v98, v72, v73
    v_cvt_pk_bf16_f32 v99, v74, v75
    v_exp_f32 v76, v76
    v_exp_f32 v77, v77
    v_mfma_f32_32x32x16_bf16 v[40:55], v[120:123], v[96:99], v[40:55]
    ds_read_b128 v[120:123], v8 offset:56320
    v_exp_f32 v78, v78
    v_exp_f32 v79, v79
    v_exp_f32 v80, v80
    v_mfma_f32_32x32x16_bf16 v[60:75], v[108:111], v[16:19], v[24:39]
    ds_read_b128 v[108:111], v8 offset:61440
    v_cvt_pk_bf16_f32 v100, v76, v77
    v_exp_f32 v81, v81
    v_cvt_pk_bf16_f32 v101, v78, v79
    v_exp_f32 v82, v82
    v_smfmac_f32_16x16x64_bf16 v[56:59], v[12:15], v[92:99], v10
    s_waitcnt lgkmcnt(2)
    v_exp_f32 v83, v83
    v_cvt_pk_bf16_f32 v102, v80, v81
    v_exp_f32 v84, v84
    v_mfma_f32_32x32x16_bf16 v[60:75], v[112:115], v[20:23], v[60:75]
    ds_read_b128 v[112:115], v8 offset:62464
    v_cvt_pk_bf16_f32 v103, v82, v83
    v_exp_f32 v85, v85
    v_exp_f32 v86, v86
    v_exp_f32 v87, v87
    v_mfma_f32_32x32x16_bf16 v[40:55], v[116:119], v[100:103], v[40:55]
    s_waitcnt lgkmcnt(1)
    ds_read_b128 v[116:119], v8 offset:59392
    v_cvt_pk_bf16_f32 v104, v84, v85
    v_exp_f32 v88, v88
    v_exp_f32 v89, v89
    v_cvt_pk_bf16_f32 v105, v86, v87
    buffer_store_dwordx4 v[136:139], v8, s[8:11], s65 offen sc0 sc1
    v_mfma_f32_16x16x32_bf16 v[188:191], v[136:139], v[140:143], v[188:191]
    s_add_u32 s65, s65, s66
    v_exp_f32 v90, v90
    v_exp_f32 v91, v91
    v_cvt_pk_bf16_f32 v106, v88, v89
    v_cvt_pk_bf16_f32 v107, v90, v91
    v_exp_f32 v60, v60
    v_exp_f32 v61, v61
    s_cmp_lg_u32 s45, 1
    v_mfma_f32_32x32x16_bf16 v[40:55], v[120:123], v[104:107], v[40:55]
    ds_read_b128 v[120:123], v8 offset:60416
    s_cbranch_scc1 att_nb11
    s_waitcnt vmcnt(4)
    s_barrier
att_nb11:
    v_exp_f32 v62, v62
    v_exp_f32 v63, v63
    v_exp_f32 v64, v64
    v_mfma_f32_32x32x16_bf16 v[76:91], v[108:111], v[16:19], v[24:39]
    ds_read_b128 v[108:111], v9 offset:0
    v_cvt_pk_bf16_f32 v92, v60, v61
    v_exp_f32 v65, v65
    v_cvt_pk_bf16_f32 v93, v62, v63
    v_exp_f32 v66, v66
    v_smfmac_f32_16x16x64_bf16 v[56:59], v[12:15], v[100:107], v10
    s_waitcnt lgkmcnt(2)
    v_exp_f32 v67, v67
    v_cvt_pk_bf16_f32 v94, v64, v65
    v_exp_f32 v68, v68
    v_mfma_f32_32x32x16_bf16 v[76:91], v[112:115], v[20:23], v[76:91]
    ds_read_b128 v[112:115], v9 offset:1024
    v_cvt_pk_bf16_f32 v95, v66, v67
    v_exp_f32 v69, v69
    v_exp_f32 v70, v70
    v_exp_f32 v71, v71
    v_mfma_f32_32x32x16_bf16 v[40:55], v[116:119], v[92:95], v[40:55]
    s_waitcnt lgkmcnt(1)
    ds_read_b128 v[116:119], v8 offset:63488
    v_cvt_pk_bf16_f32 v96, v68, v69
    v_exp_f32 v72, v72
    v_exp_f32 v73, v73
    v_cvt_pk_bf16_f32 v97, v70, v71
    v_exp_f32 v74, v74
    v_exp_f32 v75, v75
    v_cvt_pk_bf16_f32 v98, v72, v73
    v_cvt_pk_bf16_f32 v99, v74, v75
    v_exp_f32 v76, v76
    v_exp_f32 v77, v77
    v_mfma_f32_32x32x16_bf16 v[40:55], v[120:123], v[96:99], v[40:55]
    ds_read_b128 v[120:123], v8 offset:64512
    v_exp_f32 v78, v78
    v_exp_f32 v79, v79
    v_exp_f32 v80, v80
    v_mfma_f32_32x32x16_bf16 v[60:75], v[108:111], v[16:19], v[24:39]
    ds_read_b128 v[108:111], v9 offset:4096
    v_cvt_pk_bf16_f32 v100, v76, v77
    v_exp_f32 v81, v81
    v_cvt_pk_bf16_f32 v101, v78, v79
    v_exp_f32 v82, v82
    v_smfmac_f32_16x16x64_bf16 v[56:59], v[12:15], v[92:99], v10
    s_waitcnt lgkmcnt(2)
    s_cmp_ge_u32 s37, 112
    s_cbranch_scc1 att_nocs
    s_mov_b32 exec_lo, 0x10001
    s_mov_b32 exec_hi, 0x10001
    buffer_store_dwordx4 v[176:179], v0, s[8:11], s57 offen offset:0 sc0 sc1
    buffer_store_dwordx4 v[180:183], v0, s[8:11], s57 offen offset:64 sc0 sc1
    buffer_store_dwordx4 v[184:187], v0, s[8:11], s57 offen offset:128 sc0 sc1
    buffer_store_dwordx4 v[188:191], v0, s[8:11], s57 offen offset:192 sc0 sc1
    s_mov_b64 exec, -1
att_nocs:
    v_exp_f32 v83, v83
    v_cvt_pk_bf16_f32 v102, v80, v81
    v_exp_f32 v84, v84
    v_mfma_f32_32x32x16_bf16 v[60:75], v[112:115], v[20:23], v[60:75]
    ds_read_b128 v[112:115], v9 offset:5120
    v_cvt_pk_bf16_f32 v103, v82, v83
    v_exp_f32 v85, v85
    v_exp_f32 v86, v86
    v_exp_f32 v87, v87
    v_mfma_f32_32x32x16_bf16 v[40:55], v[116:119], v[100:103], v[40:55]
    s_waitcnt lgkmcnt(1)
    ds_read_b128 v[116:119], v9 offset:2048
    v_cvt_pk_bf16_f32 v104, v84, v85
    v_exp_f32 v88, v88
    v_exp_f32 v89, v89
    v_cvt_pk_bf16_f32 v105, v86, v87
    v_exp_f32 v90, v90
    v_exp_f32 v91, v91
    v_cvt_pk_bf16_f32 v106, v88, v89
    v_cvt_pk_bf16_f32 v107, v90, v91
    s_branch att_steps6
    .p2align 6
att_steps0:
    v_exp_f32 v60, v60
    v_exp_f32 v61, v61
    v_mfma_f32_32x32x16_bf16 v[40:55], v[120:123], v[104:107], v[40:55]
    ds_read_b128 v[120:123], v8 offset:3072
    v_exp_f32 v62, v62
    v_exp_f32 v63, v63
    v_exp_f32 v64, v64
    v_mfma_f32_32x32x16_bf16 v[76:91], v[108:111], v[16:19], v[24:39]
    ds_read_b128 v[108:111], v8 offset:8192
    s_add_u32 m0, s52, 65536
    v_cvt_pk_bf16_f32 v92, v60, v61
    v_exp_f32 v65, v65
    v_cvt_pk_bf16_f32 v93, v62, v63
    v_exp_f32 v66, v66
    v_smfmac_f32_16x16x64_bf16 v[56:59], v[12:15], v[100:107], v10
    s_waitcnt lgkmcnt(2)
    buffer_load_dwordx4 v8, s[8:11], s53 offen offset:1024 sc1 lds
    v_exp_f32 v67, v67
    v_cvt_pk_bf16_f32 v94, v64, v65
    v_exp_f32 v68, v68
    v_mfma_f32_32x32x16_bf16 v[76:91], v[112:115], v[20:23], v[76:91]
    ds_read_b128 v[112:115], v8 offset:9216
    v_cvt_pk_bf16_f32 v95, v66, v67
    v_exp_f32 v69, v69
    v_exp_f32 v70, v70
    v_exp_f32 v71, v71
    v_mfma_f32_32x32x16_bf16 v[40:55], v[116:119], v[92:95], v[40:55]
    s_waitcnt lgkmcnt(1)
    ds_read_b128 v[116:119], v8 offset:6144
    v_cvt_pk_bf16_f32 v96, v68, v69
    v_exp_f32 v72, v72
    v_exp_f32 v73, v73
    v_cvt_pk_bf16_f32 v97, v70, v71
    v_exp_f32 v74, v74
    v_exp_f32 v75, v75
    v_cvt_pk_bf16_f32 v98, v72, v73
    v_cvt_pk_bf16_f32 v99, v74, v75
    v_exp_f32 v76, v76
    v_exp_f32 v77, v77
    v_mfma_f32_32x32x16_bf16 v[40:55], v[120:123], v[96:99], v[40:55]
    ds_read_b128 v[120:123], v8 offset:7168
    v_exp_f32 v78, v78
    v_exp_f32 v79, v79
    v_exp_f32 v80, v80
    v_mfma_f32_32x32x16_bf16 v[60:75], v[108:111], v[16:19], v[24:39]
    ds_read_b128 v[108:111], v8 offset:12288
    v_cvt_pk_bf16_f32 v100, v76, v77
    v_exp_f32 v81, v81
    v_cvt_pk_bf16_f32 v101, v78, v79
    v_exp_f32 v82, v82
    v_smfmac_f32_16x16x64_bf16 v[56:59], v[12:15], v[92:99], v10
    s_waitcnt lgkmcnt(2)
    buffer_load_dwordx4 v8, s[8:11], s53 offen offset:0 sc1 lds
    v_exp_f32 v83, v83
    v_cvt_pk_bf16_f32 v102, v80, v81
    v_exp_f32 v84, v84
    v_mfma_f32_32x32x16_bf16 v[60:75], v[112:115], v[20:23], v[60:75]
    ds_read_b128 v[112:115], v8 offset:13312
    v_cvt_pk_bf16_f32 v103, v82, v83
    v_exp_f32 v85, v85
    v_exp_f32 v86, v86
    v_exp_f32 v87, v87
    v_mfma_f32_32x32x16_bf16 v[40:55], v[116:119], v[100:103], v[40:55]
    s_waitcnt lgkmcnt(1)
    ds_read_b128 v[116:119], v8 offset:10240
    v_cvt_pk_bf16_f32 v104, v84, v85
    v_exp_f32 v88, v88
    v_exp_f32 v89, v89
    v_cvt_pk_bf16_f32 v105, v86, v87
    v_exp_f32 v90, v90
    v_exp_f32 v91, v91
    v_cvt_pk_bf16_f32 v106, v88, v89
    v_cvt_pk_bf16_f32 v107, v90, v91
    v_exp_f32 v60, v60
    v_exp_f32 v61, v61
    v_mfma_f32_32x32x16_bf16 v[40:55], v[120:123], v[104:107], v[40:55]
    ds_read_b128 v[120:123], v8 offset:11264
    v_exp_f32 v62, v62
    v_exp_f32 v63, v63
    v_exp_f32 v64, v64
    v_mfma_f32_32x32x16_bf16 v[76:91], v[108:111], v[16:19], v[24:39]
    ds_read_b128 v[108:111], v8 offset:16384
    v_cvt_pk_bf16_f32 v92, v60, v61
    v_exp_f32 v65, v65
    v_cvt_pk_bf16_f32 v93, v62, v63
    v_exp_f32 v66, v66
    v_smfmac_f32_16x16x64_bf16 v[56:59], v[12:15], v[100:107], v10
    s_waitcnt lgkmcnt(2)
    buffer_load_dwordx4 v8, s[8:11], s53 offen offset:2048 sc1 lds
    v_exp_f32 v67, v67
    v_cvt_pk_bf16_f32 v94, v64, v65
    v_exp_f32 v68, v68
    v_mfma_f32_32x32x16_bf16 v[76:91], v[112:115], v[20:23], v[76:91]
    ds_read_b128 v[112:115], v8 offset:17408
    v_cvt_pk_bf16_f32 v95, v66, v67
    v_exp_f32 v69, v69
    v_exp_f32 v70, v70
    v_exp_f32 v71, v71
    v_mfma_f32_32x32x16_bf16 v[40:55], v[116:119], v[92:95], v[40:55]
    s_waitcnt lgkmcnt(1)
    ds_read_b128 v[116:119], v8 offset:14336
    v_cvt_pk_bf16_f32 v96, v68, v69
    v_exp_f32 v72, v72
    v_exp_f32 v73, v73
    v_cvt_pk_bf16_f32 v97, v70, v71
    v_exp_f32 v74, v74
    v_exp_f32 v75, v75
    v_cvt_pk_bf16_f32 v98, v72, v73
    v_cvt_pk_bf16_f32 v99, v74, v75
    s_setprio 2
    v_exp_f32 v76, v76
    v_exp_f32 v77, v77
    v_mfma_f32_32x32x16_bf16 v[40:55], v[120:123], v[96:99], v[40:55]
    ds_read_b128 v[120:123], v8 offset:15360
    v_exp_f32 v78, v78
    v_exp_f32 v79, v79
    v_exp_f32 v80, v80
    v_mfma_f32_32x32x16_bf16 v[60:75], v[108:111], v[16:19], v[24:39]
    ds_read_b128 v[108:111], v8 offset:20480
    v_cvt_pk_bf16_f32 v100, v76, v77
    v_exp_f32 v81, v81
    v_cvt_pk_bf16_f32 v101, v78, v79
    v_exp_f32 v82, v82
    v_smfmac_f32_16x16x64_bf16 v[56:59], v[12:15], v[92:99], v10
    s_waitcnt lgkmcnt(2)
    s_waitcnt vmcnt(3)
    v_exp_f32 v83, v83
    v_cvt_pk_bf16_f32 v102, v80, v81
    v_exp_f32 v84, v84
    v_mfma_f32_32x32x16_bf16 v[60:75], v[112:115], v[20:23], v[60:75]
    ds_read_b128 v[112:115], v8 offset:21504
    v_cvt_pk_bf16_f32 v103, v82, v83
    v_exp_f32 v85, v85
    v_exp_f32 v86, v86
    v_exp_f32 v87, v87
    v_mfma_f32_32x32x16_bf16 v[40:55], v[116:119], v[100:103], v[40:55]
    s_waitcnt lgkmcnt(1)
    ds_read_b128 v[116:119], v8 offset:18432
    v_cvt_pk_bf16_f32 v104, v84, v85
    v_exp_f32 v88, v88
    v_exp_f32 v89, v89
    v_cvt_pk_bf16_f32 v105, v86, v87
    v_exp_f32 v90, v90
    v_exp_f32 v91, v91
    v_cvt_pk_bf16_f32 v106, v88, v89
    v_cvt_pk_bf16_f32 v107, v90, v91
    s_setprio 1
    v_exp_f32 v60, v60
    v_exp_f32 v61, v61
    v_mfma_f32_32x32x16_bf16 v[40:55], v[120:123], v[104:107], v[40:55]
    ds_read_b128 v[120:123], v8 offset:19456
    v_exp_f32 v62, v62
    v_exp_f32 v63, v63
    v_exp_f32 v64, v64
    v_mfma_f32_32x32x16_bf16 v[76:91], v[108:111], v[16:19], v[24:39]
    ds_read_b128 v[108:111], v8 offset:24576
    v_cvt_pk_bf16_f32 v92, v60, v61
    v_exp_f32 v65, v65
    v_cvt_pk_bf16_f32 v93, v62, v63
    v_exp_f32 v66, v66
    v_smfmac_f32_16x16x64_bf16 v[56:59], v[12:15], v[100:107], v10
    s_waitcnt lgkmcnt(2)
    buffer_load_dwordx4 v8, s[8:11], s53 offen offset:3072 sc1 lds
    v_exp_f32 v67, v67
    v_cvt_pk_bf16_f32 v94, v64, v65
    v_exp_f32 v68, v68
    v_mfma_f32_32x32x16_bf16 v[76:91], v[112:115], v[20:23], v[76:91]
    ds_read_b128 v[112:115], v8 offset:25600
    v_cvt_pk_bf16_f32 v95, v66, v67
    v_exp_f32 v69, v69
    v_exp_f32 v70, v70
    v_exp_f32 v71, v71
    v_mfma_f32_32x32x16_bf16 v[40:55], v[116:119], v[92:95], v[40:55]
    s_waitcnt lgkmcnt(1)
    ds_read_b128 v[116:119], v8 offset:22528
    v_cvt_pk_bf16_f32 v96, v68, v69
    v_exp_f32 v72, v72
    v_exp_f32 v73, v73
    v_cvt_pk_bf16_f32 v97, v70, v71
    v_exp_f32 v74, v74
    v_exp_f32 v75, v75
    v_cvt_pk_bf16_f32 v98, v72, v73
    v_cvt_pk_bf16_f32 v99, v74, v75
    s_setprio 0
    v_exp_f32 v76, v76
    v_exp_f32 v77, v77
    v_mfma_f32_32x32x16_bf16 v[40:55], v[120:123], v[96:99], v[40:55]
    ds_read_b128 v[120:123], v8 offset:23552
    v_exp_f32 v78, v78
    v_exp_f32 v79, v79
    v_exp_f32 v80, v80
    v_mfma_f32_32x32x16_bf16 v[60:75], v[108:111], v[16:19], v[24:39]
    ds_read_b128 v[108:111], v8 offset:28672
    v_cvt_pk_bf16_f32 v100, v76, v77
    v_exp_f32 v81, v81
    v_cvt_pk_bf16_f32 v101, v78, v79
    v_exp_f32 v82, v82
    v_smfmac_f32_16x16x64_bf16 v[56:59], v[12:15], v[92:99], v10
    s_waitcnt lgkmcnt(2)
    v_exp_f32 v83, v83
    v_cvt_pk_bf16_f32 v102, v80, v81
    v_exp_f32 v84, v84
    v_mfma_f32_32x32x16_bf16 v[60:75], v[112:115], v[20:23], v[60:75]
    ds_read_b128 v[112:115], v8 offset:29696
    v_cvt_pk_bf16_f32 v103, v82, v83
    v_exp_f32 v85, v85
    v_exp_f32 v86, v86
    v_exp_f32 v87, v87
    v_mfma_f32_32x32x16_bf16 v[40:55], v[116:119], v[100:103], v[40:55]
    s_waitcnt lgkmcnt(1)
    ds_read_b128 v[116:119], v8 offset:26624
    v_cvt_pk_bf16_f32 v104, v84, v85
    v_exp_f32 v88, v88
    v_exp_f32 v89, v89
    v_cvt_pk_bf16_f32 v105, v86, v87
    v_exp_f32 v90, v90
    v_exp_f32 v91, v91
    v_cvt_pk_bf16_f32 v106, v88, v89
    v_cvt_pk_bf16_f32 v107, v90, v91
    v_exp_f32 v60, v60
    v_exp_f32 v61, v61
    v_mfma_f32_32x32x16_bf16 v[40:55], v[120:123], v[104:107], v[40:55]
    ds_read_b128 v[120:123], v8 offset:27648
    s_barrier
    s_setprio 3
    v_exp_f32 v62, v62
    v_exp_f32 v63, v63
    v_exp_f32 v64, v64
    v_mfma_f32_32x32x16_bf16 v[76:91], v[108:111], v[16:19], v[24:39]
    ds_read_b128 v[108:111], v8 offset:32768
    s_add_u32 s53, s53, 32768
    s_add_u32 m0, s52, 98304
    v_cvt_pk_bf16_f32 v92, v60, v61
    v_exp_f32 v65, v65
    v_cvt_pk_bf16_f32 v93, v62, v63
    v_exp_f32 v66, v66
    v_smfmac_f32_16x16x64_bf16 v[56:59], v[12:15], v[100:107], v10
    s_waitcnt lgkmcnt(2)
    buffer_load_dwordx4 v8, s[8:11], s53 offen offset:0 sc1 lds
    v_exp_f32 v67, v67
    v_cvt_pk_bf16_f32 v94, v64, v65
    v_exp_f32 v68, v68
    v_mfma_f32_32x32x16_bf16 v[76:91], v[112:115], v[20:23], v[76:91]
    ds_read_b128 v[112:115], v8 offset:33792
    v_cvt_pk_bf16_f32 v95, v66, v67
    v_exp_f32 v69, v69
    v_exp_f32 v70, v70
    v_exp_f32 v71, v71
    v_mfma_f32_32x32x16_bf16 v[40:55], v[116:119], v[92:95], v[40:55]
    s_waitcnt lgkmcnt(1)
    ds_read_b128 v[116:119], v8 offset:30720
    v_cvt_pk_bf16_f32 v96, v68, v69
    v_exp_f32 v72, v72
    v_exp_f32 v73, v73
    v_cvt_pk_bf16_f32 v97, v70, v71
    v_exp_f32 v74, v74
    v_exp_f32 v75, v75
    v_cvt_pk_bf16_f32 v98, v72, v73
    v_cvt_pk_bf16_f32 v99, v74, v75
    v_exp_f32 v76, v76
    v_exp_f32 v77, v77
    v_mfma_f32_32x32x16_bf16 v[40:55], v[120:123], v[96:99], v[40:55]
    ds_read_b128 v[120:123], v8 offset:31744
    v_exp_f32 v78, v78
    v_exp_f32 v79, v79
    v_exp_f32 v80, v80
    v_mfma_f32_32x32x16_bf16 v[60:75], v[108:111], v[16:19], v[24:39]
    ds_read_b128 v[108:111], v8 offset:36864
    v_cvt_pk_bf16_f32 v100, v76, v77
    v_exp_f32 v81, v81
    v_cvt_pk_bf16_f32 v101, v78, v79
    v_exp_f32 v82, v82
    v_smfmac_f32_16x16x64_bf16 v[56:59], v[12:15], v[92:99], v10
    s_waitcnt lgkmcnt(2)
    v_exp_f32 v83, v83
    v_cvt_pk_bf16_f32 v102, v80, v81
    v_exp_f32 v84, v84
    v_mfma_f32_32x32x16_bf16 v[60:75], v[112:115], v[20:23], v[60:75]
    ds_read_b128 v[112:115], v8 offset:37888
    v_cvt_pk_bf16_f32 v103, v82, v83
    v_exp_f32 v85, v85
    v_exp_f32 v86, v86
    v_exp_f32 v87, v87
    v_mfma_f32_32x32x16_bf16 v[40:55], v[116:119], v[100:103], v[40:55]
    s_waitcnt lgkmcnt(1)
    ds_read_b128 v[116:119], v8 offset:34816
    v_cvt_pk_bf16_f32 v104, v84, v85
    v_exp_f32 v88, v88
    v_exp_f32 v89, v89
    v_cvt_pk_bf16_f32 v105, v86, v87
    v_exp_f32 v90, v90
    v_exp_f32 v91, v91
    v_cvt_pk_bf16_f32 v106, v88, v89
    v_cvt_pk_bf16_f32 v107, v90, v91
    v_exp_f32 v60, v60
    v_exp_f32 v61, v61
    v_mfma_f32_32x32x16_bf16 v[40:55], v[120:123], v[104:107], v[40:55]
    ds_read_b128 v[120:123], v8 offset:35840
    v_exp_f32 v62, v62
    v_exp_f32 v63, v63
    v_exp_f32 v64, v64
    v_mfma_f32_32x32x16_bf16 v[76:91], v[108:111], v[16:19], v[24:39]
    ds_read_b128 v[108:111], v8 offset:40960
    v_cvt_pk_bf16_f32 v92, v60, v61
    v_exp_f32 v65, v65
    v_cvt_pk_bf16_f32 v93, v62, v63
    v_exp_f32 v66, v66
    v_smfmac_f32_16x16x64_bf16 v[56:59], v[12:15], v[100:107], v10
    s_waitcnt lgkmcnt(2)
    buffer_load_dwordx4 v8, s[8:11], s53 offen offset:1024 sc1 lds
    v_exp_f32 v67, v67
    v_cvt_pk_bf16_f32 v94, v64, v65
    v_exp_f32 v68, v68
    v_mfma_f32_32x32x16_bf16 v[76:91], v[112:115], v[20:23], v[76:91]
    ds_read_b128 v[112:115], v8 offset:41984
    v_cvt_pk_bf16_f32 v95, v66, v67
    v_exp_f32 v69, v69
    v_exp_f32 v70, v70
    v_exp_f32 v71, v71
    v_mfma_f32_32x32x16_bf16 v[40:55], v[116:119], v[92:95], v[40:55]
    s_waitcnt lgkmcnt(1)
    ds_read_b128 v[116:119], v8 offset:38912
    v_cvt_pk_bf16_f32 v96, v68, v69
    v_exp_f32 v72, v72
    v_exp_f32 v73, v73
    v_cvt_pk_bf16_f32 v97, v70, v71
    v_exp_f32 v74, v74
    v_exp_f32 v75, v75
    v_cvt_pk_bf16_f32 v98, v72, v73
    v_cvt_pk_bf16_f32 v99, v74, v75
    v_exp_f32 v76, v76
    v_exp_f32 v77, v77
    v_mfma_f32_32x32x16_bf16 v[40:55], v[120:123], v[96:99], v[40:55]
    ds_read_b128 v[120:123], v8 offset:39936
    v_exp_f32 v78, v78
    v_exp_f32 v79, v79
    v_exp_f32 v80, v80
    v_mfma_f32_32x32x16_bf16 v[60:75], v[108:111], v[16:19], v[24:39]
    ds_read_b128 v[108:111], v8 offset:45056
    v_cvt_pk_bf16_f32 v100, v76, v77
    v_exp_f32 v81, v81
    v_cvt_pk_bf16_f32 v101, v78, v79
    v_exp_f32 v82, v82
    v_smfmac_f32_16x16x64_bf16 v[56:59], v[12:15], v[92:99], v10
    s_waitcnt lgkmcnt(2)
    v_exp_f32 v83, v83
    v_cvt_pk_bf16_f32 v102, v80, v81
    v_exp_f32 v84, v84
    v_mfma_f32_32x32x16_bf16 v[60:75], v[112:115], v[20:23], v[60:75]
    ds_read_b128 v[112:115], v8 offset:46080
    v_cvt_pk_bf16_f32 v103, v82, v83
    v_exp_f32 v85, v85
    v_exp_f32 v86, v86
    v_exp_f32 v87, v87
    v_mfma_f32_32x32x16_bf16 v[40:55], v[116:119], v[100:103], v[40:55]
    s_waitcnt lgkmcnt(1)
    ds_read_b128 v[116:119], v8 offset:43008
    v_cvt_pk_bf16_f32 v104, v84, v85
    v_exp_f32 v88, v88
    v_exp_f32 v89, v89
    v_cvt_pk_bf16_f32 v105, v86, v87
    v_exp_f32 v90, v90
    v_exp_f32 v91, v91
    v_cvt_pk_bf16_f32 v106, v88, v89
    v_cvt_pk_bf16_f32 v107, v90, v91
    v_exp_f32 v60, v60
    v_exp_f32 v61, v61
    v_mfma_f32_32x32x16_bf16 v[40:55], v[120:123], v[104:107], v[40:55]
    ds_read_b128 v[120:123], v8 offset:44032
    v_exp_f32 v62, v62
    v_exp_f32 v63, v63
    v_exp_f32 v64, v64
    v_mfma_f32_32x32x16_bf16 v[76:91], v[108:111], v[16:19], v[24:39]
    ds_read_b128 v[108:111], v8 offset:49152
    v_cvt_pk_bf16_f32 v92, v60, v61
    v_exp_f32 v65, v65
    v_cvt_pk_bf16_f32 v93, v62, v63
    v_exp_f32 v66, v66
    v_smfmac_f32_16x16x64_bf16 v[56:59], v[12:15], v[100:107], v10
    s_waitcnt lgkmcnt(2)
    buffer_load_dwordx4 v8, s[8:11], s53 offen offset:2048 sc1 lds
    v_exp_f32 v67, v67
    v_cvt_pk_bf16_f32 v94, v64, v65
    v_exp_f32 v68, v68
    v_mfma_f32_32x32x16_bf16 v[76:91], v[112:115], v[20:23], v[76:91]
    ds_read_b128 v[112:115], v8 offset:50176
    v_cvt_pk_bf16_f32 v95, v66, v67
    v_exp_f32 v69, v69
    v_exp_f32 v70, v70
    v_exp_f32 v71, v71
    v_mfma_f32_32x32x16_bf16 v[40:55], v[116:119], v[92:95], v[40:55]
    s_waitcnt lgkmcnt(1)
    ds_read_b128 v[116:119], v8 offset:47104
    v_cvt_pk_bf16_f32 v96, v68, v69
    v_exp_f32 v72, v72
    v_exp_f32 v73, v73
    v_cvt_pk_bf16_f32 v97, v70, v71
    v_exp_f32 v74, v74
    v_exp_f32 v75, v75
    v_cvt_pk_bf16_f32 v98, v72, v73
    v_cvt_pk_bf16_f32 v99, v74, v75
    s_setprio 2
    v_exp_f32 v76, v76
    v_exp_f32 v77, v77
    v_mfma_f32_32x32x16_bf16 v[40:55], v[120:123], v[96:99], v[40:55]
    ds_read_b128 v[120:123], v8 offset:48128
    v_exp_f32 v78, v78
    v_exp_f32 v79, v79
    v_exp_f32 v80, v80
    v_mfma_f32_32x32x16_bf16 v[60:75], v[108:111], v[16:19], v[24:39]
    ds_read_b128 v[108:111], v8 offset:53248
    v_cvt_pk_bf16_f32 v100, v76, v77
    v_exp_f32 v81, v81
    v_cvt_pk_bf16_f32 v101, v78, v79
    v_exp_f32 v82, v82
    v_smfmac_f32_16x16x64_bf16 v[56:59], v[12:15], v[92:99], v10
    s_waitcnt lgkmcnt(2)
    s_waitcnt vmcnt(3)
    v_exp_f32 v83, v83
    v_cvt_pk_bf16_f32 v102, v80, v81
    v_exp_f32 v84, v84
    v_mfma_f32_32x32x16_bf16 v[60:75], v[112:115], v[20:23], v[60:75]
    ds_read_b128 v[112:115], v8 offset:54272
    v_cvt_pk_bf16_f32 v103, v82, v83
    v_exp_f32 v85, v85
    v_exp_f32 v86, v86
    v_exp_f32 v87, v87
    v_mfma_f32_32x32x16_bf16 v[40:55], v[116:119], v[100:103], v[40:55]
    s_waitcnt lgkmcnt(1)
    ds_read_b128 v[116:119], v8 offset:51200
    v_cvt_pk_bf16_f32 v104, v84, v85
    v_exp_f32 v88, v88
    v_exp_f32 v89, v89
    v_cvt_pk_bf16_f32 v105, v86, v87
    v_exp_f32 v90, v90
    v_exp_f32 v91, v91
    v_cvt_pk_bf16_f32 v106, v88, v89
    v_cvt_pk_bf16_f32 v107, v90, v91
    s_setprio 1
    v_exp_f32 v60, v60
    v_exp_f32 v61, v61
    v_mfma_f32_32x32x16_bf16 v[40:55], v[120:123], v[104:107], v[40:55]
    ds_read_b128 v[120:123], v8 offset:52224
    v_exp_f32 v62, v62
    v_exp_f32 v63, v63
    v_exp_f32 v64, v64
    v_mfma_f32_32x32x16_bf16 v[76:91], v[108:111], v[16:19], v[24:39]
    ds_read_b128 v[108:111], v8 offset:57344
    v_cvt_pk_bf16_f32 v92, v60, v61
    v_exp_f32 v65, v65
    v_cvt_pk_bf16_f32 v93, v62, v63
    v_exp_f32 v66, v66
    v_smfmac_f32_16x16x64_bf16 v[56:59], v[12:15], v[100:107], v10
    s_waitcnt lgkmcnt(2)
    buffer_load_dwordx4 v8, s[8:11], s53 offen offset:3072 sc1 lds
    v_exp_f32 v67, v67
    v_cvt_pk_bf16_f32 v94, v64, v65
    v_exp_f32 v68, v68
    v_mfma_f32_32x32x16_bf16 v[76:91], v[112:115], v[20:23], v[76:91]
    ds_read_b128 v[112:115], v8 offset:58368
    v_cvt_pk_bf16_f32 v95, v66, v67
    v_exp_f32 v69, v69
    v_exp_f32 v70, v70
    v_exp_f32 v71, v71
    v_mfma_f32_32x32x16_bf16 v[40:55], v[116:119], v[92:95], v[40:55]
    s_waitcnt lgkmcnt(1)
    ds_read_b128 v[116:119], v8 offset:55296
    v_cvt_pk_bf16_f32 v96, v68, v69
    v_exp_f32 v72, v72
    v_exp_f32 v73, v73
    v_cvt_pk_bf16_f32 v97, v70, v71
    v_exp_f32 v74, v74
    v_exp_f32 v75, v75
    v_cvt_pk_bf16_f32 v98, v72, v73
    v_cvt_pk_bf16_f32 v99, v74, v75
    s_setprio 0
    v_exp_f32 v76, v76
    v_exp_f32 v77, v77
    v_mfma_f32_32x32x16_bf16 v[40:55], v[120:123], v[96:99], v[40:55]
    ds_read_b128 v[120:123], v8 offset:56320
    v_exp_f32 v78, v78
    v_exp_f32 v79, v79
    v_exp_f32 v80, v80
    v_mfma_f32_32x32x16_bf16 v[60:75], v[108:111], v[16:19], v[24:39]
    ds_read_b128 v[108:111], v8 offset:61440
    v_cvt_pk_bf16_f32 v100, v76, v77
    v_exp_f32 v81, v81
    v_cvt_pk_bf16_f32 v101, v78, v79
    v_exp_f32 v82, v82
    v_smfmac_f32_16x16x64_bf16 v[56:59], v[12:15], v[92:99], v10
    s_waitcnt lgkmcnt(2)
    v_exp_f32 v83, v83
    v_cvt_pk_bf16_f32 v102, v80, v81
    v_exp_f32 v84, v84
    v_mfma_f32_32x32x16_bf16 v[60:75], v[112:115], v[20:23], v[60:75]
    ds_read_b128 v[112:115], v8 offset:62464
    v_cvt_pk_bf16_f32 v103, v82, v83
    v_exp_f32 v85, v85
    v_exp_f32 v86, v86
    v_exp_f32 v87, v87
    v_mfma_f32_32x32x16_bf16 v[40:55], v[116:119], v[100:103], v[40:55]
    s_waitcnt lgkmcnt(1)
    ds_read_b128 v[116:119], v8 offset:59392
    v_cvt_pk_bf16_f32 v104, v84, v85
    v_exp_f32 v88, v88
    v_exp_f32 v89, v89
    v_cvt_pk_bf16_f32 v105, v86, v87
    v_exp_f32 v90, v90
    v_exp_f32 v91, v91
    v_cvt_pk_bf16_f32 v106, v88, v89
    v_cvt_pk_bf16_f32 v107, v90, v91
    v_exp_f32 v60, v60
    v_exp_f32 v61, v61
    v_mfma_f32_32x32x16_bf16 v[40:55], v[120:123], v[104:107], v[40:55]
    ds_read_b128 v[120:123], v8 offset:60416
    s_barrier
    s_setprio 3
    v_exp_f32 v62, v62
    v_exp_f32 v63, v63
    v_exp_f32 v64, v64
    v_mfma_f32_32x32x16_bf16 v[76:91], v[108:111], v[16:19], v[24:39]
    ds_read_b128 v[108:111], v9 offset:0
    s_add_u32 s53, s53, 32768
    s_add_u32 m0, s52, 0
    v_cvt_pk_bf16_f32 v92, v60, v61
    v_exp_f32 v65, v65
    v_cvt_pk_bf16_f32 v93, v62, v63
    v_exp_f32 v66, v66
    v_smfmac_f32_16x16x64_bf16 v[56:59], v[12:15], v[100:107], v10
    s_waitcnt lgkmcnt(2)
    buffer_load_dwordx4 v8, s[8:11], s53 offen offset:0 sc1 lds
    v_exp_f32 v67, v67
    v_cvt_pk_bf16_f32 v94, v64, v65
    v_exp_f32 v68, v68
    v_mfma_f32_32x32x16_bf16 v[76:91], v[112:115], v[20:23], v[76:91]
    ds_read_b128 v[112:115], v9 offset:1024
    v_cvt_pk_bf16_f32 v95, v66, v67
    v_exp_f32 v69, v69
    v_exp_f32 v70, v70
    v_exp_f32 v71, v71
    v_mfma_f32_32x32x16_bf16 v[40:55], v[116:119], v[92:95], v[40:55]
    s_waitcnt lgkmcnt(1)
    ds_read_b128 v[116:119], v8 offset:63488
    v_cvt_pk_bf16_f32 v96, v68, v69
    v_exp_f32 v72, v72
    v_exp_f32 v73, v73
    v_cvt_pk_bf16_f32 v97, v70, v71
    v_exp_f32 v74, v74
    v_exp_f32 v75, v75
    v_cvt_pk_bf16_f32 v98, v72, v73
    v_cvt_pk_bf16_f32 v99, v74, v75
    v_exp_f32 v76, v76
    v_exp_f32 v77, v77
    v_mfma_f32_32x32x16_bf16 v[40:55], v[120:123], v[96:99], v[40:55]
    ds_read_b128 v[120:123], v8 offset:64512
    v_exp_f32 v78, v78
    v_exp_f32 v79, v79
    v_exp_f32 v80, v80
    v_mfma_f32_32x32x16_bf16 v[60:75], v[108:111], v[16:19], v[24:39]
    ds_read_b128 v[108:111], v9 offset:4096
    v_cvt_pk_bf16_f32 v100, v76, v77
    v_exp_f32 v81, v81
    v_cvt_pk_bf16_f32 v101, v78, v79
    v_exp_f32 v82, v82
    v_smfmac_f32_16x16x64_bf16 v[56:59], v[12:15], v[92:99], v10
    s_waitcnt lgkmcnt(2)
    v_exp_f32 v83, v83
    v_cvt_pk_bf16_f32 v102, v80, v81
    v_exp_f32 v84, v84
    v_mfma_f32_32x32x16_bf16 v[60:75], v[112:115], v[20:23], v[60:75]
    ds_read_b128 v[112:115], v9 offset:5120
    v_cvt_pk_bf16_f32 v103, v82, v83
    v_exp_f32 v85, v85
    v_exp_f32 v86, v86
    v_exp_f32 v87, v87
    v_mfma_f32_32x32x16_bf16 v[40:55], v[116:119], v[100:103], v[40:55]
    s_waitcnt lgkmcnt(1)
    ds_read_b128 v[116:119], v9 offset:2048
    v_cvt_pk_bf16_f32 v104, v84, v85
    v_exp_f32 v88, v88
    v_exp_f32 v89, v89
    v_cvt_pk_bf16_f32 v105, v86, v87
    v_exp_f32 v90, v90
    v_exp_f32 v91, v91
    v_cvt_pk_bf16_f32 v106, v88, v89
    v_cvt_pk_bf16_f32 v107, v90, v91
    v_exp_f32 v60, v60
    v_exp_f32 v61, v61
    v_mfma_f32_32x32x16_bf16 v[40:55], v[120:123], v[104:107], v[40:55]
    ds_read_b128 v[120:123], v9 offset:3072
    v_exp_f32 v62, v62
    v_exp_f32 v63, v63
    v_exp_f32 v64, v64
    v_mfma_f32_32x32x16_bf16 v[76:91], v[108:111], v[16:19], v[24:39]
    ds_read_b128 v[108:111], v9 offset:8192
    v_cvt_pk_bf16_f32 v92, v60, v61
    v_exp_f32 v65, v65
    v_cvt_pk_bf16_f32 v93, v62, v63
    v_exp_f32 v66, v66
    v_smfmac_f32_16x16x64_bf16 v[56:59], v[12:15], v[100:107], v10
    s_waitcnt lgkmcnt(2)
    buffer_load_dwordx4 v8, s[8:11], s53 offen offset:1024 sc1 lds
    v_exp_f32 v67, v67
    v_cvt_pk_bf16_f32 v94, v64, v65
    v_exp_f32 v68, v68
    v_mfma_f32_32x32x16_bf16 v[76:91], v[112:115], v[20:23], v[76:91]
    ds_read_b128 v[112:115], v9 offset:9216
    v_cvt_pk_bf16_f32 v95, v66, v67
    v_exp_f32 v69, v69
    v_exp_f32 v70, v70
    v_exp_f32 v71, v71
    v_mfma_f32_32x32x16_bf16 v[40:55], v[116:119], v[92:95], v[40:55]
    s_waitcnt lgkmcnt(1)
    ds_read_b128 v[116:119], v9 offset:6144
    v_cvt_pk_bf16_f32 v96, v68, v69
    v_exp_f32 v72, v72
    v_exp_f32 v73, v73
    v_cvt_pk_bf16_f32 v97, v70, v71
    v_exp_f32 v74, v74
    v_exp_f32 v75, v75
    v_cvt_pk_bf16_f32 v98, v72, v73
    v_cvt_pk_bf16_f32 v99, v74, v75
    v_exp_f32 v76, v76
    v_exp_f32 v77, v77
    v_mfma_f32_32x32x16_bf16 v[40:55], v[120:123], v[96:99], v[40:55]
    ds_read_b128 v[120:123], v9 offset:7168
    v_exp_f32 v78, v78
    v_exp_f32 v79, v79
    v_exp_f32 v80, v80
    v_mfma_f32_32x32x16_bf16 v[60:75], v[108:111], v[16:19], v[24:39]
    ds_read_b128 v[108:111], v9 offset:12288
    v_cvt_pk_bf16_f32 v100, v76, v77
    v_exp_f32 v81, v81
    v_cvt_pk_bf16_f32 v101, v78, v79
    v_exp_f32 v82, v82
    v_smfmac_f32_16x16x64_bf16 v[56:59], v[12:15], v[92:99], v10
    s_waitcnt lgkmcnt(2)
    v_exp_f32 v83, v83
    v_cvt_pk_bf16_f32 v102, v80, v81
    v_exp_f32 v84, v84
    v_mfma_f32_32x32x16_bf16 v[60:75], v[112:115], v[20:23], v[60:75]
    ds_read_b128 v[112:115], v9 offset:13312
    v_cvt_pk_bf16_f32 v103, v82, v83
    v_exp_f32 v85, v85
    v_exp_f32 v86, v86
    v_exp_f32 v87, v87
    v_mfma_f32_32x32x16_bf16 v[40:55], v[116:119], v[100:103], v[40:55]
    s_waitcnt lgkmcnt(1)
    ds_read_b128 v[116:119], v9 offset:10240
    v_cvt_pk_bf16_f32 v104, v84, v85
    v_exp_f32 v88, v88
    v_exp_f32 v89, v89
    v_cvt_pk_bf16_f32 v105, v86, v87
    v_exp_f32 v90, v90
    v_exp_f32 v91, v91
    v_cvt_pk_bf16_f32 v106, v88, v89
    v_cvt_pk_bf16_f32 v107, v90, v91
    v_exp_f32 v60, v60
    v_exp_f32 v61, v61
    v_mfma_f32_32x32x16_bf16 v[40:55], v[120:123], v[104:107], v[40:55]
    ds_read_b128 v[120:123], v9 offset:11264
    v_exp_f32 v62, v62
    v_exp_f32 v63, v63
    v_exp_f32 v64, v64
    v_mfma_f32_32x32x16_bf16 v[76:91], v[108:111], v[16:19], v[24:39]
    ds_read_b128 v[108:111], v9 offset:16384
    v_cvt_pk_bf16_f32 v92, v60, v61
    v_exp_f32 v65, v65
    v_cvt_pk_bf16_f32 v93, v62, v63
    v_exp_f32 v66, v66
    v_smfmac_f32_16x16x64_bf16 v[56:59], v[12:15], v[100:107], v10
    s_waitcnt lgkmcnt(2)
    buffer_load_dwordx4 v8, s[8:11], s53 offen offset:2048 sc1 lds
    v_exp_f32 v67, v67
    v_cvt_pk_bf16_f32 v94, v64, v65
    v_exp_f32 v68, v68
    v_mfma_f32_32x32x16_bf16 v[76:91], v[112:115], v[20:23], v[76:91]
    ds_read_b128 v[112:115], v9 offset:17408
    v_cvt_pk_bf16_f32 v95, v66, v67
    v_exp_f32 v69, v69
    v_exp_f32 v70, v70
    v_exp_f32 v71, v71
    v_mfma_f32_32x32x16_bf16 v[40:55], v[116:119], v[92:95], v[40:55]
    s_waitcnt lgkmcnt(1)
    ds_read_b128 v[116:119], v9 offset:14336
    v_cvt_pk_bf16_f32 v96, v68, v69
    v_exp_f32 v72, v72
    v_exp_f32 v73, v73
    v_cvt_pk_bf16_f32 v97, v70, v71
    v_exp_f32 v74, v74
    v_exp_f32 v75, v75
    v_cvt_pk_bf16_f32 v98, v72, v73
    v_cvt_pk_bf16_f32 v99, v74, v75
    s_setprio 2
    v_exp_f32 v76, v76
    v_exp_f32 v77, v77
    v_mfma_f32_32x32x16_bf16 v[40:55], v[120:123], v[96:99], v[40:55]
    ds_read_b128 v[120:123], v9 offset:15360
    v_exp_f32 v78, v78
    v_exp_f32 v79, v79
    v_exp_f32 v80, v80
    v_mfma_f32_32x32x16_bf16 v[60:75], v[108:111], v[16:19], v[24:39]
    ds_read_b128 v[108:111], v9 offset:20480
    v_cvt_pk_bf16_f32 v100, v76, v77
    v_exp_f32 v81, v81
    v_cvt_pk_bf16_f32 v101, v78, v79
    v_exp_f32 v82, v82
    v_smfmac_f32_16x16x64_bf16 v[56:59], v[12:15], v[92:99], v10
    s_waitcnt lgkmcnt(2)
    s_waitcnt vmcnt(3)
    v_exp_f32 v83, v83
    v_cvt_pk_bf16_f32 v102, v80, v81
    v_exp_f32 v84, v84
    v_mfma_f32_32x32x16_bf16 v[60:75], v[112:115], v[20:23], v[60:75]
    ds_read_b128 v[112:115], v9 offset:21504
    v_cvt_pk_bf16_f32 v103, v82, v83
    v_exp_f32 v85, v85
    v_exp_f32 v86, v86
    v_exp_f32 v87, v87
    v_mfma_f32_32x32x16_bf16 v[40:55], v[116:119], v[100:103], v[40:55]
    s_waitcnt lgkmcnt(1)
    ds_read_b128 v[116:119], v9 offset:18432
    v_cvt_pk_bf16_f32 v104, v84, v85
    v_exp_f32 v88, v88
    v_exp_f32 v89, v89
    v_cvt_pk_bf16_f32 v105, v86, v87
    v_exp_f32 v90, v90
    v_exp_f32 v91, v91
    v_cvt_pk_bf16_f32 v106, v88, v89
    v_cvt_pk_bf16_f32 v107, v90, v91
    s_setprio 1
    v_exp_f32 v60, v60
    v_exp_f32 v61, v61
    v_mfma_f32_32x32x16_bf16 v[40:55], v[120:123], v[104:107], v[40:55]
    ds_read_b128 v[120:123], v9 offset:19456
    v_exp_f32 v62, v62
    v_exp_f32 v63, v63
    v_exp_f32 v64, v64
    v_mfma_f32_32x32x16_bf16 v[76:91], v[108:111], v[16:19], v[24:39]
    ds_read_b128 v[108:111], v9 offset:24576
    v_cvt_pk_bf16_f32 v92, v60, v61
    v_exp_f32 v65, v65
    v_cvt_pk_bf16_f32 v93, v62, v63
    v_exp_f32 v66, v66
    v_smfmac_f32_16x16x64_bf16 v[56:59], v[12:15], v[100:107], v10
    s_waitcnt lgkmcnt(2)
    buffer_load_dwordx4 v8, s[8:11], s53 offen offset:3072 sc1 lds
    v_exp_f32 v67, v67
    v_cvt_pk_bf16_f32 v94, v64, v65
    v_exp_f32 v68, v68
    v_mfma_f32_32x32x16_bf16 v[76:91], v[112:115], v[20:23], v[76:91]
    ds_read_b128 v[112:115], v9 offset:25600
    v_cvt_pk_bf16_f32 v95, v66, v67
    v_exp_f32 v69, v69
    v_exp_f32 v70, v70
    v_exp_f32 v71, v71
    v_mfma_f32_32x32x16_bf16 v[40:55], v[116:119], v[92:95], v[40:55]
    s_waitcnt lgkmcnt(1)
    ds_read_b128 v[116:119], v9 offset:22528
    v_cvt_pk_bf16_f32 v96, v68, v69
    v_exp_f32 v72, v72
    v_exp_f32 v73, v73
    v_cvt_pk_bf16_f32 v97, v70, v71
    v_exp_f32 v74, v74
    v_exp_f32 v75, v75
    v_cvt_pk_bf16_f32 v98, v72, v73
    v_cvt_pk_bf16_f32 v99, v74, v75
    s_setprio 0
    v_exp_f32 v76, v76
    v_exp_f32 v77, v77
    v_mfma_f32_32x32x16_bf16 v[40:55], v[120:123], v[96:99], v[40:55]
    ds_read_b128 v[120:123], v9 offset:23552
    v_exp_f32 v78, v78
    v_exp_f32 v79, v79
    v_exp_f32 v80, v80
    v_mfma_f32_32x32x16_bf16 v[60:75], v[108:111], v[16:19], v[24:39]
    ds_read_b128 v[108:111], v9 offset:28672
    v_cvt_pk_bf16_f32 v100, v76, v77
    v_exp_f32 v81, v81
    v_cvt_pk_bf16_f32 v101, v78, v79
    v_exp_f32 v82, v82
    v_smfmac_f32_16x16x64_bf16 v[56:59], v[12:15], v[92:99], v10
    s_waitcnt lgkmcnt(2)
    v_exp_f32 v83, v83
    v_cvt_pk_bf16_f32 v102, v80, v81
    v_exp_f32 v84, v84
    v_mfma_f32_32x32x16_bf16 v[60:75], v[112:115], v[20:23], v[60:75]
    ds_read_b128 v[112:115], v9 offset:29696
    v_cvt_pk_bf16_f32 v103, v82, v83
    v_exp_f32 v85, v85
    v_exp_f32 v86, v86
    v_exp_f32 v87, v87
    v_mfma_f32_32x32x16_bf16 v[40:55], v[116:119], v[100:103], v[40:55]
    s_waitcnt lgkmcnt(1)
    ds_read_b128 v[116:119], v9 offset:26624
    v_cvt_pk_bf16_f32 v104, v84, v85
    v_exp_f32 v88, v88
    v_exp_f32 v89, v89
    v_cvt_pk_bf16_f32 v105, v86, v87
    v_exp_f32 v90, v90
    v_exp_f32 v91, v91
    v_cvt_pk_bf16_f32 v106, v88, v89
    v_cvt_pk_bf16_f32 v107, v90, v91
    v_exp_f32 v60, v60
    v_exp_f32 v61, v61
    v_mfma_f32_32x32x16_bf16 v[40:55], v[120:123], v[104:107], v[40:55]
    ds_read_b128 v[120:123], v9 offset:27648
    s_barrier
    s_setprio 3
    v_exp_f32 v62, v62
    v_exp_f32 v63, v63
    v_exp_f32 v64, v64
    v_mfma_f32_32x32x16_bf16 v[76:91], v[108:111], v[16:19], v[24:39]
    ds_read_b128 v[108:111], v9 offset:32768
    s_add_u32 s53, s53, 32768
    s_add_u32 m0, s52, 32768
    v_cvt_pk_bf16_f32 v92, v60, v61
    v_exp_f32 v65, v65
    v_cvt_pk_bf16_f32 v93, v62, v63
    v_exp_f32 v66, v66
    v_smfmac_f32_16x16x64_bf16 v[56:59], v[12:15], v[100:107], v10
    s_waitcnt lgkmcnt(2)
    buffer_load_dwordx4 v8, s[8:11], s53 offen offset:0 sc1 lds
    v_exp_f32 v67, v67
    v_cvt_pk_bf16_f32 v94, v64, v65
    v_exp_f32 v68, v68
    v_mfma_f32_32x32x16_bf16 v[76:91], v[112:115], v[20:23], v[76:91]
    ds_read_b128 v[112:115], v9 offset:33792
    v_cvt_pk_bf16_f32 v95, v66, v67
    v_exp_f32 v69, v69
    v_exp_f32 v70, v70
    v_exp_f32 v71, v71
    v_mfma_f32_32x32x16_bf16 v[40:55], v[116:119], v[92:95], v[40:55]
    s_waitcnt lgkmcnt(1)
    ds_read_b128 v[116:119], v9 offset:30720
    v_cvt_pk_bf16_f32 v96, v68, v69
    v_exp_f32 v72, v72
    v_exp_f32 v73, v73
    v_cvt_pk_bf16_f32 v97, v70, v71
    v_exp_f32 v74, v74
    v_exp_f32 v75, v75
    v_cvt_pk_bf16_f32 v98, v72, v73
    v_cvt_pk_bf16_f32 v99, v74, v75
    v_exp_f32 v76, v76
    v_exp_f32 v77, v77
    v_mfma_f32_32x32x16_bf16 v[40:55], v[120:123], v[96:99], v[40:55]
    ds_read_b128 v[120:123], v9 offset:31744
    v_exp_f32 v78, v78
    v_exp_f32 v79, v79
    v_exp_f32 v80, v80
    v_mfma_f32_32x32x16_bf16 v[60:75], v[108:111], v[16:19], v[24:39]
    ds_read_b128 v[108:111], v9 offset:36864
    v_cvt_pk_bf16_f32 v100, v76, v77
    v_exp_f32 v81, v81
    v_cvt_pk_bf16_f32 v101, v78, v79
    v_exp_f32 v82, v82
    v_smfmac_f32_16x16x64_bf16 v[56:59], v[12:15], v[92:99], v10
    s_waitcnt lgkmcnt(2)
    v_exp_f32 v83, v83
    v_cvt_pk_bf16_f32 v102, v80, v81
    v_exp_f32 v84, v84
    v_mfma_f32_32x32x16_bf16 v[60:75], v[112:115], v[20:23], v[60:75]
    ds_read_b128 v[112:115], v9 offset:37888
    v_cvt_pk_bf16_f32 v103, v82, v83
    v_exp_f32 v85, v85
    v_exp_f32 v86, v86
    v_exp_f32 v87, v87
    v_mfma_f32_32x32x16_bf16 v[40:55], v[116:119], v[100:103], v[40:55]
    s_waitcnt lgkmcnt(1)
    ds_read_b128 v[116:119], v9 offset:34816
    v_cvt_pk_bf16_f32 v104, v84, v85
    v_exp_f32 v88, v88
    v_exp_f32 v89, v89
    v_cvt_pk_bf16_f32 v105, v86, v87
    v_exp_f32 v90, v90
    v_exp_f32 v91, v91
    v_cvt_pk_bf16_f32 v106, v88, v89
    v_cvt_pk_bf16_f32 v107, v90, v91
    v_exp_f32 v60, v60
    v_exp_f32 v61, v61
    v_mfma_f32_32x32x16_bf16 v[40:55], v[120:123], v[104:107], v[40:55]
    ds_read_b128 v[120:123], v9 offset:35840
    v_exp_f32 v62, v62
    v_exp_f32 v63, v63
    v_exp_f32 v64, v64
    v_mfma_f32_32x32x16_bf16 v[76:91], v[108:111], v[16:19], v[24:39]
    ds_read_b128 v[108:111], v9 offset:40960
    v_cvt_pk_bf16_f32 v92, v60, v61
    v_exp_f32 v65, v65
    v_cvt_pk_bf16_f32 v93, v62, v63
    v_exp_f32 v66, v66
    v_smfmac_f32_16x16x64_bf16 v[56:59], v[12:15], v[100:107], v10
    s_waitcnt lgkmcnt(2)
    buffer_load_dwordx4 v8, s[8:11], s53 offen offset:1024 sc1 lds
    v_exp_f32 v67, v67
    v_cvt_pk_bf16_f32 v94, v64, v65
    v_exp_f32 v68, v68
    v_mfma_f32_32x32x16_bf16 v[76:91], v[112:115], v[20:23], v[76:91]
    ds_read_b128 v[112:115], v9 offset:41984
    v_cvt_pk_bf16_f32 v95, v66, v67
    v_exp_f32 v69, v69
    v_exp_f32 v70, v70
    v_exp_f32 v71, v71
    v_mfma_f32_32x32x16_bf16 v[40:55], v[116:119], v[92:95], v[40:55]
    s_waitcnt lgkmcnt(1)
    ds_read_b128 v[116:119], v9 offset:38912
    v_cvt_pk_bf16_f32 v96, v68, v69
    v_exp_f32 v72, v72
    v_exp_f32 v73, v73
    v_cvt_pk_bf16_f32 v97, v70, v71
    v_exp_f32 v74, v74
    v_exp_f32 v75, v75
    v_cvt_pk_bf16_f32 v98, v72, v73
    v_cvt_pk_bf16_f32 v99, v74, v75
    v_exp_f32 v76, v76
    v_exp_f32 v77, v77
    v_mfma_f32_32x32x16_bf16 v[40:55], v[120:123], v[96:99], v[40:55]
    ds_read_b128 v[120:123], v9 offset:39936
    v_exp_f32 v78, v78
    v_exp_f32 v79, v79
    v_exp_f32 v80, v80
    v_mfma_f32_32x32x16_bf16 v[60:75], v[108:111], v[16:19], v[24:39]
    ds_read_b128 v[108:111], v9 offset:45056
    v_cvt_pk_bf16_f32 v100, v76, v77
    v_exp_f32 v81, v81
    v_cvt_pk_bf16_f32 v101, v78, v79
    v_exp_f32 v82, v82
    v_smfmac_f32_16x16x64_bf16 v[56:59], v[12:15], v[92:99], v10
    s_waitcnt lgkmcnt(2)
    v_exp_f32 v83, v83
    v_cvt_pk_bf16_f32 v102, v80, v81
    v_exp_f32 v84, v84
    v_mfma_f32_32x32x16_bf16 v[60:75], v[112:115], v[20:23], v[60:75]
    ds_read_b128 v[112:115], v9 offset:46080
    v_cvt_pk_bf16_f32 v103, v82, v83
    v_exp_f32 v85, v85
    v_exp_f32 v86, v86
    v_exp_f32 v87, v87
    v_mfma_f32_32x32x16_bf16 v[40:55], v[116:119], v[100:103], v[40:55]
    s_waitcnt lgkmcnt(1)
    ds_read_b128 v[116:119], v9 offset:43008
    v_cvt_pk_bf16_f32 v104, v84, v85
    v_exp_f32 v88, v88
    v_exp_f32 v89, v89
    v_cvt_pk_bf16_f32 v105, v86, v87
    v_exp_f32 v90, v90
    v_exp_f32 v91, v91
    v_cvt_pk_bf16_f32 v106, v88, v89
    v_cvt_pk_bf16_f32 v107, v90, v91
    v_exp_f32 v60, v60
    v_exp_f32 v61, v61
    v_mfma_f32_32x32x16_bf16 v[40:55], v[120:123], v[104:107], v[40:55]
    ds_read_b128 v[120:123], v9 offset:44032
    v_exp_f32 v62, v62
    v_exp_f32 v63, v63
    v_exp_f32 v64, v64
    v_mfma_f32_32x32x16_bf16 v[76:91], v[108:111], v[16:19], v[24:39]
    ds_read_b128 v[108:111], v9 offset:49152
    v_cvt_pk_bf16_f32 v92, v60, v61
    v_exp_f32 v65, v65
    v_cvt_pk_bf16_f32 v93, v62, v63
    v_exp_f32 v66, v66
    v_smfmac_f32_16x16x64_bf16 v[56:59], v[12:15], v[100:107], v10
    s_waitcnt lgkmcnt(2)
    buffer_load_dwordx4 v8, s[8:11], s53 offen offset:2048 sc1 lds
    v_exp_f32 v67, v67
    v_cvt_pk_bf16_f32 v94, v64, v65
    v_exp_f32 v68, v68
    v_mfma_f32_32x32x16_bf16 v[76:91], v[112:115], v[20:23], v[76:91]
    ds_read_b128 v[112:115], v9 offset:50176
    v_cvt_pk_bf16_f32 v95, v66, v67
    v_exp_f32 v69, v69
    v_exp_f32 v70, v70
    v_exp_f32 v71, v71
    v_mfma_f32_32x32x16_bf16 v[40:55], v[116:119], v[92:95], v[40:55]
    s_waitcnt lgkmcnt(1)
    ds_read_b128 v[116:119], v9 offset:47104
    v_cvt_pk_bf16_f32 v96, v68, v69
    v_exp_f32 v72, v72
    v_exp_f32 v73, v73
    v_cvt_pk_bf16_f32 v97, v70, v71
    v_exp_f32 v74, v74
    v_exp_f32 v75, v75
    v_cvt_pk_bf16_f32 v98, v72, v73
    v_cvt_pk_bf16_f32 v99, v74, v75
    s_setprio 2
    v_exp_f32 v76, v76
    v_exp_f32 v77, v77
    v_mfma_f32_32x32x16_bf16 v[40:55], v[120:123], v[96:99], v[40:55]
    ds_read_b128 v[120:123], v9 offset:48128
    v_exp_f32 v78, v78
    v_exp_f32 v79, v79
    v_exp_f32 v80, v80
    v_mfma_f32_32x32x16_bf16 v[60:75], v[108:111], v[16:19], v[24:39]
    ds_read_b128 v[108:111], v9 offset:53248
    v_cvt_pk_bf16_f32 v100, v76, v77
    v_exp_f32 v81, v81
    v_cvt_pk_bf16_f32 v101, v78, v79
    v_exp_f32 v82, v82
    v_smfmac_f32_16x16x64_bf16 v[56:59], v[12:15], v[92:99], v10
    s_waitcnt lgkmcnt(2)
    s_waitcnt vmcnt(3)
    v_exp_f32 v83, v83
    v_cvt_pk_bf16_f32 v102, v80, v81
    v_exp_f32 v84, v84
    v_mfma_f32_32x32x16_bf16 v[60:75], v[112:115], v[20:23], v[60:75]
    ds_read_b128 v[112:115], v9 offset:54272
    v_cvt_pk_bf16_f32 v103, v82, v83
    v_exp_f32 v85, v85
    v_exp_f32 v86, v86
    v_exp_f32 v87, v87
    v_mfma_f32_32x32x16_bf16 v[40:55], v[116:119], v[100:103], v[40:55]
    s_waitcnt lgkmcnt(1)
    ds_read_b128 v[116:119], v9 offset:51200
    v_cvt_pk_bf16_f32 v104, v84, v85
    v_exp_f32 v88, v88
    v_exp_f32 v89, v89
    v_cvt_pk_bf16_f32 v105, v86, v87
    v_exp_f32 v90, v90
    v_exp_f32 v91, v91
    v_cvt_pk_bf16_f32 v106, v88, v89
    v_cvt_pk_bf16_f32 v107, v90, v91
    s_setprio 1
    v_exp_f32 v60, v60
    v_exp_f32 v61, v61
    v_mfma_f32_32x32x16_bf16 v[40:55], v[120:123], v[104:107], v[40:55]
    ds_read_b128 v[120:123], v9 offset:52224
    v_exp_f32 v62, v62
    v_exp_f32 v63, v63
    v_exp_f32 v64, v64
    v_mfma_f32_32x32x16_bf16 v[76:91], v[108:111], v[16:19], v[24:39]
    ds_read_b128 v[108:111], v9 offset:57344
    v_cvt_pk_bf16_f32 v92, v60, v61
    v_exp_f32 v65, v65
    v_cvt_pk_bf16_f32 v93, v62, v63
    v_exp_f32 v66, v66
    v_smfmac_f32_16x16x64_bf16 v[56:59], v[12:15], v[100:107], v10
    s_waitcnt lgkmcnt(2)
    buffer_load_dwordx4 v8, s[8:11], s53 offen offset:3072 sc1 lds
    v_exp_f32 v67, v67
    v_cvt_pk_bf16_f32 v94, v64, v65
    v_exp_f32 v68, v68
    v_mfma_f32_32x32x16_bf16 v[76:91], v[112:115], v[20:23], v[76:91]
    ds_read_b128 v[112:115], v9 offset:58368
    v_cvt_pk_bf16_f32 v95, v66, v67
    v_exp_f32 v69, v69
    v_exp_f32 v70, v70
    v_exp_f32 v71, v71
    v_mfma_f32_32x32x16_bf16 v[40:55], v[116:119], v[92:95], v[40:55]
    s_waitcnt lgkmcnt(1)
    ds_read_b128 v[116:119], v9 offset:55296
    v_cvt_pk_bf16_f32 v96, v68, v69
    v_exp_f32 v72, v72
    v_exp_f32 v73, v73
    v_cvt_pk_bf16_f32 v97, v70, v71
    v_exp_f32 v74, v74
    v_exp_f32 v75, v75
    v_cvt_pk_bf16_f32 v98, v72, v73
    v_cvt_pk_bf16_f32 v99, v74, v75
    s_setprio 0
    v_exp_f32 v76, v76
    v_exp_f32 v77, v77
    v_mfma_f32_32x32x16_bf16 v[40:55], v[120:123], v[96:99], v[40:55]
    ds_read_b128 v[120:123], v9 offset:56320
    v_exp_f32 v78, v78
    v_exp_f32 v79, v79
    v_exp_f32 v80, v80
    v_mfma_f32_32x32x16_bf16 v[60:75], v[108:111], v[16:19], v[24:39]
    ds_read_b128 v[108:111], v9 offset:61440
    v_cvt_pk_bf16_f32 v100, v76, v77
    v_exp_f32 v81, v81
    v_cvt_pk_bf16_f32 v101, v78, v79
    v_exp_f32 v82, v82
    v_smfmac_f32_16x16x64_bf16 v[56:59], v[12:15], v[92:99], v10
    s_waitcnt lgkmcnt(2)
    v_exp_f32 v83, v83
    v_cvt_pk_bf16_f32 v102, v80, v81
    v_exp_f32 v84, v84
    v_mfma_f32_32x32x16_bf16 v[60:75], v[112:115], v[20:23], v[60:75]
    ds_read_b128 v[112:115], v9 offset:62464
    v_cvt_pk_bf16_f32 v103, v82, v83
    v_exp_f32 v85, v85
    v_exp_f32 v86, v86
    v_exp_f32 v87, v87
    v_mfma_f32_32x32x16_bf16 v[40:55], v[116:119], v[100:103], v[40:55]
    s_waitcnt lgkmcnt(1)
    ds_read_b128 v[116:119], v9 offset:59392
    v_cvt_pk_bf16_f32 v104, v84, v85
    v_exp_f32 v88, v88
    v_exp_f32 v89, v89
    v_cvt_pk_bf16_f32 v105, v86, v87
    v_exp_f32 v90, v90
    v_exp_f32 v91, v91
    v_cvt_pk_bf16_f32 v106, v88, v89
    v_cvt_pk_bf16_f32 v107, v90, v91
    v_exp_f32 v60, v60
    v_exp_f32 v61, v61
    v_mfma_f32_32x32x16_bf16 v[40:55], v[120:123], v[104:107], v[40:55]
    ds_read_b128 v[120:123], v9 offset:60416
    s_barrier
    s_setprio 3
    v_exp_f32 v62, v62
    v_exp_f32 v63, v63
    v_exp_f32 v64, v64
    v_mfma_f32_32x32x16_bf16 v[76:91], v[108:111], v[16:19], v[24:39]
    ds_read_b128 v[108:111], v8 offset:0
    s_add_u32 s53, s53, 32768
    s_add_u32 m0, s52, 65536
    v_cvt_pk_bf16_f32 v92, v60, v61
    v_exp_f32 v65, v65
    v_cvt_pk_bf16_f32 v93, v62, v63
    v_exp_f32 v66, v66
    v_smfmac_f32_16x16x64_bf16 v[56:59], v[12:15], v[100:107], v10
    s_waitcnt lgkmcnt(2)
    buffer_load_dwordx4 v8, s[8:11], s53 offen offset:0 sc1 lds
    v_exp_f32 v67, v67
    v_cvt_pk_bf16_f32 v94, v64, v65
    v_exp_f32 v68, v68
    v_mfma_f32_32x32x16_bf16 v[76:91], v[112:115], v[20:23], v[76:91]
    ds_read_b128 v[112:115], v8 offset:1024
    v_cvt_pk_bf16_f32 v95, v66, v67
    v_exp_f32 v69, v69
    v_exp_f32 v70, v70
    v_exp_f32 v71, v71
    v_mfma_f32_32x32x16_bf16 v[40:55], v[116:119], v[92:95], v[40:55]
    s_waitcnt lgkmcnt(1)
    ds_read_b128 v[116:119], v9 offset:63488
    v_cvt_pk_bf16_f32 v96, v68, v69
    v_exp_f32 v72, v72
    v_exp_f32 v73, v73
    v_cvt_pk_bf16_f32 v97, v70, v71
    v_exp_f32 v74, v74
    v_exp_f32 v75, v75
    v_cvt_pk_bf16_f32 v98, v72, v73
    v_cvt_pk_bf16_f32 v99, v74, v75
    v_exp_f32 v76, v76
    v_exp_f32 v77, v77
    v_mfma_f32_32x32x16_bf16 v[40:55], v[120:123], v[96:99], v[40:55]
    ds_read_b128 v[120:123], v9 offset:64512
    v_exp_f32 v78, v78
    v_exp_f32 v79, v79
    v_exp_f32 v80, v80
    v_mfma_f32_32x32x16_bf16 v[60:75], v[108:111], v[16:19], v[24:39]
    ds_read_b128 v[108:111], v8 offset:4096
    v_cvt_pk_bf16_f32 v100, v76, v77
    v_exp_f32 v81, v81
    v_cvt_pk_bf16_f32 v101, v78, v79
    v_exp_f32 v82, v82
    v_smfmac_f32_16x16x64_bf16 v[56:59], v[12:15], v[92:99], v10
    s_waitcnt lgkmcnt(2)
    v_exp_f32 v83, v83
    v_cvt_pk_bf16_f32 v102, v80, v81
    v_exp_f32 v84, v84
    v_mfma_f32_32x32x16_bf16 v[60:75], v[112:115], v[20:23], v[60:75]
    ds_read_b128 v[112:115], v8 offset:5120
    v_cvt_pk_bf16_f32 v103, v82, v83
    v_exp_f32 v85, v85
    v_exp_f32 v86, v86
    v_exp_f32 v87, v87
    v_mfma_f32_32x32x16_bf16 v[40:55], v[116:119], v[100:103], v[40:55]
    s_waitcnt lgkmcnt(1)
    ds_read_b128 v[116:119], v8 offset:2048
    v_cvt_pk_bf16_f32 v104, v84, v85
    v_exp_f32 v88, v88
    v_exp_f32 v89, v89
    v_cvt_pk_bf16_f32 v105, v86, v87
    v_exp_f32 v90, v90
    v_exp_f32 v91, v91
    v_cvt_pk_bf16_f32 v106, v88, v89
    v_cvt_pk_bf16_f32 v107, v90, v91
    v_exp_f32 v60, v60
    v_exp_f32 v61, v61
    v_mfma_f32_32x32x16_bf16 v[40:55], v[120:123], v[104:107], v[40:55]
    ds_read_b128 v[120:123], v8 offset:3072
    v_exp_f32 v62, v62
    v_exp_f32 v63, v63
    v_exp_f32 v64, v64
    v_mfma_f32_32x32x16_bf16 v[76:91], v[108:111], v[16:19], v[24:39]
    ds_read_b128 v[108:111], v8 offset:8192
    v_cvt_pk_bf16_f32 v92, v60, v61
    v_exp_f32 v65, v65
    v_cvt_pk_bf16_f32 v93, v62, v63
    v_exp_f32 v66, v66
    v_smfmac_f32_16x16x64_bf16 v[56:59], v[12:15], v[100:107], v10
    s_waitcnt lgkmcnt(2)
    buffer_load_dwordx4 v8, s[8:11], s53 offen offset:1024 sc1 lds
    v_exp_f32 v67, v67
    v_cvt_pk_bf16_f32 v94, v64, v65
    v_exp_f32 v68, v68
    v_mfma_f32_32x32x16_bf16 v[76:91], v[112:115], v[20:23], v[76:91]
    ds_read_b128 v[112:115], v8 offset:9216
    v_cvt_pk_bf16_f32 v95, v66, v67
    v_exp_f32 v69, v69
    v_exp_f32 v70, v70
    v_exp_f32 v71, v71
    v_mfma_f32_32x32x16_bf16 v[40:55], v[116:119], v[92:95], v[40:55]
    s_waitcnt lgkmcnt(1)
    ds_read_b128 v[116:119], v8 offset:6144
    v_cvt_pk_bf16_f32 v96, v68, v69
    v_exp_f32 v72, v72
    v_exp_f32 v73, v73
    v_cvt_pk_bf16_f32 v97, v70, v71
    v_exp_f32 v74, v74
    v_exp_f32 v75, v75
    v_cvt_pk_bf16_f32 v98, v72, v73
    v_cvt_pk_bf16_f32 v99, v74, v75
    v_exp_f32 v76, v76
    v_exp_f32 v77, v77
    v_mfma_f32_32x32x16_bf16 v[40:55], v[120:123], v[96:99], v[40:55]
    ds_read_b128 v[120:123], v8 offset:7168
    v_exp_f32 v78, v78
    v_exp_f32 v79, v79
    v_exp_f32 v80, v80
    v_mfma_f32_32x32x16_bf16 v[60:75], v[108:111], v[16:19], v[24:39]
    ds_read_b128 v[108:111], v8 offset:12288
    v_cvt_pk_bf16_f32 v100, v76, v77
    v_exp_f32 v81, v81
    v_cvt_pk_bf16_f32 v101, v78, v79
    v_exp_f32 v82, v82
    v_smfmac_f32_16x16x64_bf16 v[56:59], v[12:15], v[92:99], v10
    s_waitcnt lgkmcnt(2)
    v_exp_f32 v83, v83
    v_cvt_pk_bf16_f32 v102, v80, v81
    v_exp_f32 v84, v84
    v_mfma_f32_32x32x16_bf16 v[60:75], v[112:115], v[20:23], v[60:75]
    ds_read_b128 v[112:115], v8 offset:13312
    v_cvt_pk_bf16_f32 v103, v82, v83
    v_exp_f32 v85, v85
    v_exp_f32 v86, v86
    v_exp_f32 v87, v87
    v_mfma_f32_32x32x16_bf16 v[40:55], v[116:119], v[100:103], v[40:55]
    s_waitcnt lgkmcnt(1)
    ds_read_b128 v[116:119], v8 offset:10240
    v_cvt_pk_bf16_f32 v104, v84, v85
    v_exp_f32 v88, v88
    v_exp_f32 v89, v89
    v_cvt_pk_bf16_f32 v105, v86, v87
    v_exp_f32 v90, v90
    v_exp_f32 v91, v91
    v_cvt_pk_bf16_f32 v106, v88, v89
    v_cvt_pk_bf16_f32 v107, v90, v91
    v_exp_f32 v60, v60
    v_exp_f32 v61, v61
    v_mfma_f32_32x32x16_bf16 v[40:55], v[120:123], v[104:107], v[40:55]
    ds_read_b128 v[120:123], v8 offset:11264
    v_exp_f32 v62, v62
    v_exp_f32 v63, v63
    v_exp_f32 v64, v64
    v_mfma_f32_32x32x16_bf16 v[76:91], v[108:111], v[16:19], v[24:39]
    ds_read_b128 v[108:111], v8 offset:16384
    v_cvt_pk_bf16_f32 v92, v60, v61
    v_exp_f32 v65, v65
    v_cvt_pk_bf16_f32 v93, v62, v63
    v_exp_f32 v66, v66
    v_smfmac_f32_16x16x64_bf16 v[56:59], v[12:15], v[100:107], v10
    s_waitcnt lgkmcnt(2)
    buffer_load_dwordx4 v8, s[8:11], s53 offen offset:2048 sc1 lds
    v_exp_f32 v67, v67
    v_cvt_pk_bf16_f32 v94, v64, v65
    v_exp_f32 v68, v68
    v_mfma_f32_32x32x16_bf16 v[76:91], v[112:115], v[20:23], v[76:91]
    ds_read_b128 v[112:115], v8 offset:17408
    v_cvt_pk_bf16_f32 v95, v66, v67
    v_exp_f32 v69, v69
    v_exp_f32 v70, v70
    v_exp_f32 v71, v71
    v_mfma_f32_32x32x16_bf16 v[40:55], v[116:119], v[92:95], v[40:55]
    s_waitcnt lgkmcnt(1)
    ds_read_b128 v[116:119], v8 offset:14336
    v_cvt_pk_bf16_f32 v96, v68, v69
    v_exp_f32 v72, v72
    v_exp_f32 v73, v73
    v_cvt_pk_bf16_f32 v97, v70, v71
    v_exp_f32 v74, v74
    v_exp_f32 v75, v75
    v_cvt_pk_bf16_f32 v98, v72, v73
    v_cvt_pk_bf16_f32 v99, v74, v75
    s_setprio 2
    v_exp_f32 v76, v76
    v_exp_f32 v77, v77
    v_mfma_f32_32x32x16_bf16 v[40:55], v[120:123], v[96:99], v[40:55]
    ds_read_b128 v[120:123], v8 offset:15360
    v_exp_f32 v78, v78
    v_exp_f32 v79, v79
    v_exp_f32 v80, v80
    v_mfma_f32_32x32x16_bf16 v[60:75], v[108:111], v[16:19], v[24:39]
    ds_read_b128 v[108:111], v8 offset:20480
    v_cvt_pk_bf16_f32 v100, v76, v77
    v_exp_f32 v81, v81
    v_cvt_pk_bf16_f32 v101, v78, v79
    v_exp_f32 v82, v82
    v_smfmac_f32_16x16x64_bf16 v[56:59], v[12:15], v[92:99], v10
    s_waitcnt lgkmcnt(2)
    s_waitcnt vmcnt(3)
    v_exp_f32 v83, v83
    v_cvt_pk_bf16_f32 v102, v80, v81
    v_exp_f32 v84, v84
    v_mfma_f32_32x32x16_bf16 v[60:75], v[112:115], v[20:23], v[60:75]
    ds_read_b128 v[112:115], v8 offset:21504
    v_cvt_pk_bf16_f32 v103, v82, v83
    v_exp_f32 v85, v85
    v_exp_f32 v86, v86
    v_exp_f32 v87, v87
    v_mfma_f32_32x32x16_bf16 v[40:55], v[116:119], v[100:103], v[40:55]
    s_waitcnt lgkmcnt(1)
    ds_read_b128 v[116:119], v8 offset:18432
    v_cvt_pk_bf16_f32 v104, v84, v85
    v_exp_f32 v88, v88
    v_exp_f32 v89, v89
    v_cvt_pk_bf16_f32 v105, v86, v87
    v_exp_f32 v90, v90
    v_exp_f32 v91, v91
    v_cvt_pk_bf16_f32 v106, v88, v89
    v_cvt_pk_bf16_f32 v107, v90, v91
    s_setprio 1
    v_exp_f32 v60, v60
    v_exp_f32 v61, v61
    v_mfma_f32_32x32x16_bf16 v[40:55], v[120:123], v[104:107], v[40:55]
    ds_read_b128 v[120:123], v8 offset:19456
    v_exp_f32 v62, v62
    v_exp_f32 v63, v63
    v_exp_f32 v64, v64
    v_mfma_f32_32x32x16_bf16 v[76:91], v[108:111], v[16:19], v[24:39]
    ds_read_b128 v[108:111], v8 offset:24576
    v_cvt_pk_bf16_f32 v92, v60, v61
    v_exp_f32 v65, v65
    v_cvt_pk_bf16_f32 v93, v62, v63
    v_exp_f32 v66, v66
    v_smfmac_f32_16x16x64_bf16 v[56:59], v[12:15], v[100:107], v10
    s_waitcnt lgkmcnt(2)
    buffer_load_dwordx4 v8, s[8:11], s53 offen offset:3072 sc1 lds
    v_exp_f32 v67, v67
    v_cvt_pk_bf16_f32 v94, v64, v65
    v_exp_f32 v68, v68
    v_mfma_f32_32x32x16_bf16 v[76:91], v[112:115], v[20:23], v[76:91]
    ds_read_b128 v[112:115], v8 offset:25600
    v_cvt_pk_bf16_f32 v95, v66, v67
    v_exp_f32 v69, v69
    v_exp_f32 v70, v70
    v_exp_f32 v71, v71
    v_mfma_f32_32x32x16_bf16 v[40:55], v[116:119], v[92:95], v[40:55]
    s_waitcnt lgkmcnt(1)
    ds_read_b128 v[116:119], v8 offset:22528
    v_cvt_pk_bf16_f32 v96, v68, v69
    v_exp_f32 v72, v72
    v_exp_f32 v73, v73
    v_cvt_pk_bf16_f32 v97, v70, v71
    v_exp_f32 v74, v74
    v_exp_f32 v75, v75
    v_cvt_pk_bf16_f32 v98, v72, v73
    v_cvt_pk_bf16_f32 v99, v74, v75
    s_setprio 0
    v_exp_f32 v76, v76
    v_exp_f32 v77, v77
    v_mfma_f32_32x32x16_bf16 v[40:55], v[120:123], v[96:99], v[40:55]
    ds_read_b128 v[120:123], v8 offset:23552
    v_exp_f32 v78, v78
    v_exp_f32 v79, v79
    v_exp_f32 v80, v80
    v_mfma_f32_32x32x16_bf16 v[60:75], v[108:111], v[16:19], v[24:39]
    ds_read_b128 v[108:111], v8 offset:28672
    v_cvt_pk_bf16_f32 v100, v76, v77
    v_exp_f32 v81, v81
    v_cvt_pk_bf16_f32 v101, v78, v79
    v_exp_f32 v82, v82
    v_smfmac_f32_16x16x64_bf16 v[56:59], v[12:15], v[92:99], v10
    s_waitcnt lgkmcnt(2)
    v_exp_f32 v83, v83
    v_cvt_pk_bf16_f32 v102, v80, v81
    v_exp_f32 v84, v84
    v_mfma_f32_32x32x16_bf16 v[60:75], v[112:115], v[20:23], v[60:75]
    ds_read_b128 v[112:115], v8 offset:29696
    v_cvt_pk_bf16_f32 v103, v82, v83
    v_exp_f32 v85, v85
    v_exp_f32 v86, v86
    v_exp_f32 v87, v87
    v_mfma_f32_32x32x16_bf16 v[40:55], v[116:119], v[100:103], v[40:55]
    s_waitcnt lgkmcnt(1)
    ds_read_b128 v[116:119], v8 offset:26624
    v_cvt_pk_bf16_f32 v104, v84, v85
    v_exp_f32 v88, v88
    v_exp_f32 v89, v89
    v_cvt_pk_bf16_f32 v105, v86, v87
    v_exp_f32 v90, v90
    v_exp_f32 v91, v91
    v_cvt_pk_bf16_f32 v106, v88, v89
    v_cvt_pk_bf16_f32 v107, v90, v91
    v_exp_f32 v60, v60
    v_exp_f32 v61, v61
    v_mfma_f32_32x32x16_bf16 v[40:55], v[120:123], v[104:107], v[40:55]
    ds_read_b128 v[120:123], v8 offset:27648
    s_barrier
    s_cmp_eq_u32 s45, 0
    s_cbranch_scc1 att_lo0
    s_setprio 3
    s_lshl_b32 s40, s7, 12
    v_mov_b32 v2, s40
    v_mov_b32 v3, 0
    ds_write_b32 v2, v3
att_lo0:
    v_exp_f32 v62, v62
    v_exp_f32 v63, v63
    v_exp_f32 v64, v64
    v_mfma_f32_32x32x16_bf16 v[76:91], v[108:111], v[16:19], v[24:39]
    ds_read_b128 v[108:111], v8 offset:32768
    s_add_u32 s53, s53, 32768
    s_add_u32 m0, s52, 98304
    v_cvt_pk_bf16_f32 v92, v60, v61
    v_exp_f32 v65, v65
    v_cvt_pk_bf16_f32 v93, v62, v63
    v_exp_f32 v66, v66
    v_smfmac_f32_16x16x64_bf16 v[56:59], v[12:15], v[100:107], v10
    s_waitcnt lgkmcnt(2)
    buffer_load_dwordx4 v8, s[8:11], s53 offen offset:0 sc1 lds
    v_exp_f32 v67, v67
    v_cvt_pk_bf16_f32 v94, v64, v65
    v_exp_f32 v68, v68
    v_mfma_f32_32x32x16_bf16 v[76:91], v[112:115], v[20:23], v[76:91]
    buffer_load_dwordx4 v8, s[8:11], s53 offen offset:1024 sc1 lds
    ds_read_b128 v[112:115], v8 offset:33792
    v_cvt_pk_bf16_f32 v95, v66, v67
    v_exp_f32 v69, v69
    v_exp_f32 v70, v70
    v_exp_f32 v71, v71
    v_mfma_f32_32x32x16_bf16 v[40:55], v[116:119], v[92:95], v[40:55]
    s_waitcnt lgkmcnt(1)
    buffer_load_dwordx4 v8, s[8:11], s53 offen offset:2048 sc1 lds
    ds_read_b128 v[116:119], v8 offset:30720
    v_cvt_pk_bf16_f32 v96, v68, v69
    v_exp_f32 v72, v72
    v_exp_f32 v73, v73
    v_cvt_pk_bf16_f32 v97, v70, v71
    buffer_load_dwordx4 v8, s[8:11], s53 offen offset:3072 sc1 lds
    v_exp_f32 v74, v74
    v_exp_f32 v75, v75
    v_cvt_pk_bf16_f32 v98, v72, v73
    v_cvt_pk_bf16_f32 v99, v74, v75
    v_exp_f32 v76, v76
    v_exp_f32 v77, v77
    v_mfma_f32_32x32x16_bf16 v[40:55], v[120:123], v[96:99], v[40:55]
    ds_read_b128 v[120:123], v8 offset:31744
    v_exp_f32 v78, v78
    v_exp_f32 v79, v79
    v_exp_f32 v80, v80
    v_mfma_f32_32x32x16_bf16 v[60:75], v[108:111], v[16:19], v[24:39]
    ds_read_b128 v[108:111], v8 offset:36864
    v_cvt_pk_bf16_f32 v100, v76, v77
    v_exp_f32 v81, v81
    v_cvt_pk_bf16_f32 v101, v78, v79
    v_exp_f32 v82, v82
    v_smfmac_f32_16x16x64_bf16 v[56:59], v[12:15], v[92:99], v10
    s_waitcnt lgkmcnt(2)
    v_exp_f32 v83, v83
    v_cvt_pk_bf16_f32 v102, v80, v81
    v_exp_f32 v84, v84
    v_mfma_f32_32x32x16_bf16 v[60:75], v[112:115], v[20:23], v[60:75]
    ds_read_b128 v[112:115], v8 offset:37888
    v_cvt_pk_bf16_f32 v103, v82, v83
    v_exp_f32 v85, v85
    v_exp_f32 v86, v86
    v_exp_f32 v87, v87
    v_mfma_f32_32x32x16_bf16 v[40:55], v[116:119], v[100:103], v[40:55]
    s_waitcnt lgkmcnt(1)
    ds_read_b128 v[116:119], v8 offset:34816
    v_cvt_pk_bf16_f32 v104, v84, v85
    v_exp_f32 v88, v88
    v_exp_f32 v89, v89
    v_cvt_pk_bf16_f32 v105, v86, v87
    v_exp_f32 v90, v90
    v_exp_f32 v91, v91
    v_cvt_pk_bf16_f32 v106, v88, v89
    v_cvt_pk_bf16_f32 v107, v90, v91
    v_exp_f32 v60, v60
    v_exp_f32 v61, v61
    v_mfma_f32_32x32x16_bf16 v[40:55], v[120:123], v[104:107], v[40:55]
    ds_read_b128 v[120:123], v8 offset:35840
    v_exp_f32 v62, v62
    v_exp_f32 v63, v63
    v_exp_f32 v64, v64
    v_mfma_f32_32x32x16_bf16 v[76:91], v[108:111], v[16:19], v[24:39]
    ds_read_b128 v[108:111], v8 offset:40960
    v_cvt_pk_bf16_f32 v92, v60, v61
    v_exp_f32 v65, v65
    v_cvt_pk_bf16_f32 v93, v62, v63
    v_exp_f32 v66, v66
    v_smfmac_f32_16x16x64_bf16 v[56:59], v[12:15], v[100:107], v10
    s_waitcnt lgkmcnt(2)
    v_exp_f32 v67, v67
    v_cvt_pk_bf16_f32 v94, v64, v65
    v_exp_f32 v68, v68
    v_mfma_f32_32x32x16_bf16 v[76:91], v[112:115], v[20:23], v[76:91]
    ds_read_b128 v[112:115], v8 offset:41984
    v_cvt_pk_bf16_f32 v95, v66, v67
    v_exp_f32 v69, v69
    v_exp_f32 v70, v70
    v_exp_f32 v71, v71
    v_mfma_f32_32x32x16_bf16 v[40:55], v[116:119], v[92:95], v[40:55]
    s_waitcnt lgkmcnt(1)
    ds_read_b128 v[116:119], v8 offset:38912
    v_cvt_pk_bf16_f32 v96, v68, v69
    v_exp_f32 v72, v72
    v_exp_f32 v73, v73
    v_cvt_pk_bf16_f32 v97, v70, v71
    v_exp_f32 v74, v74
    v_exp_f32 v75, v75
    v_cvt_pk_bf16_f32 v98, v72, v73
    v_cvt_pk_bf16_f32 v99, v74, v75
    v_exp_f32 v76, v76
    v_exp_f32 v77, v77
    s_cmp_lg_u32 s45, 0
    v_mfma_f32_32x32x16_bf16 v[40:55], v[120:123], v[96:99], v[40:55]
    ds_read_b128 v[120:123], v8 offset:39936
    s_cbranch_scc1 att_nb00
    s_waitcnt vmcnt(0)
    s_barrier
att_nb00:
    v_exp_f32 v78, v78
    v_exp_f32 v79, v79
    v_exp_f32 v80, v80
    v_mfma_f32_32x32x16_bf16 v[60:75], v[108:111], v[16:19], v[24:39]
    ds_read_b128 v[108:111], v8 offset:45056
    v_cvt_pk_bf16_f32 v100, v76, v77
    v_exp_f32 v81, v81
    v_cvt_pk_bf16_f32 v101, v78, v79
    v_exp_f32 v82, v82
    v_smfmac_f32_16x16x64_bf16 v[56:59], v[12:15], v[92:99], v10
    s_waitcnt lgkmcnt(2)
    v_exp_f32 v83, v83
    v_cvt_pk_bf16_f32 v102, v80, v81
    v_exp_f32 v84, v84
    v_mfma_f32_32x32x16_bf16 v[60:75], v[112:115], v[20:23], v[60:75]
    ds_read_b128 v[112:115], v8 offset:46080
    v_cvt_pk_bf16_f32 v103, v82, v83
    v_exp_f32 v85, v85
    v_exp_f32 v86, v86
    v_exp_f32 v87, v87
    v_mfma_f32_32x32x16_bf16 v[40:55], v[116:119], v[100:103], v[40:55]
    s_waitcnt lgkmcnt(1)
    ds_read_b128 v[116:119], v8 offset:43008
    v_cvt_pk_bf16_f32 v104, v84, v85
    v_exp_f32 v88, v88
    v_exp_f32 v89, v89
    v_cvt_pk_bf16_f32 v105, v86, v87
    v_exp_f32 v90, v90
    v_exp_f32 v91, v91
    v_cvt_pk_bf16_f32 v106, v88, v89
    v_cvt_pk_bf16_f32 v107, v90, v91
    v_exp_f32 v60, v60
    v_exp_f32 v61, v61
    v_mfma_f32_32x32x16_bf16 v[40:55], v[120:123], v[104:107], v[40:55]
    ds_read_b128 v[120:123], v8 offset:44032
    v_exp_f32 v62, v62
    v_exp_f32 v63, v63
    v_exp_f32 v64, v64
    v_mfma_f32_32x32x16_bf16 v[76:91], v[108:111], v[16:19], v[24:39]
    ds_read_b128 v[108:111], v8 offset:49152
    v_cvt_pk_bf16_f32 v92, v60, v61
    v_exp_f32 v65, v65
    v_cvt_pk_bf16_f32 v93, v62, v63
    v_exp_f32 v66, v66
    v_smfmac_f32_16x16x64_bf16 v[56:59], v[12:15], v[100:107], v10
    s_waitcnt lgkmcnt(2)
    v_exp_f32 v67, v67
    v_cvt_pk_bf16_f32 v94, v64, v65
    v_exp_f32 v68, v68
    v_mfma_f32_32x32x16_bf16 v[76:91], v[112:115], v[20:23], v[76:91]
    ds_read_b128 v[112:115], v8 offset:50176
    v_cvt_pk_bf16_f32 v95, v66, v67
    v_exp_f32 v69, v69
    v_exp_f32 v70, v70
    v_exp_f32 v71, v71
    v_mfma_f32_32x32x16_bf16 v[40:55], v[116:119], v[92:95], v[40:55]
    s_waitcnt lgkmcnt(1)
    ds_read_b128 v[116:119], v8 offset:47104
    v_cvt_pk_bf16_f32 v96, v68, v69
    v_exp_f32 v72, v72
    v_exp_f32 v73, v73
    v_cvt_pk_bf16_f32 v97, v70, v71
    v_exp_f32 v74, v74
    v_exp_f32 v75, v75
    v_cvt_pk_bf16_f32 v98, v72, v73
    v_cvt_pk_bf16_f32 v99, v74, v75
    v_exp_f32 v76, v76
    v_exp_f32 v77, v77
    v_mfma_f32_32x32x16_bf16 v[40:55], v[120:123], v[96:99], v[40:55]
    ds_read_b128 v[120:123], v8 offset:48128
    v_exp_f32 v78, v78
    v_exp_f32 v79, v79
    v_exp_f32 v80, v80
    v_mfma_f32_32x32x16_bf16 v[60:75], v[108:111], v[16:19], v[24:39]
    ds_read_b128 v[108:111], v8 offset:53248
    v_cvt_pk_bf16_f32 v100, v76, v77
    v_exp_f32 v81, v81
    v_cvt_pk_bf16_f32 v101, v78, v79
    v_exp_f32 v82, v82
    v_smfmac_f32_16x16x64_bf16 v[56:59], v[12:15], v[92:99], v10
    s_waitcnt lgkmcnt(2)
    v_exp_f32 v83, v83
    v_cvt_pk_bf16_f32 v102, v80, v81
    v_exp_f32 v84, v84
    v_mfma_f32_32x32x16_bf16 v[60:75], v[112:115], v[20:23], v[60:75]
    ds_read_b128 v[112:115], v8 offset:54272
    v_cvt_pk_bf16_f32 v103, v82, v83
    v_exp_f32 v85, v85
    v_exp_f32 v86, v86
    v_exp_f32 v87, v87
    v_mfma_f32_32x32x16_bf16 v[40:55], v[116:119], v[100:103], v[40:55]
    s_waitcnt lgkmcnt(1)
    ds_read_b128 v[116:119], v8 offset:51200
    v_cvt_pk_bf16_f32 v104, v84, v85
    v_exp_f32 v88, v88
    v_exp_f32 v89, v89
    v_cvt_pk_bf16_f32 v105, v86, v87
    v_exp_f32 v90, v90
    v_exp_f32 v91, v91
    v_cvt_pk_bf16_f32 v106, v88, v89
    v_cvt_pk_bf16_f32 v107, v90, v91
    v_exp_f32 v60, v60
    v_exp_f32 v61, v61
    v_mfma_f32_32x32x16_bf16 v[40:55], v[120:123], v[104:107], v[40:55]
    ds_read_b128 v[120:123], v8 offset:52224
    v_exp_f32 v62, v62
    v_exp_f32 v63, v63
    v_exp_f32 v64, v64
    v_mfma_f32_32x32x16_bf16 v[76:91], v[108:111], v[16:19], v[24:39]
    ds_read_b128 v[108:111], v8 offset:57344
    v_cvt_pk_bf16_f32 v92, v60, v61
    v_exp_f32 v65, v65
    v_cvt_pk_bf16_f32 v93, v62, v63
    v_exp_f32 v66, v66
    v_smfmac_f32_16x16x64_bf16 v[56:59], v[12:15], v[100:107], v10
    s_waitcnt lgkmcnt(2)
    v_exp_f32 v67, v67
    v_cvt_pk_bf16_f32 v94, v64, v65
    v_exp_f32 v68, v68
    v_mfma_f32_32x32x16_bf16 v[76:91], v[112:115], v[20:23], v[76:91]
    ds_read_b128 v[112:115], v8 offset:58368
    v_cvt_pk_bf16_f32 v95, v66, v67
    v_exp_f32 v69, v69
    v_exp_f32 v70, v70
    v_exp_f32 v71, v71
    v_mfma_f32_32x32x16_bf16 v[40:55], v[116:119], v[92:95], v[40:55]
    s_waitcnt lgkmcnt(1)
    ds_read_b128 v[116:119], v8 offset:55296
    v_cvt_pk_bf16_f32 v96, v68, v69
    v_exp_f32 v72, v72
    v_exp_f32 v73, v73
    v_cvt_pk_bf16_f32 v97, v70, v71
    v_exp_f32 v74, v74
    v_exp_f32 v75, v75
    v_cvt_pk_bf16_f32 v98, v72, v73
    v_cvt_pk_bf16_f32 v99, v74, v75
    v_exp_f32 v76, v76
    v_exp_f32 v77, v77
    v_mfma_f32_32x32x16_bf16 v[40:55], v[120:123], v[96:99], v[40:55]
    ds_read_b128 v[120:123], v8 offset:56320
    v_exp_f32 v78, v78
    v_exp_f32 v79, v79
    v_exp_f32 v80, v80
    v_mfma_f32_32x32x16_bf16 v[60:75], v[108:111], v[16:19], v[24:39]
    ds_read_b128 v[108:111], v8 offset:61440
    v_cvt_pk_bf16_f32 v100, v76, v77
    v_exp_f32 v81, v81
    v_cvt_pk_bf16_f32 v101, v78, v79
    v_exp_f32 v82, v82
    v_smfmac_f32_16x16x64_bf16 v[56:59], v[12:15], v[92:99], v10
    s_waitcnt lgkmcnt(2)
    v_exp_f32 v83, v83
    v_cvt_pk_bf16_f32 v102, v80, v81
    v_exp_f32 v84, v84
    v_mfma_f32_32x32x16_bf16 v[60:75], v[112:115], v[20:23], v[60:75]
    ds_read_b128 v[112:115], v8 offset:62464
    v_cvt_pk_bf16_f32 v103, v82, v83
    v_exp_f32 v85, v85
    v_exp_f32 v86, v86
    v_exp_f32 v87, v87
    v_mfma_f32_32x32x16_bf16 v[40:55], v[116:119], v[100:103], v[40:55]
    s_waitcnt lgkmcnt(1)
    ds_read_b128 v[116:119], v8 offset:59392
    v_cvt_pk_bf16_f32 v104, v84, v85
    v_exp_f32 v88, v88
    v_exp_f32 v89, v89
    v_cvt_pk_bf16_f32 v105, v86, v87
    v_exp_f32 v90, v90
    v_exp_f32 v91, v91
    v_cvt_pk_bf16_f32 v106, v88, v89
    v_cvt_pk_bf16_f32 v107, v90, v91
    v_exp_f32 v60, v60
    v_exp_f32 v61, v61
    s_cmp_lg_u32 s45, 1
    v_mfma_f32_32x32x16_bf16 v[40:55], v[120:123], v[104:107], v[40:55]
    ds_read_b128 v[120:123], v8 offset:60416
    s_cbranch_scc1 att_nb10
    s_waitcnt vmcnt(0)
    s_barrier
att_nb10:
    v_exp_f32 v62, v62
    v_exp_f32 v63, v63
    v_exp_f32 v64, v64
    v_mfma_f32_32x32x16_bf16 v[76:91], v[108:111], v[16:19], v[24:39]
    ds_read_b128 v[108:111], v9 offset:0
    v_cvt_pk_bf16_f32 v92, v60, v61
    v_exp_f32 v65, v65
    v_cvt_pk_bf16_f32 v93, v62, v63
    v_exp_f32 v66, v66
    v_smfmac_f32_16x16x64_bf16 v[56:59], v[12:15], v[100:107], v10
    s_waitcnt lgkmcnt(2)
    v_exp_f32 v67, v67
    v_cvt_pk_bf16_f32 v94, v64, v65
    v_exp_f32 v68, v68
    v_mfma_f32_32x32x16_bf16 v[76:91], v[112:115], v[20:23], v[76:91]
    ds_read_b128 v[112:115], v9 offset:1024
    v_cvt_pk_bf16_f32 v95, v66, v67
    v_exp_f32 v69, v69
    v_exp_f32 v70, v70
    v_exp_f32 v71, v71
    v_mfma_f32_32x32x16_bf16 v[40:55], v[116:119], v[92:95], v[40:55]
    s_waitcnt lgkmcnt(1)
    ds_read_b128 v[116:119], v8 offset:63488
    v_cvt_pk_bf16_f32 v96, v68, v69
    v_exp_f32 v72, v72
    v_exp_f32 v73, v73
    v_cvt_pk_bf16_f32 v97, v70, v71
    v_exp_f32 v74, v74
    v_exp_f32 v75, v75
    v_cvt_pk_bf16_f32 v98, v72, v73
    v_cvt_pk_bf16_f32 v99, v74, v75
    v_exp_f32 v76, v76
    v_exp_f32 v77, v77
    v_mfma_f32_32x32x16_bf16 v[40:55], v[120:123], v[96:99], v[40:55]
    ds_read_b128 v[120:123], v8 offset:64512
    v_exp_f32 v78, v78
    v_exp_f32 v79, v79
    v_exp_f32 v80, v80
    v_mfma_f32_32x32x16_bf16 v[60:75], v[108:111], v[16:19], v[24:39]
    ds_read_b128 v[108:111], v9 offset:4096
    v_cvt_pk_bf16_f32 v100, v76, v77
    v_exp_f32 v81, v81
    v_cvt_pk_bf16_f32 v101, v78, v79
    v_exp_f32 v82, v82
    v_smfmac_f32_16x16x64_bf16 v[56:59], v[12:15], v[92:99], v10
    s_waitcnt lgkmcnt(2)
    v_exp_f32 v83, v83
    v_cvt_pk_bf16_f32 v102, v80, v81
    v_exp_f32 v84, v84
    v_mfma_f32_32x32x16_bf16 v[60:75], v[112:115], v[20:23], v[60:75]
    ds_read_b128 v[112:115], v9 offset:5120
    v_cvt_pk_bf16_f32 v103, v82, v83
    v_exp_f32 v85, v85
    v_exp_f32 v86, v86
    v_exp_f32 v87, v87
    v_mfma_f32_32x32x16_bf16 v[40:55], v[116:119], v[100:103], v[40:55]
    s_waitcnt lgkmcnt(1)
    ds_read_b128 v[116:119], v9 offset:2048
    v_cvt_pk_bf16_f32 v104, v84, v85
    v_exp_f32 v88, v88
    v_exp_f32 v89, v89
    v_cvt_pk_bf16_f32 v105, v86, v87
    v_exp_f32 v90, v90
    v_exp_f32 v91, v91
    v_cvt_pk_bf16_f32 v106, v88, v89
    v_cvt_pk_bf16_f32 v107, v90, v91
att_steps6:
    v_exp_f32 v60, v60
    v_exp_f32 v61, v61
    v_mfma_f32_32x32x16_bf16 v[40:55], v[120:123], v[104:107], v[40:55]
    ds_read_b128 v[120:123], v9 offset:3072
    v_exp_f32 v62, v62
    v_exp_f32 v63, v63
    v_exp_f32 v64, v64
    v_mfma_f32_32x32x16_bf16 v[76:91], v[108:111], v[16:19], v[24:39]
    ds_read_b128 v[108:111], v9 offset:8192
    v_cvt_pk_bf16_f32 v92, v60, v61
    v_exp_f32 v65, v65
    v_cvt_pk_bf16_f32 v93, v62, v63
    v_exp_f32 v66, v66
    v_smfmac_f32_16x16x64_bf16 v[56:59], v[12:15], v[100:107], v10
    s_waitcnt lgkmcnt(2)
    v_exp_f32 v67, v67
    v_cvt_pk_bf16_f32 v94, v64, v65
    v_exp_f32 v68, v68
    v_mfma_f32_32x32x16_bf16 v[76:91], v[112:115], v[20:23], v[76:91]
    ds_read_b128 v[112:115], v9 offset:9216
    v_cvt_pk_bf16_f32 v95, v66, v67
    v_exp_f32 v69, v69
    v_exp_f32 v70, v70
    v_exp_f32 v71, v71
    v_mfma_f32_32x32x16_bf16 v[40:55], v[116:119], v[92:95], v[40:55]
    s_waitcnt lgkmcnt(1)
    ds_read_b128 v[116:119], v9 offset:6144
    v_cvt_pk_bf16_f32 v96, v68, v69
    v_exp_f32 v72, v72
    v_exp_f32 v73, v73
    v_cvt_pk_bf16_f32 v97, v70, v71
    v_exp_f32 v74, v74
    v_exp_f32 v75, v75
    v_cvt_pk_bf16_f32 v98, v72, v73
    v_cvt_pk_bf16_f32 v99, v74, v75
    v_exp_f32 v76, v76
    v_exp_f32 v77, v77
    v_mfma_f32_32x32x16_bf16 v[40:55], v[120:123], v[96:99], v[40:55]
    ds_read_b128 v[120:123], v9 offset:7168
    v_exp_f32 v78, v78
    v_exp_f32 v79, v79
    v_exp_f32 v80, v80
    v_mfma_f32_32x32x16_bf16 v[60:75], v[108:111], v[16:19], v[24:39]
    ds_read_b128 v[108:111], v9 offset:12288
    v_cvt_pk_bf16_f32 v100, v76, v77
    v_exp_f32 v81, v81
    v_cvt_pk_bf16_f32 v101, v78, v79
    v_exp_f32 v82, v82
    v_smfmac_f32_16x16x64_bf16 v[56:59], v[12:15], v[92:99], v10
    s_waitcnt lgkmcnt(2)
    v_exp_f32 v83, v83
    v_cvt_pk_bf16_f32 v102, v80, v81
    v_exp_f32 v84, v84
    v_mfma_f32_32x32x16_bf16 v[60:75], v[112:115], v[20:23], v[60:75]
    ds_read_b128 v[112:115], v9 offset:13312
    v_cvt_pk_bf16_f32 v103, v82, v83
    v_exp_f32 v85, v85
    v_exp_f32 v86, v86
    v_exp_f32 v87, v87
    v_mfma_f32_32x32x16_bf16 v[40:55], v[116:119], v[100:103], v[40:55]
    s_waitcnt lgkmcnt(1)
    ds_read_b128 v[116:119], v9 offset:10240
    v_cvt_pk_bf16_f32 v104, v84, v85
    v_exp_f32 v88, v88
    v_exp_f32 v89, v89
    v_cvt_pk_bf16_f32 v105, v86, v87
    v_exp_f32 v90, v90
    v_exp_f32 v91, v91
    v_cvt_pk_bf16_f32 v106, v88, v89
    v_cvt_pk_bf16_f32 v107, v90, v91
    v_exp_f32 v60, v60
    v_exp_f32 v61, v61
    v_mfma_f32_32x32x16_bf16 v[40:55], v[120:123], v[104:107], v[40:55]
    ds_read_b128 v[120:123], v9 offset:11264
    v_exp_f32 v62, v62
    v_exp_f32 v63, v63
    v_exp_f32 v64, v64
    v_mfma_f32_32x32x16_bf16 v[76:91], v[108:111], v[16:19], v[24:39]
    ds_read_b128 v[108:111], v9 offset:16384
    v_cvt_pk_bf16_f32 v92, v60, v61
    v_exp_f32 v65, v65
    v_cvt_pk_bf16_f32 v93, v62, v63
    v_exp_f32 v66, v66
    v_smfmac_f32_16x16x64_bf16 v[56:59], v[12:15], v[100:107], v10
    s_waitcnt lgkmcnt(2)
    v_exp_f32 v67, v67
    v_cvt_pk_bf16_f32 v94, v64, v65
    v_exp_f32 v68, v68
    v_mfma_f32_32x32x16_bf16 v[76:91], v[112:115], v[20:23], v[76:91]
    ds_read_b128 v[112:115], v9 offset:17408
    v_cvt_pk_bf16_f32 v95, v66, v67
    v_exp_f32 v69, v69
    v_exp_f32 v70, v70
    v_exp_f32 v71, v71
    v_mfma_f32_32x32x16_bf16 v[40:55], v[116:119], v[92:95], v[40:55]
    s_waitcnt lgkmcnt(1)
    ds_read_b128 v[116:119], v9 offset:14336
    v_cvt_pk_bf16_f32 v96, v68, v69
    v_exp_f32 v72, v72
    v_exp_f32 v73, v73
    v_cvt_pk_bf16_f32 v97, v70, v71
    v_exp_f32 v74, v74
    v_exp_f32 v75, v75
    v_cvt_pk_bf16_f32 v98, v72, v73
    v_cvt_pk_bf16_f32 v99, v74, v75
    v_exp_f32 v76, v76
    v_exp_f32 v77, v77
    v_mfma_f32_32x32x16_bf16 v[40:55], v[120:123], v[96:99], v[40:55]
    ds_read_b128 v[120:123], v9 offset:15360
    v_exp_f32 v78, v78
    v_exp_f32 v79, v79
    v_exp_f32 v80, v80
    v_mfma_f32_32x32x16_bf16 v[60:75], v[108:111], v[16:19], v[24:39]
    ds_read_b128 v[108:111], v9 offset:20480
    v_cvt_pk_bf16_f32 v100, v76, v77
    v_exp_f32 v81, v81
    v_cvt_pk_bf16_f32 v101, v78, v79
    v_exp_f32 v82, v82
    v_smfmac_f32_16x16x64_bf16 v[56:59], v[12:15], v[92:99], v10
    s_waitcnt lgkmcnt(2)
    v_exp_f32 v83, v83
    v_cvt_pk_bf16_f32 v102, v80, v81
    v_exp_f32 v84, v84
    v_mfma_f32_32x32x16_bf16 v[60:75], v[112:115], v[20:23], v[60:75]
    ds_read_b128 v[112:115], v9 offset:21504
    v_cvt_pk_bf16_f32 v103, v82, v83
    v_exp_f32 v85, v85
    v_exp_f32 v86, v86
    v_exp_f32 v87, v87
    v_mfma_f32_32x32x16_bf16 v[40:55], v[116:119], v[100:103], v[40:55]
    s_waitcnt lgkmcnt(1)
    ds_read_b128 v[116:119], v9 offset:18432
    v_cvt_pk_bf16_f32 v104, v84, v85
    v_exp_f32 v88, v88
    v_exp_f32 v89, v89
    v_cvt_pk_bf16_f32 v105, v86, v87
    v_exp_f32 v90, v90
    v_exp_f32 v91, v91
    v_cvt_pk_bf16_f32 v106, v88, v89
    v_cvt_pk_bf16_f32 v107, v90, v91
    v_exp_f32 v60, v60
    v_exp_f32 v61, v61
    v_mfma_f32_32x32x16_bf16 v[40:55], v[120:123], v[104:107], v[40:55]
    ds_read_b128 v[120:123], v9 offset:19456
    v_exp_f32 v62, v62
    v_exp_f32 v63, v63
    v_exp_f32 v64, v64
    v_mfma_f32_32x32x16_bf16 v[76:91], v[108:111], v[16:19], v[24:39]
    ds_read_b128 v[108:111], v9 offset:24576
    v_cvt_pk_bf16_f32 v92, v60, v61
    v_exp_f32 v65, v65
    v_cvt_pk_bf16_f32 v93, v62, v63
    v_exp_f32 v66, v66
    v_smfmac_f32_16x16x64_bf16 v[56:59], v[12:15], v[100:107], v10
    s_waitcnt lgkmcnt(2)
    v_exp_f32 v67, v67
    v_cvt_pk_bf16_f32 v94, v64, v65
    v_exp_f32 v68, v68
    v_mfma_f32_32x32x16_bf16 v[76:91], v[112:115], v[20:23], v[76:91]
    ds_read_b128 v[112:115], v9 offset:25600
    v_cvt_pk_bf16_f32 v95, v66, v67
    v_exp_f32 v69, v69
    v_exp_f32 v70, v70
    v_exp_f32 v71, v71
    v_mfma_f32_32x32x16_bf16 v[40:55], v[116:119], v[92:95], v[40:55]
    s_waitcnt lgkmcnt(1)
    ds_read_b128 v[116:119], v9 offset:22528
    v_cvt_pk_bf16_f32 v96, v68, v69
    v_exp_f32 v72, v72
    v_exp_f32 v73, v73
    v_cvt_pk_bf16_f32 v97, v70, v71
    v_exp_f32 v74, v74
    v_exp_f32 v75, v75
    v_cvt_pk_bf16_f32 v98, v72, v73
    v_cvt_pk_bf16_f32 v99, v74, v75
    v_exp_f32 v76, v76
    v_exp_f32 v77, v77
    v_mfma_f32_32x32x16_bf16 v[40:55], v[120:123], v[96:99], v[40:55]
    ds_read_b128 v[120:123], v9 offset:23552
    v_exp_f32 v78, v78
    v_exp_f32 v79, v79
    v_exp_f32 v80, v80
    v_mfma_f32_32x32x16_bf16 v[60:75], v[108:111], v[16:19], v[24:39]
    ds_read_b128 v[108:111], v9 offset:28672
    v_cvt_pk_bf16_f32 v100, v76, v77
    v_exp_f32 v81, v81
    v_cvt_pk_bf16_f32 v101, v78, v79
    v_exp_f32 v82, v82
    v_smfmac_f32_16x16x64_bf16 v[56:59], v[12:15], v[92:99], v10
    s_waitcnt lgkmcnt(2)
    v_exp_f32 v83, v83
    v_cvt_pk_bf16_f32 v102, v80, v81
    v_exp_f32 v84, v84
    v_mfma_f32_32x32x16_bf16 v[60:75], v[112:115], v[20:23], v[60:75]
    ds_read_b128 v[112:115], v9 offset:29696
    v_cvt_pk_bf16_f32 v103, v82, v83
    v_exp_f32 v85, v85
    v_exp_f32 v86, v86
    v_exp_f32 v87, v87
    v_mfma_f32_32x32x16_bf16 v[40:55], v[116:119], v[100:103], v[40:55]
    s_waitcnt lgkmcnt(1)
    ds_read_b128 v[116:119], v9 offset:26624
    v_cvt_pk_bf16_f32 v104, v84, v85
    v_exp_f32 v88, v88
    v_exp_f32 v89, v89
    v_cvt_pk_bf16_f32 v105, v86, v87
    v_exp_f32 v90, v90
    v_exp_f32 v91, v91
    v_cvt_pk_bf16_f32 v106, v88, v89
    v_cvt_pk_bf16_f32 v107, v90, v91
    v_exp_f32 v60, v60
    v_exp_f32 v61, v61
    v_mfma_f32_32x32x16_bf16 v[40:55], v[120:123], v[104:107], v[40:55]
    ds_read_b128 v[120:123], v9 offset:27648
    v_exp_f32 v62, v62
    v_exp_f32 v63, v63
    v_exp_f32 v64, v64
    v_mfma_f32_32x32x16_bf16 v[76:91], v[108:111], v[16:19], v[24:39]
    ds_read_b128 v[108:111], v9 offset:32768
    v_cvt_pk_bf16_f32 v92, v60, v61
    v_exp_f32 v65, v65
    v_cvt_pk_bf16_f32 v93, v62, v63
    v_exp_f32 v66, v66
    v_smfmac_f32_16x16x64_bf16 v[56:59], v[12:15], v[100:107], v10
    s_waitcnt lgkmcnt(2)
    v_exp_f32 v67, v67
    v_cvt_pk_bf16_f32 v94, v64, v65
    v_exp_f32 v68, v68
    v_mfma_f32_32x32x16_bf16 v[76:91], v[112:115], v[20:23], v[76:91]
    ds_read_b128 v[112:115], v9 offset:33792
    v_cvt_pk_bf16_f32 v95, v66, v67
    v_exp_f32 v69, v69
    v_exp_f32 v70, v70
    v_exp_f32 v71, v71
    v_mfma_f32_32x32x16_bf16 v[40:55], v[116:119], v[92:95], v[40:55]
    s_waitcnt lgkmcnt(1)
    ds_read_b128 v[116:119], v9 offset:30720
    v_cvt_pk_bf16_f32 v96, v68, v69
    v_exp_f32 v72, v72
    v_exp_f32 v73, v73
    v_cvt_pk_bf16_f32 v97, v70, v71
    v_exp_f32 v74, v74
    v_exp_f32 v75, v75
    v_cvt_pk_bf16_f32 v98, v72, v73
    v_cvt_pk_bf16_f32 v99, v74, v75
    v_exp_f32 v76, v76
    v_exp_f32 v77, v77
    v_mfma_f32_32x32x16_bf16 v[40:55], v[120:123], v[96:99], v[40:55]
    ds_read_b128 v[120:123], v9 offset:31744
    v_exp_f32 v78, v78
    v_exp_f32 v79, v79
    v_exp_f32 v80, v80
    v_mfma_f32_32x32x16_bf16 v[60:75], v[108:111], v[16:19], v[24:39]
    ds_read_b128 v[108:111], v9 offset:36864
    v_cvt_pk_bf16_f32 v100, v76, v77
    v_exp_f32 v81, v81
    v_cvt_pk_bf16_f32 v101, v78, v79
    v_exp_f32 v82, v82
    v_smfmac_f32_16x16x64_bf16 v[56:59], v[12:15], v[92:99], v10
    s_waitcnt lgkmcnt(2)
    v_exp_f32 v83, v83
    v_cvt_pk_bf16_f32 v102, v80, v81
    v_exp_f32 v84, v84
    v_mfma_f32_32x32x16_bf16 v[60:75], v[112:115], v[20:23], v[60:75]
    ds_read_b128 v[112:115], v9 offset:37888
    v_cvt_pk_bf16_f32 v103, v82, v83
    v_exp_f32 v85, v85
    v_exp_f32 v86, v86
    v_exp_f32 v87, v87
    v_mfma_f32_32x32x16_bf16 v[40:55], v[116:119], v[100:103], v[40:55]
    s_waitcnt lgkmcnt(1)
    ds_read_b128 v[116:119], v9 offset:34816
    v_cvt_pk_bf16_f32 v104, v84, v85
    v_exp_f32 v88, v88
    v_exp_f32 v89, v89
    v_cvt_pk_bf16_f32 v105, v86, v87
    v_exp_f32 v90, v90
    v_exp_f32 v91, v91
    v_cvt_pk_bf16_f32 v106, v88, v89
    v_cvt_pk_bf16_f32 v107, v90, v91
    v_exp_f32 v60, v60
    v_exp_f32 v61, v61
    v_mfma_f32_32x32x16_bf16 v[40:55], v[120:123], v[104:107], v[40:55]
    ds_read_b128 v[120:123], v9 offset:35840
    v_lshlrev_b32 v2, 12, v0
    v_mov_b32 v3, 1
    s_mov_b64 exec, 15
    ds_add_u32 v2, v3
    s_mov_b64 exec, -1
    v_exp_f32 v62, v62
    v_exp_f32 v63, v63
    v_exp_f32 v64, v64
    v_mfma_f32_32x32x16_bf16 v[76:91], v[108:111], v[16:19], v[24:39]
    ds_read_b128 v[108:111], v9 offset:40960
    v_cvt_pk_bf16_f32 v92, v60, v61
    v_exp_f32 v65, v65
    v_cvt_pk_bf16_f32 v93, v62, v63
    v_exp_f32 v66, v66
    v_smfmac_f32_16x16x64_bf16 v[56:59], v[12:15], v[100:107], v10
    s_waitcnt lgkmcnt(2)
    v_exp_f32 v67, v67
    v_cvt_pk_bf16_f32 v94, v64, v65
    v_exp_f32 v68, v68
    v_mfma_f32_32x32x16_bf16 v[76:91], v[112:115], v[20:23], v[76:91]
    ds_read_b128 v[112:115], v9 offset:41984
    v_cvt_pk_bf16_f32 v95, v66, v67
    v_exp_f32 v69, v69
    v_exp_f32 v70, v70
    v_exp_f32 v71, v71
    v_mfma_f32_32x32x16_bf16 v[40:55], v[116:119], v[92:95], v[40:55]
    s_waitcnt lgkmcnt(1)
    ds_read_b128 v[116:119], v9 offset:38912
    v_cvt_pk_bf16_f32 v96, v68, v69
    v_exp_f32 v72, v72
    v_exp_f32 v73, v73
    v_cvt_pk_bf16_f32 v97, v70, v71
    v_exp_f32 v74, v74
    v_exp_f32 v75, v75
    v_cvt_pk_bf16_f32 v98, v72, v73
    v_cvt_pk_bf16_f32 v99, v74, v75
    v_exp_f32 v76, v76
    v_exp_f32 v77, v77
    v_mfma_f32_32x32x16_bf16 v[40:55], v[120:123], v[96:99], v[40:55]
    ds_read_b128 v[120:123], v9 offset:39936
    v_exp_f32 v78, v78
    v_exp_f32 v79, v79
    v_exp_f32 v80, v80
    v_mfma_f32_32x32x16_bf16 v[60:75], v[108:111], v[16:19], v[24:39]
    ds_read_b128 v[108:111], v9 offset:45056
    v_cvt_pk_bf16_f32 v100, v76, v77
    v_exp_f32 v81, v81
    v_cvt_pk_bf16_f32 v101, v78, v79
    v_exp_f32 v82, v82
    v_smfmac_f32_16x16x64_bf16 v[56:59], v[12:15], v[92:99], v10
    s_waitcnt lgkmcnt(2)
    v_exp_f32 v83, v83
    v_cvt_pk_bf16_f32 v102, v80, v81
    v_exp_f32 v84, v84
    v_mfma_f32_32x32x16_bf16 v[60:75], v[112:115], v[20:23], v[60:75]
    ds_read_b128 v[112:115], v9 offset:46080
    v_cvt_pk_bf16_f32 v103, v82, v83
    v_exp_f32 v85, v85
    v_exp_f32 v86, v86
    v_exp_f32 v87, v87
    v_mfma_f32_32x32x16_bf16 v[40:55], v[116:119], v[100:103], v[40:55]
    s_waitcnt lgkmcnt(1)
    ds_read_b128 v[116:119], v9 offset:43008
    v_cvt_pk_bf16_f32 v104, v84, v85
    v_exp_f32 v88, v88
    v_exp_f32 v89, v89
    v_cvt_pk_bf16_f32 v105, v86, v87
    v_exp_f32 v90, v90
    v_exp_f32 v91, v91
    v_cvt_pk_bf16_f32 v106, v88, v89
    v_cvt_pk_bf16_f32 v107, v90, v91
    v_exp_f32 v60, v60
    v_exp_f32 v61, v61
    v_mfma_f32_32x32x16_bf16 v[40:55], v[120:123], v[104:107], v[40:55]
    ds_read_b128 v[120:123], v9 offset:44032
    v_exp_f32 v62, v62
    v_exp_f32 v63, v63
    v_exp_f32 v64, v64
    v_mfma_f32_32x32x16_bf16 v[76:91], v[108:111], v[16:19], v[24:39]
    ds_read_b128 v[108:111], v9 offset:49152
    v_cvt_pk_bf16_f32 v92, v60, v61
    v_exp_f32 v65, v65
    v_cvt_pk_bf16_f32 v93, v62, v63
    v_exp_f32 v66, v66
    v_smfmac_f32_16x16x64_bf16 v[56:59], v[12:15], v[100:107], v10
    s_waitcnt lgkmcnt(2)
    v_exp_f32 v67, v67
    v_cvt_pk_bf16_f32 v94, v64, v65
    v_exp_f32 v68, v68
    v_mfma_f32_32x32x16_bf16 v[76:91], v[112:115], v[20:23], v[76:91]
    ds_read_b128 v[112:115], v9 offset:50176
    v_cvt_pk_bf16_f32 v95, v66, v67
    v_exp_f32 v69, v69
    v_exp_f32 v70, v70
    v_exp_f32 v71, v71
    v_mfma_f32_32x32x16_bf16 v[40:55], v[116:119], v[92:95], v[40:55]
    s_waitcnt lgkmcnt(1)
    ds_read_b128 v[116:119], v9 offset:47104
    v_cvt_pk_bf16_f32 v96, v68, v69
    v_exp_f32 v72, v72
    v_exp_f32 v73, v73
    v_cvt_pk_bf16_f32 v97, v70, v71
    v_exp_f32 v74, v74
    v_exp_f32 v75, v75
    v_cvt_pk_bf16_f32 v98, v72, v73
    v_cvt_pk_bf16_f32 v99, v74, v75
    v_exp_f32 v76, v76
    v_exp_f32 v77, v77
    v_mfma_f32_32x32x16_bf16 v[40:55], v[120:123], v[96:99], v[40:55]
    ds_read_b128 v[120:123], v9 offset:48128
    v_exp_f32 v78, v78
    v_exp_f32 v79, v79
    v_exp_f32 v80, v80
    v_mfma_f32_32x32x16_bf16 v[60:75], v[108:111], v[16:19], v[24:39]
    ds_read_b128 v[108:111], v9 offset:53248
    v_cvt_pk_bf16_f32 v100, v76, v77
    v_exp_f32 v81, v81
    v_cvt_pk_bf16_f32 v101, v78, v79
    v_exp_f32 v82, v82
    v_smfmac_f32_16x16x64_bf16 v[56:59], v[12:15], v[92:99], v10
    s_waitcnt lgkmcnt(2)
    v_exp_f32 v83, v83
    v_cvt_pk_bf16_f32 v102, v80, v81
    v_exp_f32 v84, v84
    v_mfma_f32_32x32x16_bf16 v[60:75], v[112:115], v[20:23], v[60:75]
    ds_read_b128 v[112:115], v9 offset:54272
    v_cvt_pk_bf16_f32 v103, v82, v83
    v_exp_f32 v85, v85
    v_exp_f32 v86, v86
    v_exp_f32 v87, v87
    v_mfma_f32_32x32x16_bf16 v[40:55], v[116:119], v[100:103], v[40:55]
    s_waitcnt lgkmcnt(1)
    ds_read_b128 v[116:119], v9 offset:51200
    v_cvt_pk_bf16_f32 v104, v84, v85
    v_exp_f32 v88, v88
    v_exp_f32 v89, v89
    v_cvt_pk_bf16_f32 v105, v86, v87
    v_exp_f32 v90, v90
    v_exp_f32 v91, v91
    v_cvt_pk_bf16_f32 v106, v88, v89
    v_cvt_pk_bf16_f32 v107, v90, v91
    v_exp_f32 v60, v60
    v_exp_f32 v61, v61
    v_mfma_f32_32x32x16_bf16 v[40:55], v[120:123], v[104:107], v[40:55]
    ds_read_b128 v[120:123], v9 offset:52224
    v_exp_f32 v62, v62
    v_exp_f32 v63, v63
    v_exp_f32 v64, v64
    v_mfma_f32_32x32x16_bf16 v[76:91], v[108:111], v[16:19], v[24:39]
    ds_read_b128 v[108:111], v9 offset:57344
    v_cvt_pk_bf16_f32 v92, v60, v61
    v_exp_f32 v65, v65
    v_cvt_pk_bf16_f32 v93, v62, v63
    v_exp_f32 v66, v66
    v_smfmac_f32_16x16x64_bf16 v[56:59], v[12:15], v[100:107], v10
    s_waitcnt lgkmcnt(2)
    v_exp_f32 v67, v67
    v_cvt_pk_bf16_f32 v94, v64, v65
    v_exp_f32 v68, v68
    v_mfma_f32_32x32x16_bf16 v[76:91], v[112:115], v[20:23], v[76:91]
    ds_read_b128 v[112:115], v9 offset:58368
    v_cvt_pk_bf16_f32 v95, v66, v67
    v_exp_f32 v69, v69
    v_exp_f32 v70, v70
    v_exp_f32 v71, v71
    v_mfma_f32_32x32x16_bf16 v[40:55], v[116:119], v[92:95], v[40:55]
    s_waitcnt lgkmcnt(1)
    ds_read_b128 v[116:119], v9 offset:55296
    v_cvt_pk_bf16_f32 v96, v68, v69
    v_exp_f32 v72, v72
    v_exp_f32 v73, v73
    v_cvt_pk_bf16_f32 v97, v70, v71
    v_exp_f32 v74, v74
    v_exp_f32 v75, v75
    v_cvt_pk_bf16_f32 v98, v72, v73
    v_cvt_pk_bf16_f32 v99, v74, v75
    v_exp_f32 v76, v76
    v_exp_f32 v77, v77
    v_mfma_f32_32x32x16_bf16 v[40:55], v[120:123], v[96:99], v[40:55]
    ds_read_b128 v[120:123], v9 offset:56320
    v_exp_f32 v78, v78
    v_exp_f32 v79, v79
    v_exp_f32 v80, v80
    v_mfma_f32_32x32x16_bf16 v[60:75], v[108:111], v[16:19], v[24:39]
    ds_read_b128 v[108:111], v9 offset:61440
    v_cvt_pk_bf16_f32 v100, v76, v77
    v_exp_f32 v81, v81
    v_cvt_pk_bf16_f32 v101, v78, v79
    v_exp_f32 v82, v82
    v_smfmac_f32_16x16x64_bf16 v[56:59], v[12:15], v[92:99], v10
    s_waitcnt lgkmcnt(2)
    v_exp_f32 v83, v83
    v_cvt_pk_bf16_f32 v102, v80, v81
    v_exp_f32 v84, v84
    v_mfma_f32_32x32x16_bf16 v[60:75], v[112:115], v[20:23], v[60:75]
    ds_read_b128 v[112:115], v9 offset:62464
    v_cvt_pk_bf16_f32 v103, v82, v83
    v_exp_f32 v85, v85
    v_exp_f32 v86, v86
    v_exp_f32 v87, v87
    v_mfma_f32_32x32x16_bf16 v[40:55], v[116:119], v[100:103], v[40:55]
    s_waitcnt lgkmcnt(1)
    ds_read_b128 v[116:119], v9 offset:59392
    v_cvt_pk_bf16_f32 v104, v84, v85
    v_exp_f32 v88, v88
    v_exp_f32 v89, v89
    v_cvt_pk_bf16_f32 v105, v86, v87
    v_exp_f32 v90, v90
    v_exp_f32 v91, v91
    v_cvt_pk_bf16_f32 v106, v88, v89
    v_cvt_pk_bf16_f32 v107, v90, v91
    v_exp_f32 v60, v60
    v_exp_f32 v61, v61
    v_mfma_f32_32x32x16_bf16 v[40:55], v[120:123], v[104:107], v[40:55]
    ds_read_b128 v[120:123], v9 offset:60416
    v_exp_f32 v62, v62
    v_exp_f32 v63, v63
    v_exp_f32 v64, v64
    v_mfma_f32_32x32x16_bf16 v[76:91], v[108:111], v[16:19], v[24:39]
    v_cvt_pk_bf16_f32 v92, v60, v61
    v_exp_f32 v65, v65
    v_cvt_pk_bf16_f32 v93, v62, v63
    v_exp_f32 v66, v66
    v_smfmac_f32_16x16x64_bf16 v[56:59], v[12:15], v[100:107], v10
    s_waitcnt lgkmcnt(1)
    v_exp_f32 v67, v67
    v_cvt_pk_bf16_f32 v94, v64, v65
    v_exp_f32 v68, v68
    v_mfma_f32_32x32x16_bf16 v[76:91], v[112:115], v[20:23], v[76:91]
    v_cvt_pk_bf16_f32 v95, v66, v67
    v_exp_f32 v69, v69
    v_exp_f32 v70, v70
    v_exp_f32 v71, v71
    v_mfma_f32_32x32x16_bf16 v[40:55], v[116:119], v[92:95], v[40:55]
    s_waitcnt lgkmcnt(0)
    ds_read_b128 v[116:119], v9 offset:63488
    v_cvt_pk_bf16_f32 v96, v68, v69
    v_exp_f32 v72, v72
    v_exp_f32 v73, v73
    v_cvt_pk_bf16_f32 v97, v70, v71
    v_exp_f32 v74, v74
    v_exp_f32 v75, v75
    v_cvt_pk_bf16_f32 v98, v72, v73
    v_cvt_pk_bf16_f32 v99, v74, v75
    v_exp_f32 v76, v76
    v_exp_f32 v77, v77
    v_mfma_f32_32x32x16_bf16 v[40:55], v[120:123], v[96:99], v[40:55]
    ds_read_b128 v[120:123], v9 offset:64512
    v_exp_f32 v78, v78
    v_exp_f32 v79, v79
    v_exp_f32 v80, v80
    v_cvt_pk_bf16_f32 v100, v76, v77
    v_exp_f32 v81, v81
    v_cvt_pk_bf16_f32 v101, v78, v79
    v_exp_f32 v82, v82
    v_smfmac_f32_16x16x64_bf16 v[56:59], v[12:15], v[92:99], v10
    s_waitcnt lgkmcnt(1)
    v_exp_f32 v83, v83
    v_cvt_pk_bf16_f32 v102, v80, v81
    v_exp_f32 v84, v84
    v_cvt_pk_bf16_f32 v103, v82, v83
    v_exp_f32 v85, v85
    v_exp_f32 v86, v86
    v_exp_f32 v87, v87
    v_mfma_f32_32x32x16_bf16 v[40:55], v[116:119], v[100:103], v[40:55]
    v_cvt_pk_bf16_f32 v104, v84, v85
    v_exp_f32 v88, v88
    v_exp_f32 v89, v89
    v_cvt_pk_bf16_f32 v105, v86, v87
    v_exp_f32 v90, v90
    v_exp_f32 v91, v91
    v_cvt_pk_bf16_f32 v106, v88, v89
    v_cvt_pk_bf16_f32 v107, v90, v91
    s_waitcnt lgkmcnt(0)
    v_and_b32 v6, 15, v0
    v_mfma_f32_32x32x16_bf16 v[40:55], v[120:123], v[104:107], v[40:55]
    v_smfmac_f32_16x16x64_bf16 v[56:59], v[12:15], v[100:107], v10
    v_lshlrev_b32 v6, 4, v6
    v_bfe_u32 v7, v0, 4, 1
    v_lshl_add_u32 v6, v7, 10, v6
    v_lshrrev_b32 v7, 5, v0
    v_lshl_add_u32 v6, v7, 8, v6
    s_xor_b32 s41, s45, 1
    s_lshl_b32 s41, s41, 4
    s_add_u32 s41, s41, s5
    s_lshl_b32 s42, s4, 5
    s_add_u32 s42, s42, s41
    s_lshl_b32 s42, s42, 13
    s_lshl_b32 s41, s7, 11
    s_add_u32 s42, s42, s41
    s_add_u32 s42, s42, s36
    s_add_u32 s42, s42, 0x0
    s_mov_b32 s40, 0x76800000
    v_pk_mul_f32 v[4:5], v[40:41], 0
    v_pk_fma_f32 v[4:5], v[42:43], 0, v[4:5]
    v_pk_fma_f32 v[4:5], v[44:45], 0, v[4:5]
    v_pk_fma_f32 v[4:5], v[46:47], 0, v[4:5]
    v_pk_fma_f32 v[4:5], v[48:49], 0, v[4:5]
    v_pk_fma_f32 v[4:5], v[50:51], 0, v[4:5]
    v_pk_fma_f32 v[4:5], v[52:53], 0, v[4:5]
    v_pk_fma_f32 v[4:5], v[54:55], 0, v[4:5]
    v_add_f32 v56, v56, v57
    v_cmp_nlt_f32 s[50:51], v56, s40
    v_rcp_f32 v58, v56
    v_cmp_u_f32 vcc, v4, v5
    s_nop 1
    s_or_b64 s[50:51], s[50:51], vcc
    s_cbranch_scc1 att_fallback
att_fin:
    v_pk_mul_f32 v[40:41], v[40:41], v[58:59] op_sel:[0,0] op_sel_hi:[1,0]
    v_pk_mul_f32 v[42:43], v[42:43], v[58:59] op_sel:[0,0] op_sel_hi:[1,0]
    v_pk_mul_f32 v[44:45], v[44:45], v[58:59] op_sel:[0,0] op_sel_hi:[1,0]
    v_pk_mul_f32 v[46:47], v[46:47], v[58:59] op_sel:[0,0] op_sel_hi:[1,0]
    v_pk_mul_f32 v[48:49], v[48:49], v[58:59] op_sel:[0,0] op_sel_hi:[1,0]
    v_pk_mul_f32 v[50:51], v[50:51], v[58:59] op_sel:[0,0] op_sel_hi:[1,0]
    v_pk_mul_f32 v[52:53], v[52:53], v[58:59] op_sel:[0,0] op_sel_hi:[1,0]
    v_pk_mul_f32 v[54:55], v[54:55], v[58:59] op_sel:[0,0] op_sel_hi:[1,0]
    v_cvt_pk_bf16_f32 v92, v40, v41
    v_cvt_pk_bf16_f32 v93, v42, v43
    v_cvt_pk_bf16_f32 v94, v44, v45
    v_cvt_pk_bf16_f32 v95, v46, v47
    buffer_store_dwordx4 v[92:95], v6, s[8:11], s42 offen offset:0 sc0 sc1
    v_cvt_pk_bf16_f32 v96, v48, v49
    v_cvt_pk_bf16_f32 v97, v50, v51
    v_cvt_pk_bf16_f32 v98, v52, v53
    v_cvt_pk_bf16_f32 v99, v54, v55
    buffer_store_dwordx4 v[96:99], v6, s[8:11], s42 offen offset:512 sc0 sc1
    s_cmp_ge_u32 s6, 4
    s_cbranch_scc1 wo_loader
    s_branch wo_compute
att_setup:
    s_lshl_b32 s52, s6, 12
    s_mov_b32 s57, 0x4438000
    s_cmp_lt_u32 s37, 112
    s_cbranch_scc1 att_sw1
    s_mov_b32 s60, 2048
    s_cmp_lt_u32 s37, 192
    s_cbranch_scc1 att_sw2
    s_sub_u32 s67, s37, 192
    s_lshl_b32 s67, s67, 3
    s_add_u32 s67, s67, s6
    s_and_b32 s41, s67, 15
    s_lshr_b32 s40, s67, 4
    s_lshl_b32 s61, s40, 16
    s_lshl_b32 s42, s41, 7
    s_add_u32 s61, s61, s42
    s_lshr_b32 s42, s40, 1
    s_bitcmp1_b32 s40, 0
    s_cselect_b32 s43, 0, 16
    s_add_u32 s42, s42, s43
    s_lshl_b32 s41, s41, 5
    s_add_u32 s42, s42, s41
    s_lshl_b32 s62, s42, 12
    s_add_u32 s62, s62, 0x6000000
    s_add_u32 s67, s67, 1280
    s_branch att_sw2b
att_sw2:
    s_mov_b32 s28, s78
    s_mov_b32 s29, s79
    s_mov_b32 s30, 7340032
    s_sub_u32 s67, s37, 112
    s_lshl_b32 s67, s67, 4
    s_add_u32 s67, s67, s6
    s_mov_b32 s40, s67
    s_and_b32 s41, s40, 15
    s_lshr_b32 s40, s40, 4
    s_lshl_b32 s61, s40, 16
    s_lshl_b32 s42, s41, 7
    s_add_u32 s61, s61, s42
    s_mul_i32 s42, s40, 9363
    s_lshr_b32 s42, s42, 16
    s_mul_i32 s44, s42, 7
    s_sub_u32 s40, s40, s44
    s_and_b32 s43, s42, 1
    s_mul_i32 s43, s43, 56
    s_lshr_b32 s42, s42, 1
    s_and_b32 s44, s40, 3
    s_lshl_b32 s44, s44, 4
    s_add_u32 s44, s44, s42
    s_add_u32 s43, s43, s44
    s_lshr_b32 s44, s40, 2
    s_add_u32 s44, s44, s42
    s_cmp_eq_u32 s40, 3
    s_cselect_b32 s44, 0, s44
    s_add_u32 s44, s44, s43
    s_lshr_b32 s42, s41, 1
    s_mul_i32 s42, s42, 112
    s_add_u32 s44, s44, s42
    s_lshl_b32 s44, s44, 1
    s_and_b32 s41, s41, 1
    s_add_u32 s44, s44, s41
    s_lshl_b32 s62, s44, 12
    s_add_u32 s62, s62, 0x5800000
    s_add_u32 s67, s67, 8
att_sw2b:
    s_mov_b32 s40, s67
    s_and_b32 s41, s40, 15
    s_lshr_b32 s40, s40, 4
    s_lshl_b32 s56, s40, 16
    s_lshl_b32 s42, s41, 7
    s_add_u32 s56, s56, s42
    s_mul_i32 s42, s40, 9363
    s_lshr_b32 s42, s42, 16
    s_mul_i32 s44, s42, 7
    s_sub_u32 s40, s40, s44
    s_and_b32 s43, s42, 1
    s_mul_i32 s43, s43, 56
    s_lshr_b32 s42, s42, 1
    s_and_b32 s44, s40, 3
    s_lshl_b32 s44, s44, 4
    s_add_u32 s44, s44, s42
    s_add_u32 s43, s43, s44
    s_lshr_b32 s44, s40, 2
    s_add_u32 s44, s44, s42
    s_cmp_eq_u32 s40, 3
    s_cselect_b32 s44, 0, s44
    s_add_u32 s44, s44, s43
    s_lshr_b32 s42, s41, 1
    s_mul_i32 s42, s42, 112
    s_add_u32 s44, s44, s42
    s_lshl_b32 s44, s44, 1
    s_and_b32 s41, s41, 1
    s_add_u32 s44, s44, s41
    s_lshl_b32 s66, s44, 12
    s_add_u32 s66, s66, 0x5800000
    s_sub_u32 s66, s66, s62
    s_add_u32 s63, s62, 1024
    s_add_u32 s64, s62, 2048
    s_add_u32 s65, s62, 3072
    s_branch att_swj
att_sw1:
    s_mov_b32 s28, s76
    s_mov_b32 s29, s77
    s_mov_b32 s30, 7340032
    s_lshr_b32 s41, s37, 1
    s_and_b32 s40, s37, 1
    s_lshl_b32 s40, s40, 3
    s_add_u32 s67, s40, s6
    s_mul_i32 s57, s67, 14336
    s_lshl_b32 s40, s41, 8
    s_add_u32 s57, s57, s40
    s_add_u32 s57, s57, 0x4400000
    s_lshl_b32 s67, s67, 1
    s_mov_b32 s60, 7168
    s_mov_b32 s66, 14336
    s_mul_i32 s43, s67, 14336
    s_mul_i32 s61, s67, 229376
    s_lshl_b32 s40, s41, 7
    s_add_u32 s61, s61, s40
    s_add_u32 s56, s61, 229376
    s_lshl_b32 s40, s41, 2
    s_add_u32 s40, s40, 0
    s_mul_i32 s42, s40, 4682
    s_lshr_b32 s42, s42, 16
    s_mul_i32 s62, s42, 444416
    s_lshl_b32 s40, s40, 10
    s_add_u32 s62, s62, s40
    s_add_u32 s62, s62, s43
    s_add_u32 s62, s62, 0x5000000
    s_lshl_b32 s40, s41, 2
    s_add_u32 s40, s40, 1
    s_mul_i32 s42, s40, 4682
    s_lshr_b32 s42, s42, 16
    s_mul_i32 s63, s42, 444416
    s_lshl_b32 s40, s40, 10
    s_add_u32 s63, s63, s40
    s_add_u32 s63, s63, s43
    s_add_u32 s63, s63, 0x5000000
    s_lshl_b32 s40, s41, 2
    s_add_u32 s40, s40, 2
    s_mul_i32 s42, s40, 4682
    s_lshr_b32 s42, s42, 16
    s_mul_i32 s64, s42, 444416
    s_lshl_b32 s40, s40, 10
    s_add_u32 s64, s64, s40
    s_add_u32 s64, s64, s43
    s_add_u32 s64, s64, 0x5000000
    s_lshl_b32 s40, s41, 2
    s_add_u32 s40, s40, 3
    s_mul_i32 s42, s40, 4682
    s_lshr_b32 s42, s42, 16
    s_mul_i32 s65, s42, 444416
    s_lshl_b32 s40, s40, 10
    s_add_u32 s65, s65, s40
    s_add_u32 s65, s65, s43
    s_add_u32 s65, s65, 0x5000000
att_swj:
    v_lshrrev_b32 v2, 3, v0
    v_mul_lo_u32 v192, v2, s60
    v_lshrrev_b32 v2, 4, v0
    v_lshlrev_b32 v2, 1, v2
    v_and_b32 v3, 7, v0
    v_xor_b32 v2, v2, v3
    v_lshl_add_u32 v192, v2, 4, v192
    s_lshl_b32 s68, s60, 3
    s_sub_u32 s68, s68, 1024
    s_add_u32 s69, s52, 131072
    v_lshrrev_b32 v4, 2, v0
    v_lshlrev_b32 v2, 7, v4
    v_and_b32 v3, 3, v0
    v_lshl_add_u32 v2, v3, 3, v2
    v_lshrrev_b32 v3, 3, v0
    v_and_b32 v3, 3, v3
    v_lshlrev_b32 v3, 5, v3
    v_xor_b32 v4, 0, v3
    v_add3_u32 v194, v2, v4, s69
    v_xor_b32 v4, 32, v3
    v_add3_u32 v195, v2, v4, s69
    v_xor_b32 v4, 64, v3
    v_add3_u32 v196, v2, v4, s69
    v_xor_b32 v4, 96, v3
    v_add3_u32 v197, v2, v4, s69
    v_pk_mul_f32 v[176:177], 0, 0
    v_pk_mul_f32 v[178:179], 0, 0
    v_pk_mul_f32 v[180:181], 0, 0
    v_pk_mul_f32 v[182:183], 0, 0
    v_pk_mul_f32 v[184:185], 0, 0
    v_pk_mul_f32 v[186:187], 0, 0
    v_pk_mul_f32 v[188:189], 0, 0
    v_pk_mul_f32 v[190:191], 0, 0
    s_lshl_b32 s40, s4, 7
    s_lshr_b32 s41, s7, 1
    s_lshl_b32 s41, s41, 6
    s_add_u32 s40, s40, s41
    v_and_b32 v2, 15, v0
    v_add_u32 v2, s40, v2
    v_lshlrev_b32 v193, 11, v2
    v_lshrrev_b32 v2, 4, v0
    v_lshl_add_u32 v193, v2, 3, v193
    s_lshl_b32 s47, s5, 7
    s_and_b32 s41, s7, 1
    s_lshl_b32 s41, s41, 6
    s_add_u32 s47, s47, s41
    s_setpc_b64 s[88:89]
att_ssig:
    s_lshl_b32 s40, s4, 7
    s_lshl_b32 s41, s5, 2
    s_add_u32 s40, s40, s41
    s_add_u32 s40, s40, 0x4551800
    v_mov_b32 v2, 1
    s_mov_b64 exec, 1
    buffer_store_dword v2, off, s[8:11], s40 sc0 sc1
    s_mov_b64 exec, -1
    s_branch att_ssigret
att_fallback:
    s_add_u32 s40, s36, 0x1e00000
    s_add_u32 s41, s40, 262144
    v_mov_b32 v2, 0xff800000
att_fb1:
    buffer_load_dwordx4 v[108:111], v8, s[8:11], s40 offen sc1
    buffer_load_dwordx4 v[112:115], v8, s[8:11], s40 offen offset:1024 sc1
    s_waitcnt vmcnt(0)
    v_mfma_f32_32x32x16_bf16 v[60:75], v[108:111], v[16:19], 0
    v_mfma_f32_32x32x16_bf16 v[60:75], v[112:115], v[20:23], v[60:75]
    s_nop 15
    v_max3_f32 v2, v2, v60, v61
    v_max3_f32 v2, v2, v62, v63
    v_max3_f32 v2, v2, v64, v65
    v_max3_f32 v2, v2, v66, v67
    v_max3_f32 v2, v2, v68, v69
    v_max3_f32 v2, v2, v70, v71
    v_max3_f32 v2, v2, v72, v73
    v_max3_f32 v2, v2, v74, v75
    s_add_u32 s40, s40, 4096
    s_cmp_lt_u32 s40, s41
    s_cbranch_scc1 att_fb1
    v_mov_b32 v3, v2
    s_nop 1
    v_permlane32_swap_b32 v2, v3
    s_nop 1
    v_max_f32 v2, v2, v3
    v_pk_mul_f32 v[24:25], v[2:3], -1.0 op_sel:[0,0] op_sel_hi:[0,0]
    v_pk_mul_f32 v[26:27], v[2:3], -1.0 op_sel:[0,0] op_sel_hi:[0,0]
    v_pk_mul_f32 v[28:29], v[2:3], -1.0 op_sel:[0,0] op_sel_hi:[0,0]
    v_pk_mul_f32 v[30:31], v[2:3], -1.0 op_sel:[0,0] op_sel_hi:[0,0]
    v_pk_mul_f32 v[32:33], v[2:3], -1.0 op_sel:[0,0] op_sel_hi:[0,0]
    v_pk_mul_f32 v[34:35], v[2:3], -1.0 op_sel:[0,0] op_sel_hi:[0,0]
    v_pk_mul_f32 v[36:37], v[2:3], -1.0 op_sel:[0,0] op_sel_hi:[0,0]
    v_pk_mul_f32 v[38:39], v[2:3], -1.0 op_sel:[0,0] op_sel_hi:[0,0]
    v_pk_mul_f32 v[40:41], 0, 0
    v_pk_mul_f32 v[42:43], 0, 0
    v_pk_mul_f32 v[44:45], 0, 0
    v_pk_mul_f32 v[46:47], 0, 0
    v_pk_mul_f32 v[48:49], 0, 0
    v_pk_mul_f32 v[50:51], 0, 0
    v_pk_mul_f32 v[52:53], 0, 0
    v_pk_mul_f32 v[54:55], 0, 0
    v_pk_mul_f32 v[56:57], 0, 0
    v_pk_mul_f32 v[58:59], 0, 0
    s_sub_u32 s40, s41, 262144
att_fb2:
    buffer_load_dwordx4 v[108:111], v8, s[8:11], s40 offen offset:0 sc1
    buffer_load_dwordx4 v[112:115], v8, s[8:11], s40 offen offset:1024 sc1
    buffer_load_dwordx4 v[116:119], v8, s[8:11], s40 offen offset:2048 sc1
    buffer_load_dwordx4 v[120:123], v8, s[8:11], s40 offen offset:3072 sc1
    s_waitcnt vmcnt(0)
    v_mfma_f32_32x32x16_bf16 v[60:75], v[108:111], v[16:19], v[24:39]
    v_mfma_f32_32x32x16_bf16 v[60:75], v[112:115], v[20:23], v[60:75]
    s_nop 15
    v_exp_f32 v60, v60
    v_exp_f32 v61, v61
    v_exp_f32 v62, v62
    v_exp_f32 v63, v63
    v_exp_f32 v64, v64
    v_exp_f32 v65, v65
    v_exp_f32 v66, v66
    v_exp_f32 v67, v67
    v_exp_f32 v68, v68
    v_exp_f32 v69, v69
    v_exp_f32 v70, v70
    v_exp_f32 v71, v71
    v_exp_f32 v72, v72
    v_exp_f32 v73, v73
    v_exp_f32 v74, v74
    v_exp_f32 v75, v75
    v_cvt_pk_bf16_f32 v92, v60, v61
    v_cvt_pk_bf16_f32 v93, v62, v63
    v_cvt_pk_bf16_f32 v94, v64, v65
    v_cvt_pk_bf16_f32 v95, v66, v67
    v_cvt_pk_bf16_f32 v96, v68, v69
    v_cvt_pk_bf16_f32 v97, v70, v71
    v_cvt_pk_bf16_f32 v98, v72, v73
    v_cvt_pk_bf16_f32 v99, v74, v75
    s_nop 1
    v_mfma_f32_32x32x16_bf16 v[40:55], v[116:119], v[92:95], v[40:55]
    v_mfma_f32_32x32x16_bf16 v[40:55], v[120:123], v[96:99], v[40:55]
    v_smfmac_f32_16x16x64_bf16 v[56:59], v[12:15], v[92:99], v10
    s_add_u32 s40, s40, 4096
    s_cmp_lt_u32 s40, s41
    s_cbranch_scc1 att_fb2
    s_nop 15
    v_add_f32 v56, v56, v57
    v_rcp_f32 v58, v56
    s_branch att_fin
wo_compute:
    s_lshr_b32 s48, s7, 1
    s_and_b32 s49, s7, 1
    s_lshl_b32 s40, s4, 7
    s_lshl_b32 s41, s48, 6
    s_add_u32 s40, s40, s41
    s_lshl_b32 s44, s37, 14
    s_lshl_b32 s41, s49, 13
    s_add_u32 s44, s44, s41
    s_add_u32 s44, s44, s36
    s_add_u32 s44, s44, 0x400000
    s_lshl_b32 s41, s48, 12
    v_lshl_add_u32 v11, v0, 4, s41
    v_mov_b32 v12, v11
    s_lshl_b32 s41, s49, 11
    s_add_u32 s41, s41, 131072
    v_lshl_add_u32 v13, v0, 4, s41
    v_add_u32 v10, s40, v0
    v_lshlrev_b32 v10, 3, v10
    s_lshl_b32 s45, s5, 1
    s_add_u32 s45, s45, s49
    s_lshl_b32 s45, s45, 14
    s_add_u32 s45, s45, s36
    s_add_u32 s45, s45, 0x1e40000
    s_mov_b32 s47, 0x3f803f80
    v_lshlrev_b32 v16, 16, v232
    v_and_b32 v17, 0xffff0000, v232
    v_lshlrev_b32 v18, 16, v233
    v_and_b32 v19, 0xffff0000, v233
    v_lshlrev_b32 v20, 16, v234
    v_and_b32 v21, 0xffff0000, v234
    v_lshlrev_b32 v22, 16, v235
    v_and_b32 v23, 0xffff0000, v235
    v_lshlrev_b32 v24, 16, v236
    v_and_b32 v25, 0xffff0000, v236
    v_lshlrev_b32 v26, 16, v237
    v_and_b32 v27, 0xffff0000, v237
    v_lshlrev_b32 v28, 16, v238
    v_and_b32 v29, 0xffff0000, v238
    v_lshlrev_b32 v30, 16, v239
    v_and_b32 v31, 0xffff0000, v239
    v_lshlrev_b32 v32, 16, v240
    v_and_b32 v33, 0xffff0000, v240
    v_lshlrev_b32 v34, 16, v241
    v_and_b32 v35, 0xffff0000, v241
    v_lshlrev_b32 v36, 16, v242
    v_and_b32 v37, 0xffff0000, v242
    v_lshlrev_b32 v38, 16, v243
    v_and_b32 v39, 0xffff0000, v243
    v_lshlrev_b32 v40, 16, v244
    v_and_b32 v41, 0xffff0000, v244
    v_lshlrev_b32 v42, 16, v245
    v_and_b32 v43, 0xffff0000, v245
    v_lshlrev_b32 v44, 16, v246
    v_and_b32 v45, 0xffff0000, v246
    v_lshlrev_b32 v46, 16, v247
    v_and_b32 v47, 0xffff0000, v247
    s_waitcnt vmcnt(0)
    s_mov_b32 s50, 0
    s_mov_b32 s51, 8
    s_mov_b32 s52, 4
    s_add_u32 s50, s50, 1
    s_mov_b32 s53, 16384
    s_cmp_eq_u32 s50, 4
    s_cselect_b32 s53, -49152, s53
    s_cselect_b32 s50, 0, s50
    s_add_u32 s51, s51, 1
    s_mov_b32 s54, 8192
    s_cmp_eq_u32 s51, 12
    s_cselect_b32 s54, -90112, s54
    s_cselect_b32 s51, 0, s51
    s_barrier
    ds_read_b128 v[112:115], v13 offset:0
    ds_read_b128 v[116:119], v13 offset:1024
    ds_read_b128 v[48:51], v12 offset:0
    ds_read_b128 v[52:55], v12 offset:1024
    ds_read_b128 v[56:59], v12 offset:2048
    ds_read_b128 v[60:63], v12 offset:3072
    .p2align 6
wo_loop:
    s_waitcnt lgkmcnt(0)
    v_mfma_f32_16x16x32_bf16 v[16:19], v[112:115], v[48:51], v[16:19]
    ds_read_b128 v[120:123], v13 offset:4096
    ds_read_b128 v[124:127], v13 offset:5120
    v_mfma_f32_16x16x32_bf16 v[20:23], v[116:119], v[48:51], v[20:23]
    ds_read_b128 v[64:67], v12 offset:8192
    ds_read_b128 v[68:71], v12 offset:9216
    v_mfma_f32_16x16x32_bf16 v[24:27], v[112:115], v[52:55], v[24:27]
    ds_read_b128 v[72:75], v12 offset:10240
    ds_read_b128 v[76:79], v12 offset:11264
    v_mfma_f32_16x16x32_bf16 v[28:31], v[116:119], v[52:55], v[28:31]
    v_add_u32 v12, s53, v12
    v_add_u32 v13, s54, v13
    v_mfma_f32_16x16x32_bf16 v[32:35], v[112:115], v[56:59], v[32:35]
    v_mfma_f32_16x16x32_bf16 v[36:39], v[116:119], v[56:59], v[36:39]
    v_mfma_f32_16x16x32_bf16 v[40:43], v[112:115], v[60:63], v[40:43]
    v_mfma_f32_16x16x32_bf16 v[44:47], v[116:119], v[60:63], v[44:47]
    s_waitcnt lgkmcnt(0)
    s_barrier
    v_mfma_f32_16x16x32_bf16 v[16:19], v[120:123], v[64:67], v[16:19]
    ds_read_b128 v[112:115], v13 offset:0
    ds_read_b128 v[116:119], v13 offset:1024
    v_mfma_f32_16x16x32_bf16 v[20:23], v[124:127], v[64:67], v[20:23]
    ds_read_b128 v[48:51], v12 offset:0
    ds_read_b128 v[52:55], v12 offset:1024
    v_mfma_f32_16x16x32_bf16 v[24:27], v[120:123], v[68:71], v[24:27]
    ds_read_b128 v[56:59], v12 offset:2048
    ds_read_b128 v[60:63], v12 offset:3072
    v_mfma_f32_16x16x32_bf16 v[28:31], v[124:127], v[68:71], v[28:31]
    s_add_u32 s50, s50, 1
    s_mov_b32 s53, 16384
    s_cmp_eq_u32 s50, 4
    s_cselect_b32 s53, -49152, s53
    v_mfma_f32_16x16x32_bf16 v[32:35], v[120:123], v[72:75], v[32:35]
    s_cselect_b32 s50, 0, s50
    s_add_u32 s51, s51, 1
    s_mov_b32 s54, 8192
    v_mfma_f32_16x16x32_bf16 v[36:39], v[124:127], v[72:75], v[36:39]
    s_cmp_eq_u32 s51, 12
    s_cselect_b32 s54, -90112, s54
    s_cselect_b32 s51, 0, s51
    v_mfma_f32_16x16x32_bf16 v[40:43], v[120:123], v[76:79], v[40:43]
    v_mfma_f32_16x16x32_bf16 v[44:47], v[124:127], v[76:79], v[44:47]
    s_waitcnt lgkmcnt(0)
    v_mfma_f32_16x16x32_bf16 v[16:19], v[112:115], v[48:51], v[16:19]
    ds_read_b128 v[120:123], v13 offset:4096
    ds_read_b128 v[124:127], v13 offset:5120
    v_mfma_f32_16x16x32_bf16 v[20:23], v[116:119], v[48:51], v[20:23]
    ds_read_b128 v[64:67], v12 offset:8192
    ds_read_b128 v[68:71], v12 offset:9216
    v_mfma_f32_16x16x32_bf16 v[24:27], v[112:115], v[52:55], v[24:27]
    ds_read_b128 v[72:75], v12 offset:10240
    ds_read_b128 v[76:79], v12 offset:11264
    v_mfma_f32_16x16x32_bf16 v[28:31], v[116:119], v[52:55], v[28:31]
    v_add_u32 v12, s53, v12
    v_add_u32 v13, s54, v13
    v_mfma_f32_16x16x32_bf16 v[32:35], v[112:115], v[56:59], v[32:35]
    v_mfma_f32_16x16x32_bf16 v[36:39], v[116:119], v[56:59], v[36:39]
    v_mfma_f32_16x16x32_bf16 v[40:43], v[112:115], v[60:63], v[40:43]
    v_mfma_f32_16x16x32_bf16 v[44:47], v[116:119], v[60:63], v[44:47]
    s_waitcnt lgkmcnt(0)
    s_barrier
    v_mfma_f32_16x16x32_bf16 v[16:19], v[120:123], v[64:67], v[16:19]
    ds_read_b128 v[112:115], v13 offset:0
    ds_read_b128 v[116:119], v13 offset:1024
    v_mfma_f32_16x16x32_bf16 v[20:23], v[124:127], v[64:67], v[20:23]
    ds_read_b128 v[48:51], v12 offset:0
    ds_read_b128 v[52:55], v12 offset:1024
    v_mfma_f32_16x16x32_bf16 v[24:27], v[120:123], v[68:71], v[24:27]
    ds_read_b128 v[56:59], v12 offset:2048
    ds_read_b128 v[60:63], v12 offset:3072
    v_mfma_f32_16x16x32_bf16 v[28:31], v[124:127], v[68:71], v[28:31]
    s_add_u32 s50, s50, 1
    s_mov_b32 s53, 16384
    s_cmp_eq_u32 s50, 4
    s_cselect_b32 s53, -49152, s53
    v_mfma_f32_16x16x32_bf16 v[32:35], v[120:123], v[72:75], v[32:35]
    s_cselect_b32 s50, 0, s50
    s_add_u32 s51, s51, 1
    s_mov_b32 s54, 8192
    v_mfma_f32_16x16x32_bf16 v[36:39], v[124:127], v[72:75], v[36:39]
    s_cmp_eq_u32 s51, 12
    s_cselect_b32 s54, -90112, s54
    s_cselect_b32 s51, 0, s51
    v_mfma_f32_16x16x32_bf16 v[40:43], v[120:123], v[76:79], v[40:43]
    v_mfma_f32_16x16x32_bf16 v[44:47], v[124:127], v[76:79], v[44:47]
    s_waitcnt lgkmcnt(0)
    v_mfma_f32_16x16x32_bf16 v[16:19], v[112:115], v[48:51], v[16:19]
    ds_read_b128 v[120:123], v13 offset:4096
    ds_read_b128 v[124:127], v13 offset:5120
    v_mfma_f32_16x16x32_bf16 v[20:23], v[116:119], v[48:51], v[20:23]
    ds_read_b128 v[64:67], v12 offset:8192
    ds_read_b128 v[68:71], v12 offset:9216
    v_mfma_f32_16x16x32_bf16 v[24:27], v[112:115], v[52:55], v[24:27]
    ds_read_b128 v[72:75], v12 offset:10240
    ds_read_b128 v[76:79], v12 offset:11264
    v_mfma_f32_16x16x32_bf16 v[28:31], v[116:119], v[52:55], v[28:31]
    v_add_u32 v12, s53, v12
    v_add_u32 v13, s54, v13
    v_mfma_f32_16x16x32_bf16 v[32:35], v[112:115], v[56:59], v[32:35]
    v_mfma_f32_16x16x32_bf16 v[36:39], v[116:119], v[56:59], v[36:39]
    v_mfma_f32_16x16x32_bf16 v[40:43], v[112:115], v[60:63], v[40:43]
    v_mfma_f32_16x16x32_bf16 v[44:47], v[116:119], v[60:63], v[44:47]
    s_waitcnt lgkmcnt(0)
    s_barrier
    v_mfma_f32_16x16x32_bf16 v[16:19], v[120:123], v[64:67], v[16:19]
    ds_read_b128 v[112:115], v13 offset:0
    ds_read_b128 v[116:119], v13 offset:1024
    v_mfma_f32_16x16x32_bf16 v[20:23], v[124:127], v[64:67], v[20:23]
    ds_read_b128 v[48:51], v12 offset:0
    ds_read_b128 v[52:55], v12 offset:1024
    v_mfma_f32_16x16x32_bf16 v[24:27], v[120:123], v[68:71], v[24:27]
    ds_read_b128 v[56:59], v12 offset:2048
    ds_read_b128 v[60:63], v12 offset:3072
    v_mfma_f32_16x16x32_bf16 v[28:31], v[124:127], v[68:71], v[28:31]
    s_add_u32 s50, s50, 1
    s_mov_b32 s53, 16384
    s_cmp_eq_u32 s50, 4
    s_cselect_b32 s53, -49152, s53
    v_mfma_f32_16x16x32_bf16 v[32:35], v[120:123], v[72:75], v[32:35]
    s_cselect_b32 s50, 0, s50
    s_add_u32 s51, s51, 1
    s_mov_b32 s54, 8192
    v_mfma_f32_16x16x32_bf16 v[36:39], v[124:127], v[72:75], v[36:39]
    s_cmp_eq_u32 s51, 12
    s_cselect_b32 s54, -90112, s54
    s_cselect_b32 s51, 0, s51
    v_mfma_f32_16x16x32_bf16 v[40:43], v[120:123], v[76:79], v[40:43]
    v_mfma_f32_16x16x32_bf16 v[44:47], v[124:127], v[76:79], v[44:47]
    s_waitcnt lgkmcnt(0)
    v_mfma_f32_16x16x32_bf16 v[16:19], v[112:115], v[48:51], v[16:19]
    ds_read_b128 v[120:123], v13 offset:4096
    ds_read_b128 v[124:127], v13 offset:5120
    v_mfma_f32_16x16x32_bf16 v[20:23], v[116:119], v[48:51], v[20:23]
    ds_read_b128 v[64:67], v12 offset:8192
    ds_read_b128 v[68:71], v12 offset:9216
    v_mfma_f32_16x16x32_bf16 v[24:27], v[112:115], v[52:55], v[24:27]
    ds_read_b128 v[72:75], v12 offset:10240
    ds_read_b128 v[76:79], v12 offset:11264
    v_mfma_f32_16x16x32_bf16 v[28:31], v[116:119], v[52:55], v[28:31]
    v_add_u32 v12, s53, v12
    v_add_u32 v13, s54, v13
    v_mfma_f32_16x16x32_bf16 v[32:35], v[112:115], v[56:59], v[32:35]
    v_mfma_f32_16x16x32_bf16 v[36:39], v[116:119], v[56:59], v[36:39]
    v_mfma_f32_16x16x32_bf16 v[40:43], v[112:115], v[60:63], v[40:43]
    v_mfma_f32_16x16x32_bf16 v[44:47], v[116:119], v[60:63], v[44:47]
    s_waitcnt lgkmcnt(0)
    s_barrier
    v_mfma_f32_16x16x32_bf16 v[16:19], v[120:123], v[64:67], v[16:19]
    ds_read_b128 v[112:115], v13 offset:0
    ds_read_b128 v[116:119], v13 offset:1024
    v_mfma_f32_16x16x32_bf16 v[20:23], v[124:127], v[64:67], v[20:23]
    ds_read_b128 v[48:51], v12 offset:0
    ds_read_b128 v[52:55], v12 offset:1024
    v_mfma_f32_16x16x32_bf16 v[24:27], v[120:123], v[68:71], v[24:27]
    ds_read_b128 v[56:59], v12 offset:2048
    ds_read_b128 v[60:63], v12 offset:3072
    v_mfma_f32_16x16x32_bf16 v[28:31], v[124:127], v[68:71], v[28:31]
    s_add_u32 s50, s50, 1
    s_mov_b32 s53, 16384
    s_cmp_eq_u32 s50, 4
    s_cselect_b32 s53, -49152, s53
    v_mfma_f32_16x16x32_bf16 v[32:35], v[120:123], v[72:75], v[32:35]
    s_cselect_b32 s50, 0, s50
    s_add_u32 s51, s51, 1
    s_mov_b32 s54, 8192
    v_mfma_f32_16x16x32_bf16 v[36:39], v[124:127], v[72:75], v[36:39]
    s_cmp_eq_u32 s51, 12
    s_cselect_b32 s54, -90112, s54
    s_cselect_b32 s51, 0, s51
    v_mfma_f32_16x16x32_bf16 v[40:43], v[120:123], v[76:79], v[40:43]
    s_sub_u32 s52, s52, 1
    s_cmp_lg_u32 s52, 0
    v_mfma_f32_16x16x32_bf16 v[44:47], v[124:127], v[76:79], v[44:47]
    s_cbranch_scc1 wo_loop
    s_nop 1
    s_waitcnt lgkmcnt(0)
    s_lshl_b32 s41, s49, 13
    v_add_u32 v12, s41, v11
    s_nop 1
    v_cvt_pk_bf16_f32 v232, v16, v17
    v_cvt_pk_bf16_f32 v233, v18, v19
    v_cvt_pk_bf16_f32 v234, v20, v21
    v_cvt_pk_bf16_f32 v235, v22, v23
    buffer_store_dwordx4 v[232:235], v11, s[8:11], s44 offen offset:0 sc0 sc1
    ds_write_b128 v12, v[232:235] offset:0
    v_cvt_pk_bf16_f32 v236, v24, v25
    v_cvt_pk_bf16_f32 v237, v26, v27
    v_cvt_pk_bf16_f32 v238, v28, v29
    v_cvt_pk_bf16_f32 v239, v30, v31
    buffer_store_dwordx4 v[236:239], v11, s[8:11], s44 offen offset:1024 sc0 sc1
    ds_write_b128 v12, v[236:239] offset:1024
    v_cvt_pk_bf16_f32 v240, v32, v33
    v_cvt_pk_bf16_f32 v241, v34, v35
    v_cvt_pk_bf16_f32 v242, v36, v37
    v_cvt_pk_bf16_f32 v243, v38, v39
    buffer_store_dwordx4 v[240:243], v11, s[8:11], s44 offen offset:2048 sc0 sc1
    ds_write_b128 v12, v[240:243] offset:2048
    v_cvt_pk_bf16_f32 v244, v40, v41
    v_cvt_pk_bf16_f32 v245, v42, v43
    v_cvt_pk_bf16_f32 v246, v44, v45
    v_cvt_pk_bf16_f32 v247, v46, v47
    buffer_store_dwordx4 v[244:247], v11, s[8:11], s44 offen offset:3072 sc0 sc1
    ds_write_b128 v12, v[244:247] offset:3072
    v_dot2_f32_bf16 v2, v232, s47, 0
    v_dot2_f32_bf16 v3, v232, v232, 0
    v_dot2_f32_bf16 v4, v236, s47, 0
    v_dot2_f32_bf16 v5, v236, v236, 0
    v_dot2_f32_bf16 v6, v240, s47, 0
    v_dot2_f32_bf16 v7, v240, v240, 0
    v_dot2_f32_bf16 v8, v244, s47, 0
    v_dot2_f32_bf16 v9, v244, v244, 0
    v_dot2_f32_bf16 v2, v233, s47, v2
    v_dot2_f32_bf16 v3, v233, v233, v3
    v_dot2_f32_bf16 v4, v237, s47, v4
    v_dot2_f32_bf16 v5, v237, v237, v5
    v_dot2_f32_bf16 v6, v241, s47, v6
    v_dot2_f32_bf16 v7, v241, v241, v7
    v_dot2_f32_bf16 v8, v245, s47, v8
    v_dot2_f32_bf16 v9, v245, v245, v9
    v_dot2_f32_bf16 v2, v234, s47, v2
    v_dot2_f32_bf16 v3, v234, v234, v3
    v_dot2_f32_bf16 v4, v238, s47, v4
    v_dot2_f32_bf16 v5, v238, v238, v5
    v_dot2_f32_bf16 v6, v242, s47, v6
    v_dot2_f32_bf16 v7, v242, v242, v7
    v_dot2_f32_bf16 v8, v246, s47, v8
    v_dot2_f32_bf16 v9, v246, v246, v9
    v_dot2_f32_bf16 v2, v235, s47, v2
    v_dot2_f32_bf16 v3, v235, v235, v3
    v_dot2_f32_bf16 v4, v239, s47, v4
    v_dot2_f32_bf16 v5, v239, v239, v5
    v_dot2_f32_bf16 v6, v243, s47, v6
    v_dot2_f32_bf16 v7, v243, v243, v7
    v_dot2_f32_bf16 v8, v247, s47, v8
    v_dot2_f32_bf16 v9, v247, v247, v9
    s_nop 2
    v_permlane32_swap_b32 v2, v6
    v_permlane32_swap_b32 v3, v7
    v_permlane32_swap_b32 v4, v8
    v_permlane32_swap_b32 v5, v9
    s_nop 1
    v_pk_add_f32 v[2:3], v[2:3], v[6:7]
    v_pk_add_f32 v[4:5], v[4:5], v[8:9]
    s_nop 1
    v_permlane16_swap_b32 v2, v4
    v_permlane16_swap_b32 v3, v5
    s_nop 1
    v_pk_add_f32 v[2:3], v[2:3], v[4:5]
    buffer_store_dwordx2 v[2:3], v10, s[8:11], s45 offen sc0 sc1
ffn1_compute:
    s_lshl_b32 s41, s48, 12
    s_lshl_b32 s42, s49, 11
    s_add_u32 s41, s41, s42
    s_xor_b32 s42, s41, 2048
    v_lshl_add_u32 v6, v0, 4, s41
    v_lshl_add_u32 v7, v0, 4, s42
    v_mov_b32 v10, v6
    v_mov_b32 v11, v7
    s_lshr_b32 s41, s41, 3
    s_lshr_b32 s42, s42, 3
    v_and_b32 v4, 15, v0
    v_lshlrev_b32 v4, 3, v4
    v_add_u32 v4, 155648, v4
    v_add_u32 v2, s41, v4
    v_add_u32 v3, s42, v4
    v_lshrrev_b32 v5, 4, v0
    v_lshlrev_b32 v5, 4, v5
    v_add_u32 v5, 156672, v5
    s_lshl_b32 s41, s49, 9
    v_add_u32 v4, s41, v5
    s_lshl_b32 s41, s49, 13
    s_add_u32 s41, s41, 98304
    v_lshl_add_u32 v8, v0, 4, s41
    s_mov_b32 s41, 98304
    v_lshl_add_u32 v9, v0, 4, s41
    s_mul_i32 s40, s4, 917504
    s_add_u32 s40, s40, s36
    s_add_u32 s40, s40, 0x1000000
    s_and_b32 s41, s5, 1
    s_mul_i32 s41, s41, 458752
    s_add_u32 s40, s40, s41
    s_and_b32 s41, s5, 14
    s_add_u32 s41, s41, s49
    s_lshl_b32 s41, s41, 13
    s_add_u32 s56, s40, s41
    s_add_u32 s57, s56, 131072
    s_add_u32 s58, s56, 262144
    s_lshr_b32 s41, s5, 1
    s_lshl_b32 s41, s41, 13
    s_add_u32 s59, s40, s41
    s_add_u32 s59, s59, 393216
    s_waitcnt lgkmcnt(0)
    s_barrier
    ds_read_b128 v[124:127], v6 offset:0
    ds_read_b128 v[128:131], v6 offset:1024
    ds_read_b128 v[132:135], v7 offset:0
    ds_read_b128 v[136:139], v7 offset:1024
    ds_read_b128 v[156:159], v8 offset:0
    ds_read_b128 v[160:163], v8 offset:1024
    ds_read_b128 v[164:167], v8 offset:2048
    ds_read_b128 v[168:171], v8 offset:3072
    ds_read_b128 v[172:175], v8 offset:4096
    ds_read_b128 v[176:179], v8 offset:5120
    ds_read_b128 v[180:183], v9 offset:6144
    ds_read_b128 v[184:187], v9 offset:7168
    s_waitcnt lgkmcnt(0)
    v_mfma_f32_16x16x32_bf16 v[12:15], v[156:159], v[124:127], 0
    ds_read_b128 v[140:143], v6 offset:8192
    v_mfma_f32_16x16x32_bf16 v[44:47], v[156:159], v[128:131], 0
    ds_read_b128 v[144:147], v6 offset:9216
    v_mfma_f32_16x16x32_bf16 v[76:79], v[156:159], v[132:135], 0
    ds_read_b128 v[148:151], v7 offset:8192
    v_mfma_f32_16x16x32_bf16 v[100:103], v[156:159], v[136:139], 0
    ds_read_b128 v[152:155], v7 offset:9216
    v_mfma_f32_16x16x32_bf16 v[104:107], v[160:163], v[136:139], 0
    ds_read_b128 v[188:191], v8 offset:14336
    v_mfma_f32_16x16x32_bf16 v[80:83], v[160:163], v[132:135], 0
    ds_read_b128 v[192:195], v8 offset:15360
    v_mfma_f32_16x16x32_bf16 v[48:51], v[160:163], v[128:131], 0
    ds_read_b128 v[196:199], v8 offset:16384
    v_mfma_f32_16x16x32_bf16 v[16:19], v[160:163], v[124:127], 0
    ds_read_b128 v[200:203], v8 offset:17408
    v_mfma_f32_16x16x32_bf16 v[20:23], v[164:167], v[124:127], 0
    ds_read_b128 v[204:207], v8 offset:18432
    v_mfma_f32_16x16x32_bf16 v[52:55], v[164:167], v[128:131], 0
    ds_read_b128 v[208:211], v8 offset:19456
    v_mfma_f32_16x16x32_bf16 v[84:87], v[164:167], v[132:135], 0
    ds_read_b128 v[212:215], v9 offset:20480
    v_mfma_f32_16x16x32_bf16 v[108:111], v[164:167], v[136:139], 0
    ds_read_b128 v[216:219], v9 offset:21504
    v_mfma_f32_16x16x32_bf16 v[112:115], v[168:171], v[136:139], 0
    v_add_u32 v6, 16384, v6
    v_mfma_f32_16x16x32_bf16 v[88:91], v[168:171], v[132:135], 0
    v_add_u32 v7, 16384, v7
    v_mfma_f32_16x16x32_bf16 v[56:59], v[168:171], v[128:131], 0
    v_add_u32 v8, 28672, v8
    v_mfma_f32_16x16x32_bf16 v[24:27], v[168:171], v[124:127], 0
    v_add_u32 v9, 28672, v9
    v_mfma_f32_16x16x32_bf16 v[28:31], v[172:175], v[124:127], 0
    v_mfma_f32_16x16x32_bf16 v[60:63], v[172:175], v[128:131], 0
    v_mfma_f32_16x16x32_bf16 v[92:95], v[172:175], v[132:135], 0
    v_mfma_f32_16x16x32_bf16 v[116:119], v[172:175], v[136:139], 0
    v_mfma_f32_16x16x32_bf16 v[120:123], v[176:179], v[136:139], 0
    v_mfma_f32_16x16x32_bf16 v[96:99], v[176:179], v[132:135], 0
    v_mfma_f32_16x16x32_bf16 v[64:67], v[176:179], v[128:131], 0
    v_mfma_f32_16x16x32_bf16 v[32:35], v[176:179], v[124:127], 0
    v_mfma_f32_16x16x32_bf16 v[36:39], v[180:183], v[124:127], 0
    v_mfma_f32_16x16x32_bf16 v[68:71], v[180:183], v[128:131], 0
    v_mfma_f32_16x16x32_bf16 v[72:75], v[184:187], v[128:131], 0
    v_mfma_f32_16x16x32_bf16 v[40:43], v[184:187], v[124:127], 0
    s_waitcnt lgkmcnt(0)
    s_waitcnt vmcnt(0)
    s_barrier
    s_cmp_lg_u32 s6, 0
    s_cbranch_scc1 pub_25
    s_lshl_b32 s60, s4, 11
    s_add_u32 s60, s60, s38
    s_add_u32 s60, s60, 32768
    s_lshl_b32 s61, s5, 2
    s_add_u32 s61, s61, s60
    v_mov_b32 v124, 1
    s_mov_b64 exec, 1
    buffer_store_dword v124, off, s[8:11], s61 sc0 sc1
    s_mov_b64 exec, -1
pub_25:
    v_mfma_f32_16x16x32_bf16 v[12:15], v[188:191], v[140:143], v[12:15]
    v_mfma_f32_16x16x32_bf16 v[44:47], v[188:191], v[144:147], v[44:47]
    v_mfma_f32_16x16x32_bf16 v[76:79], v[188:191], v[148:151], v[76:79]
    v_mfma_f32_16x16x32_bf16 v[100:103], v[188:191], v[152:155], v[100:103]
    v_mfma_f32_16x16x32_bf16 v[104:107], v[192:195], v[152:155], v[104:107]
    v_mfma_f32_16x16x32_bf16 v[80:83], v[192:195], v[148:151], v[80:83]
    v_mfma_f32_16x16x32_bf16 v[48:51], v[192:195], v[144:147], v[48:51]
    v_mfma_f32_16x16x32_bf16 v[16:19], v[192:195], v[140:143], v[16:19]
    v_mfma_f32_16x16x32_bf16 v[20:23], v[196:199], v[140:143], v[20:23]
    v_mfma_f32_16x16x32_bf16 v[52:55], v[196:199], v[144:147], v[52:55]
    v_mfma_f32_16x16x32_bf16 v[84:87], v[196:199], v[148:151], v[84:87]
    v_mfma_f32_16x16x32_bf16 v[108:111], v[196:199], v[152:155], v[108:111]
    v_mfma_f32_16x16x32_bf16 v[112:115], v[200:203], v[152:155], v[112:115]
    v_mfma_f32_16x16x32_bf16 v[88:91], v[200:203], v[148:151], v[88:91]
    v_mfma_f32_16x16x32_bf16 v[56:59], v[200:203], v[144:147], v[56:59]
    v_mfma_f32_16x16x32_bf16 v[24:27], v[200:203], v[140:143], v[24:27]
    v_mfma_f32_16x16x32_bf16 v[28:31], v[204:207], v[140:143], v[28:31]
    v_mfma_f32_16x16x32_bf16 v[60:63], v[204:207], v[144:147], v[60:63]
    v_mfma_f32_16x16x32_bf16 v[92:95], v[204:207], v[148:151], v[92:95]
    v_mfma_f32_16x16x32_bf16 v[116:119], v[204:207], v[152:155], v[116:119]
    v_mfma_f32_16x16x32_bf16 v[120:123], v[208:211], v[152:155], v[120:123]
    v_mfma_f32_16x16x32_bf16 v[96:99], v[208:211], v[148:151], v[96:99]
    v_mfma_f32_16x16x32_bf16 v[64:67], v[208:211], v[144:147], v[64:67]
    v_mfma_f32_16x16x32_bf16 v[32:35], v[208:211], v[140:143], v[32:35]
    v_mfma_f32_16x16x32_bf16 v[36:39], v[212:215], v[140:143], v[36:39]
    v_mfma_f32_16x16x32_bf16 v[68:71], v[212:215], v[144:147], v[68:71]
    v_mfma_f32_16x16x32_bf16 v[72:75], v[216:219], v[144:147], v[72:75]
    v_mfma_f32_16x16x32_bf16 v[40:43], v[216:219], v[140:143], v[40:43]
    s_barrier
    s_mov_b32 s50, 1
    s_mov_b32 s51, 2
    s_mov_b32 s52, 5
    s_add_u32 s50, s50, 1
    s_mov_b32 s53, 16384
    s_cmp_eq_u32 s50, 3
    s_cselect_b32 s53, -32768, s53
    s_cselect_b32 s50, 0, s50
    s_add_u32 s51, s51, 1
    s_mov_b32 s54, 28672
    s_cmp_eq_u32 s51, 3
    s_cselect_b32 s54, -57344, s54
    s_cselect_b32 s51, 0, s51
    s_barrier
    ds_read_b128 v[124:127], v6 offset:0
    ds_read_b128 v[128:131], v6 offset:1024
    ds_read_b128 v[132:135], v7 offset:0
    ds_read_b128 v[136:139], v7 offset:1024
    ds_read_b128 v[156:159], v8 offset:0
    ds_read_b128 v[160:163], v8 offset:1024
    ds_read_b128 v[164:167], v8 offset:2048
    ds_read_b128 v[168:171], v8 offset:3072
    ds_read_b128 v[172:175], v8 offset:4096
    ds_read_b128 v[176:179], v8 offset:5120
    ds_read_b128 v[180:183], v9 offset:6144
    ds_read_b128 v[184:187], v9 offset:7168
    .p2align 6
ffn1_loop:
    s_waitcnt lgkmcnt(0)
    v_mfma_f32_16x16x32_bf16 v[12:15], v[156:159], v[124:127], v[12:15]
    ds_read_b128 v[140:143], v6 offset:8192
    v_mfma_f32_16x16x32_bf16 v[44:47], v[156:159], v[128:131], v[44:47]
    ds_read_b128 v[144:147], v6 offset:9216
    v_mfma_f32_16x16x32_bf16 v[76:79], v[156:159], v[132:135], v[76:79]
    ds_read_b128 v[148:151], v7 offset:8192
    v_mfma_f32_16x16x32_bf16 v[100:103], v[156:159], v[136:139], v[100:103]
    ds_read_b128 v[152:155], v7 offset:9216
    v_mfma_f32_16x16x32_bf16 v[104:107], v[160:163], v[136:139], v[104:107]
    ds_read_b128 v[188:191], v8 offset:14336
    v_mfma_f32_16x16x32_bf16 v[80:83], v[160:163], v[132:135], v[80:83]
    ds_read_b128 v[192:195], v8 offset:15360
    v_mfma_f32_16x16x32_bf16 v[48:51], v[160:163], v[128:131], v[48:51]
    ds_read_b128 v[196:199], v8 offset:16384
    v_mfma_f32_16x16x32_bf16 v[16:19], v[160:163], v[124:127], v[16:19]
    ds_read_b128 v[200:203], v8 offset:17408
    v_mfma_f32_16x16x32_bf16 v[20:23], v[164:167], v[124:127], v[20:23]
    ds_read_b128 v[204:207], v8 offset:18432
    v_mfma_f32_16x16x32_bf16 v[52:55], v[164:167], v[128:131], v[52:55]
    ds_read_b128 v[208:211], v8 offset:19456
    v_mfma_f32_16x16x32_bf16 v[84:87], v[164:167], v[132:135], v[84:87]
    ds_read_b128 v[212:215], v9 offset:20480
    v_mfma_f32_16x16x32_bf16 v[108:111], v[164:167], v[136:139], v[108:111]
    ds_read_b128 v[216:219], v9 offset:21504
    v_mfma_f32_16x16x32_bf16 v[112:115], v[168:171], v[136:139], v[112:115]
    v_add_u32 v6, s53, v6
    v_mfma_f32_16x16x32_bf16 v[88:91], v[168:171], v[132:135], v[88:91]
    v_add_u32 v7, s53, v7
    v_mfma_f32_16x16x32_bf16 v[56:59], v[168:171], v[128:131], v[56:59]
    v_add_u32 v8, s54, v8
    v_mfma_f32_16x16x32_bf16 v[24:27], v[168:171], v[124:127], v[24:27]
    v_add_u32 v9, s54, v9
    v_mfma_f32_16x16x32_bf16 v[28:31], v[172:175], v[124:127], v[28:31]
    v_mfma_f32_16x16x32_bf16 v[60:63], v[172:175], v[128:131], v[60:63]
    v_mfma_f32_16x16x32_bf16 v[92:95], v[172:175], v[132:135], v[92:95]
    v_mfma_f32_16x16x32_bf16 v[116:119], v[172:175], v[136:139], v[116:119]
    v_mfma_f32_16x16x32_bf16 v[120:123], v[176:179], v[136:139], v[120:123]
    v_mfma_f32_16x16x32_bf16 v[96:99], v[176:179], v[132:135], v[96:99]
    v_mfma_f32_16x16x32_bf16 v[64:67], v[176:179], v[128:131], v[64:67]
    v_mfma_f32_16x16x32_bf16 v[32:35], v[176:179], v[124:127], v[32:35]
    v_mfma_f32_16x16x32_bf16 v[36:39], v[180:183], v[124:127], v[36:39]
    v_mfma_f32_16x16x32_bf16 v[68:71], v[180:183], v[128:131], v[68:71]
    v_mfma_f32_16x16x32_bf16 v[72:75], v[184:187], v[128:131], v[72:75]
    v_mfma_f32_16x16x32_bf16 v[40:43], v[184:187], v[124:127], v[40:43]
    s_waitcnt lgkmcnt(0)
    s_barrier
    v_mfma_f32_16x16x32_bf16 v[12:15], v[188:191], v[140:143], v[12:15]
    ds_read_b128 v[124:127], v6 offset:0
    v_mfma_f32_16x16x32_bf16 v[44:47], v[188:191], v[144:147], v[44:47]
    ds_read_b128 v[128:131], v6 offset:1024
    v_mfma_f32_16x16x32_bf16 v[76:79], v[188:191], v[148:151], v[76:79]
    ds_read_b128 v[132:135], v7 offset:0
    v_mfma_f32_16x16x32_bf16 v[100:103], v[188:191], v[152:155], v[100:103]
    ds_read_b128 v[136:139], v7 offset:1024
    v_mfma_f32_16x16x32_bf16 v[104:107], v[192:195], v[152:155], v[104:107]
    ds_read_b128 v[156:159], v8 offset:0
    v_mfma_f32_16x16x32_bf16 v[80:83], v[192:195], v[148:151], v[80:83]
    ds_read_b128 v[160:163], v8 offset:1024
    v_mfma_f32_16x16x32_bf16 v[48:51], v[192:195], v[144:147], v[48:51]
    ds_read_b128 v[164:167], v8 offset:2048
    v_mfma_f32_16x16x32_bf16 v[16:19], v[192:195], v[140:143], v[16:19]
    ds_read_b128 v[168:171], v8 offset:3072
    v_mfma_f32_16x16x32_bf16 v[20:23], v[196:199], v[140:143], v[20:23]
    ds_read_b128 v[172:175], v8 offset:4096
    v_mfma_f32_16x16x32_bf16 v[52:55], v[196:199], v[144:147], v[52:55]
    ds_read_b128 v[176:179], v8 offset:5120
    v_mfma_f32_16x16x32_bf16 v[84:87], v[196:199], v[148:151], v[84:87]
    ds_read_b128 v[180:183], v9 offset:6144
    v_mfma_f32_16x16x32_bf16 v[108:111], v[196:199], v[152:155], v[108:111]
    ds_read_b128 v[184:187], v9 offset:7168
    v_mfma_f32_16x16x32_bf16 v[112:115], v[200:203], v[152:155], v[112:115]
    s_add_u32 s50, s50, 1
    s_mov_b32 s53, 16384
    v_mfma_f32_16x16x32_bf16 v[88:91], v[200:203], v[148:151], v[88:91]
    s_cmp_eq_u32 s50, 3
    s_cselect_b32 s53, -32768, s53
    v_mfma_f32_16x16x32_bf16 v[56:59], v[200:203], v[144:147], v[56:59]
    s_cselect_b32 s50, 0, s50
    v_mfma_f32_16x16x32_bf16 v[24:27], v[200:203], v[140:143], v[24:27]
    s_add_u32 s51, s51, 1
    s_mov_b32 s54, 28672
    v_mfma_f32_16x16x32_bf16 v[28:31], v[204:207], v[140:143], v[28:31]
    s_cmp_eq_u32 s51, 3
    s_cselect_b32 s54, -57344, s54
    v_mfma_f32_16x16x32_bf16 v[60:63], v[204:207], v[144:147], v[60:63]
    s_cselect_b32 s51, 0, s51
    v_mfma_f32_16x16x32_bf16 v[92:95], v[204:207], v[148:151], v[92:95]
    v_mfma_f32_16x16x32_bf16 v[116:119], v[204:207], v[152:155], v[116:119]
    v_mfma_f32_16x16x32_bf16 v[120:123], v[208:211], v[152:155], v[120:123]
    v_mfma_f32_16x16x32_bf16 v[96:99], v[208:211], v[148:151], v[96:99]
    v_mfma_f32_16x16x32_bf16 v[64:67], v[208:211], v[144:147], v[64:67]
    v_mfma_f32_16x16x32_bf16 v[32:35], v[208:211], v[140:143], v[32:35]
    v_mfma_f32_16x16x32_bf16 v[36:39], v[212:215], v[140:143], v[36:39]
    v_mfma_f32_16x16x32_bf16 v[68:71], v[212:215], v[144:147], v[68:71]
    v_mfma_f32_16x16x32_bf16 v[72:75], v[216:219], v[144:147], v[72:75]
    v_mfma_f32_16x16x32_bf16 v[40:43], v[216:219], v[140:143], v[40:43]
    s_waitcnt lgkmcnt(0)
    v_mfma_f32_16x16x32_bf16 v[12:15], v[156:159], v[124:127], v[12:15]
    ds_read_b128 v[140:143], v6 offset:8192
    v_mfma_f32_16x16x32_bf16 v[44:47], v[156:159], v[128:131], v[44:47]
    ds_read_b128 v[144:147], v6 offset:9216
    v_mfma_f32_16x16x32_bf16 v[76:79], v[156:159], v[132:135], v[76:79]
    ds_read_b128 v[148:151], v7 offset:8192
    v_mfma_f32_16x16x32_bf16 v[100:103], v[156:159], v[136:139], v[100:103]
    ds_read_b128 v[152:155], v7 offset:9216
    v_mfma_f32_16x16x32_bf16 v[104:107], v[160:163], v[136:139], v[104:107]
    ds_read_b128 v[188:191], v8 offset:14336
    v_mfma_f32_16x16x32_bf16 v[80:83], v[160:163], v[132:135], v[80:83]
    ds_read_b128 v[192:195], v8 offset:15360
    v_mfma_f32_16x16x32_bf16 v[48:51], v[160:163], v[128:131], v[48:51]
    ds_read_b128 v[196:199], v8 offset:16384
    v_mfma_f32_16x16x32_bf16 v[16:19], v[160:163], v[124:127], v[16:19]
    ds_read_b128 v[200:203], v8 offset:17408
    v_mfma_f32_16x16x32_bf16 v[20:23], v[164:167], v[124:127], v[20:23]
    ds_read_b128 v[204:207], v8 offset:18432
    v_mfma_f32_16x16x32_bf16 v[52:55], v[164:167], v[128:131], v[52:55]
    ds_read_b128 v[208:211], v8 offset:19456
    v_mfma_f32_16x16x32_bf16 v[84:87], v[164:167], v[132:135], v[84:87]
    ds_read_b128 v[212:215], v9 offset:20480
    v_mfma_f32_16x16x32_bf16 v[108:111], v[164:167], v[136:139], v[108:111]
    ds_read_b128 v[216:219], v9 offset:21504
    v_mfma_f32_16x16x32_bf16 v[112:115], v[168:171], v[136:139], v[112:115]
    v_add_u32 v6, s53, v6
    v_mfma_f32_16x16x32_bf16 v[88:91], v[168:171], v[132:135], v[88:91]
    v_add_u32 v7, s53, v7
    v_mfma_f32_16x16x32_bf16 v[56:59], v[168:171], v[128:131], v[56:59]
    v_add_u32 v8, s54, v8
    v_mfma_f32_16x16x32_bf16 v[24:27], v[168:171], v[124:127], v[24:27]
    v_add_u32 v9, s54, v9
    v_mfma_f32_16x16x32_bf16 v[28:31], v[172:175], v[124:127], v[28:31]
    v_mfma_f32_16x16x32_bf16 v[60:63], v[172:175], v[128:131], v[60:63]
    v_mfma_f32_16x16x32_bf16 v[92:95], v[172:175], v[132:135], v[92:95]
    v_mfma_f32_16x16x32_bf16 v[116:119], v[172:175], v[136:139], v[116:119]
    v_mfma_f32_16x16x32_bf16 v[120:123], v[176:179], v[136:139], v[120:123]
    v_mfma_f32_16x16x32_bf16 v[96:99], v[176:179], v[132:135], v[96:99]
    v_mfma_f32_16x16x32_bf16 v[64:67], v[176:179], v[128:131], v[64:67]
    v_mfma_f32_16x16x32_bf16 v[32:35], v[176:179], v[124:127], v[32:35]
    v_mfma_f32_16x16x32_bf16 v[36:39], v[180:183], v[124:127], v[36:39]
    v_mfma_f32_16x16x32_bf16 v[68:71], v[180:183], v[128:131], v[68:71]
    v_mfma_f32_16x16x32_bf16 v[72:75], v[184:187], v[128:131], v[72:75]
    v_mfma_f32_16x16x32_bf16 v[40:43], v[184:187], v[124:127], v[40:43]
    s_waitcnt lgkmcnt(0)
    s_barrier
    v_mfma_f32_16x16x32_bf16 v[12:15], v[188:191], v[140:143], v[12:15]
    ds_read_b128 v[124:127], v6 offset:0
    v_mfma_f32_16x16x32_bf16 v[44:47], v[188:191], v[144:147], v[44:47]
    ds_read_b128 v[128:131], v6 offset:1024
    v_mfma_f32_16x16x32_bf16 v[76:79], v[188:191], v[148:151], v[76:79]
    ds_read_b128 v[132:135], v7 offset:0
    v_mfma_f32_16x16x32_bf16 v[100:103], v[188:191], v[152:155], v[100:103]
    ds_read_b128 v[136:139], v7 offset:1024
    v_mfma_f32_16x16x32_bf16 v[104:107], v[192:195], v[152:155], v[104:107]
    ds_read_b128 v[156:159], v8 offset:0
    v_mfma_f32_16x16x32_bf16 v[80:83], v[192:195], v[148:151], v[80:83]
    ds_read_b128 v[160:163], v8 offset:1024
    v_mfma_f32_16x16x32_bf16 v[48:51], v[192:195], v[144:147], v[48:51]
    ds_read_b128 v[164:167], v8 offset:2048
    v_mfma_f32_16x16x32_bf16 v[16:19], v[192:195], v[140:143], v[16:19]
    ds_read_b128 v[168:171], v8 offset:3072
    v_mfma_f32_16x16x32_bf16 v[20:23], v[196:199], v[140:143], v[20:23]
    ds_read_b128 v[172:175], v8 offset:4096
    v_mfma_f32_16x16x32_bf16 v[52:55], v[196:199], v[144:147], v[52:55]
    ds_read_b128 v[176:179], v8 offset:5120
    v_mfma_f32_16x16x32_bf16 v[84:87], v[196:199], v[148:151], v[84:87]
    ds_read_b128 v[180:183], v9 offset:6144
    v_mfma_f32_16x16x32_bf16 v[108:111], v[196:199], v[152:155], v[108:111]
    ds_read_b128 v[184:187], v9 offset:7168
    v_mfma_f32_16x16x32_bf16 v[112:115], v[200:203], v[152:155], v[112:115]
    s_add_u32 s50, s50, 1
    s_mov_b32 s53, 16384
    v_mfma_f32_16x16x32_bf16 v[88:91], v[200:203], v[148:151], v[88:91]
    s_cmp_eq_u32 s50, 3
    s_cselect_b32 s53, -32768, s53
    v_mfma_f32_16x16x32_bf16 v[56:59], v[200:203], v[144:147], v[56:59]
    s_cselect_b32 s50, 0, s50
    v_mfma_f32_16x16x32_bf16 v[24:27], v[200:203], v[140:143], v[24:27]
    s_add_u32 s51, s51, 1
    s_mov_b32 s54, 28672
    v_mfma_f32_16x16x32_bf16 v[28:31], v[204:207], v[140:143], v[28:31]
    s_cmp_eq_u32 s51, 3
    s_cselect_b32 s54, -57344, s54
    v_mfma_f32_16x16x32_bf16 v[60:63], v[204:207], v[144:147], v[60:63]
    s_cselect_b32 s51, 0, s51
    v_mfma_f32_16x16x32_bf16 v[92:95], v[204:207], v[148:151], v[92:95]
    v_mfma_f32_16x16x32_bf16 v[116:119], v[204:207], v[152:155], v[116:119]
    v_mfma_f32_16x16x32_bf16 v[120:123], v[208:211], v[152:155], v[120:123]
    v_mfma_f32_16x16x32_bf16 v[96:99], v[208:211], v[148:151], v[96:99]
    v_mfma_f32_16x16x32_bf16 v[64:67], v[208:211], v[144:147], v[64:67]
    v_mfma_f32_16x16x32_bf16 v[32:35], v[208:211], v[140:143], v[32:35]
    v_mfma_f32_16x16x32_bf16 v[36:39], v[212:215], v[140:143], v[36:39]
    v_mfma_f32_16x16x32_bf16 v[68:71], v[212:215], v[144:147], v[68:71]
    v_mfma_f32_16x16x32_bf16 v[72:75], v[216:219], v[144:147], v[72:75]
    v_mfma_f32_16x16x32_bf16 v[40:43], v[216:219], v[140:143], v[40:43]
    s_waitcnt lgkmcnt(0)
    v_mfma_f32_16x16x32_bf16 v[12:15], v[156:159], v[124:127], v[12:15]
    ds_read_b128 v[140:143], v6 offset:8192
    v_mfma_f32_16x16x32_bf16 v[44:47], v[156:159], v[128:131], v[44:47]
    ds_read_b128 v[144:147], v6 offset:9216
    v_mfma_f32_16x16x32_bf16 v[76:79], v[156:159], v[132:135], v[76:79]
    ds_read_b128 v[148:151], v7 offset:8192
    v_mfma_f32_16x16x32_bf16 v[100:103], v[156:159], v[136:139], v[100:103]
    ds_read_b128 v[152:155], v7 offset:9216
    v_mfma_f32_16x16x32_bf16 v[104:107], v[160:163], v[136:139], v[104:107]
    ds_read_b128 v[188:191], v8 offset:14336
    v_mfma_f32_16x16x32_bf16 v[80:83], v[160:163], v[132:135], v[80:83]
    ds_read_b128 v[192:195], v8 offset:15360
    v_mfma_f32_16x16x32_bf16 v[48:51], v[160:163], v[128:131], v[48:51]
    ds_read_b128 v[196:199], v8 offset:16384
    v_mfma_f32_16x16x32_bf16 v[16:19], v[160:163], v[124:127], v[16:19]
    ds_read_b128 v[200:203], v8 offset:17408
    v_mfma_f32_16x16x32_bf16 v[20:23], v[164:167], v[124:127], v[20:23]
    ds_read_b128 v[204:207], v8 offset:18432
    v_mfma_f32_16x16x32_bf16 v[52:55], v[164:167], v[128:131], v[52:55]
    ds_read_b128 v[208:211], v8 offset:19456
    v_mfma_f32_16x16x32_bf16 v[84:87], v[164:167], v[132:135], v[84:87]
    ds_read_b128 v[212:215], v9 offset:20480
    v_mfma_f32_16x16x32_bf16 v[108:111], v[164:167], v[136:139], v[108:111]
    ds_read_b128 v[216:219], v9 offset:21504
    v_mfma_f32_16x16x32_bf16 v[112:115], v[168:171], v[136:139], v[112:115]
    v_add_u32 v6, s53, v6
    v_mfma_f32_16x16x32_bf16 v[88:91], v[168:171], v[132:135], v[88:91]
    v_add_u32 v7, s53, v7
    v_mfma_f32_16x16x32_bf16 v[56:59], v[168:171], v[128:131], v[56:59]
    v_add_u32 v8, s54, v8
    v_mfma_f32_16x16x32_bf16 v[24:27], v[168:171], v[124:127], v[24:27]
    v_add_u32 v9, s54, v9
    v_mfma_f32_16x16x32_bf16 v[28:31], v[172:175], v[124:127], v[28:31]
    v_mfma_f32_16x16x32_bf16 v[60:63], v[172:175], v[128:131], v[60:63]
    v_mfma_f32_16x16x32_bf16 v[92:95], v[172:175], v[132:135], v[92:95]
    v_mfma_f32_16x16x32_bf16 v[116:119], v[172:175], v[136:139], v[116:119]
    v_mfma_f32_16x16x32_bf16 v[120:123], v[176:179], v[136:139], v[120:123]
    v_mfma_f32_16x16x32_bf16 v[96:99], v[176:179], v[132:135], v[96:99]
    v_mfma_f32_16x16x32_bf16 v[64:67], v[176:179], v[128:131], v[64:67]
    v_mfma_f32_16x16x32_bf16 v[32:35], v[176:179], v[124:127], v[32:35]
    v_mfma_f32_16x16x32_bf16 v[36:39], v[180:183], v[124:127], v[36:39]
    v_mfma_f32_16x16x32_bf16 v[68:71], v[180:183], v[128:131], v[68:71]
    v_mfma_f32_16x16x32_bf16 v[72:75], v[184:187], v[128:131], v[72:75]
    v_mfma_f32_16x16x32_bf16 v[40:43], v[184:187], v[124:127], v[40:43]
    s_waitcnt lgkmcnt(0)
    s_barrier
    v_mfma_f32_16x16x32_bf16 v[12:15], v[188:191], v[140:143], v[12:15]
    ds_read_b128 v[124:127], v6 offset:0
    v_mfma_f32_16x16x32_bf16 v[44:47], v[188:191], v[144:147], v[44:47]
    ds_read_b128 v[128:131], v6 offset:1024
    v_mfma_f32_16x16x32_bf16 v[76:79], v[188:191], v[148:151], v[76:79]
    ds_read_b128 v[132:135], v7 offset:0
    v_mfma_f32_16x16x32_bf16 v[100:103], v[188:191], v[152:155], v[100:103]
    ds_read_b128 v[136:139], v7 offset:1024
    v_mfma_f32_16x16x32_bf16 v[104:107], v[192:195], v[152:155], v[104:107]
    ds_read_b128 v[156:159], v8 offset:0
    v_mfma_f32_16x16x32_bf16 v[80:83], v[192:195], v[148:151], v[80:83]
    ds_read_b128 v[160:163], v8 offset:1024
    v_mfma_f32_16x16x32_bf16 v[48:51], v[192:195], v[144:147], v[48:51]
    ds_read_b128 v[164:167], v8 offset:2048
    v_mfma_f32_16x16x32_bf16 v[16:19], v[192:195], v[140:143], v[16:19]
    ds_read_b128 v[168:171], v8 offset:3072
    v_mfma_f32_16x16x32_bf16 v[20:23], v[196:199], v[140:143], v[20:23]
    ds_read_b128 v[172:175], v8 offset:4096
    v_mfma_f32_16x16x32_bf16 v[52:55], v[196:199], v[144:147], v[52:55]
    ds_read_b128 v[176:179], v8 offset:5120
    v_mfma_f32_16x16x32_bf16 v[84:87], v[196:199], v[148:151], v[84:87]
    ds_read_b128 v[180:183], v9 offset:6144
    v_mfma_f32_16x16x32_bf16 v[108:111], v[196:199], v[152:155], v[108:111]
    ds_read_b128 v[184:187], v9 offset:7168
    v_mfma_f32_16x16x32_bf16 v[112:115], v[200:203], v[152:155], v[112:115]
    s_add_u32 s50, s50, 1
    s_mov_b32 s53, 16384
    v_mfma_f32_16x16x32_bf16 v[88:91], v[200:203], v[148:151], v[88:91]
    s_cmp_eq_u32 s50, 3
    s_cselect_b32 s53, -32768, s53
    v_mfma_f32_16x16x32_bf16 v[56:59], v[200:203], v[144:147], v[56:59]
    s_cselect_b32 s50, 0, s50
    v_mfma_f32_16x16x32_bf16 v[24:27], v[200:203], v[140:143], v[24:27]
    s_add_u32 s51, s51, 1
    s_mov_b32 s54, 28672
    v_mfma_f32_16x16x32_bf16 v[28:31], v[204:207], v[140:143], v[28:31]
    s_cmp_eq_u32 s51, 3
    s_cselect_b32 s54, -57344, s54
    v_mfma_f32_16x16x32_bf16 v[60:63], v[204:207], v[144:147], v[60:63]
    s_cselect_b32 s51, 0, s51
    v_mfma_f32_16x16x32_bf16 v[92:95], v[204:207], v[148:151], v[92:95]
    s_sub_u32 s52, s52, 1
    s_cmp_lg_u32 s52, 0
    v_mfma_f32_16x16x32_bf16 v[116:119], v[204:207], v[152:155], v[116:119]
    v_mfma_f32_16x16x32_bf16 v[120:123], v[208:211], v[152:155], v[120:123]
    v_mfma_f32_16x16x32_bf16 v[96:99], v[208:211], v[148:151], v[96:99]
    v_mfma_f32_16x16x32_bf16 v[64:67], v[208:211], v[144:147], v[64:67]
    v_mfma_f32_16x16x32_bf16 v[32:35], v[208:211], v[140:143], v[32:35]
    v_mfma_f32_16x16x32_bf16 v[36:39], v[212:215], v[140:143], v[36:39]
    v_mfma_f32_16x16x32_bf16 v[68:71], v[212:215], v[144:147], v[68:71]
    v_mfma_f32_16x16x32_bf16 v[72:75], v[216:219], v[144:147], v[72:75]
    v_mfma_f32_16x16x32_bf16 v[40:43], v[216:219], v[140:143], v[40:43]
    s_cbranch_scc1 ffn1_loop
    s_nop 1
    s_waitcnt lgkmcnt(0)
ffn1_epi:
    ds_read_b64 v[124:125], v2 offset:0
    ds_read_b64 v[126:127], v2 offset:128
    ds_read_b64 v[128:129], v3 offset:0
    ds_read_b64 v[130:131], v3 offset:128
    ds_read_b128 v[156:159], v4 offset:0
    ds_read_b128 v[160:163], v4 offset:64
    ds_read_b128 v[164:167], v4 offset:128
    ds_read_b128 v[168:171], v4 offset:192
    ds_read_b128 v[172:175], v4 offset:256
    ds_read_b128 v[176:179], v4 offset:320
    ds_read_b128 v[180:183], v5 offset:384
    ds_read_b128 v[184:187], v5 offset:448
    s_waitcnt lgkmcnt(8)
    v_rcp_f32 v132, v125
    v_rcp_f32 v134, v127
    v_rcp_f32 v136, v129
    v_rcp_f32 v138, v131
    v_mul_f32 v132, 0xbfb8aa3b, v132
    v_mul_f32 v134, 0xbfb8aa3b, v134
    v_mul_f32 v136, 0xbfb8aa3b, v136
    v_mul_f32 v138, 0xbfb8aa3b, v138
    s_waitcnt lgkmcnt(0)
    s_lshl_b32 s41, s49, 13
    v_add_u32 v6, s41, v10
    v_add_u32 v7, s41, v11
    v_pk_fma_f32 v[12:13], v[156:157], v[124:125], v[12:13] op_sel:[0,0,0] op_sel_hi:[1,0,1]
    v_pk_fma_f32 v[14:15], v[158:159], v[124:125], v[14:15] op_sel:[0,0,0] op_sel_hi:[1,0,1]
    v_pk_fma_f32 v[16:17], v[160:161], v[124:125], v[16:17] op_sel:[0,0,0] op_sel_hi:[1,0,1]
    v_pk_fma_f32 v[18:19], v[162:163], v[124:125], v[18:19] op_sel:[0,0,0] op_sel_hi:[1,0,1]
    v_pk_mul_f32 v[140:141], v[12:13], v[132:133] op_sel:[0,0] op_sel_hi:[1,0]
    v_pk_mul_f32 v[142:143], v[14:15], v[132:133] op_sel:[0,0] op_sel_hi:[1,0]
    v_pk_mul_f32 v[144:145], v[16:17], v[132:133] op_sel:[0,0] op_sel_hi:[1,0]
    v_pk_mul_f32 v[146:147], v[18:19], v[132:133] op_sel:[0,0] op_sel_hi:[1,0]
    v_exp_f32 v140, v140
    v_exp_f32 v141, v141
    v_exp_f32 v142, v142
    v_exp_f32 v143, v143
    v_exp_f32 v144, v144
    v_exp_f32 v145, v145
    v_exp_f32 v146, v146
    v_exp_f32 v147, v147
    v_pk_fma_f32 v[140:141], v[140:141], v[124:125], v[124:125] op_sel:[0,1,1] op_sel_hi:[1,1,1]
    v_pk_fma_f32 v[142:143], v[142:143], v[124:125], v[124:125] op_sel:[0,1,1] op_sel_hi:[1,1,1]
    v_pk_fma_f32 v[144:145], v[144:145], v[124:125], v[124:125] op_sel:[0,1,1] op_sel_hi:[1,1,1]
    v_pk_fma_f32 v[146:147], v[146:147], v[124:125], v[124:125] op_sel:[0,1,1] op_sel_hi:[1,1,1]
    v_rcp_f32 v140, v140
    v_rcp_f32 v141, v141
    v_rcp_f32 v142, v142
    v_rcp_f32 v143, v143
    v_rcp_f32 v144, v144
    v_rcp_f32 v145, v145
    v_rcp_f32 v146, v146
    v_rcp_f32 v147, v147
    v_pk_mul_f32 v[140:141], v[140:141], v[12:13]
    v_pk_mul_f32 v[142:143], v[142:143], v[14:15]
    v_pk_mul_f32 v[144:145], v[144:145], v[16:17]
    v_pk_mul_f32 v[146:147], v[146:147], v[18:19]
    v_cvt_pk_bf16_f32 v188, v140, v141
    v_cvt_pk_bf16_f32 v189, v142, v143
    v_cvt_pk_bf16_f32 v190, v144, v145
    v_cvt_pk_bf16_f32 v191, v146, v147
    v_pk_fma_f32 v[44:45], v[156:157], v[126:127], v[44:45] op_sel:[0,0,0] op_sel_hi:[1,0,1]
    v_pk_fma_f32 v[46:47], v[158:159], v[126:127], v[46:47] op_sel:[0,0,0] op_sel_hi:[1,0,1]
    v_pk_fma_f32 v[48:49], v[160:161], v[126:127], v[48:49] op_sel:[0,0,0] op_sel_hi:[1,0,1]
    v_pk_fma_f32 v[50:51], v[162:163], v[126:127], v[50:51] op_sel:[0,0,0] op_sel_hi:[1,0,1]
    v_pk_mul_f32 v[148:149], v[44:45], v[134:135] op_sel:[0,0] op_sel_hi:[1,0]
    v_pk_mul_f32 v[150:151], v[46:47], v[134:135] op_sel:[0,0] op_sel_hi:[1,0]
    v_pk_mul_f32 v[152:153], v[48:49], v[134:135] op_sel:[0,0] op_sel_hi:[1,0]
    v_pk_mul_f32 v[154:155], v[50:51], v[134:135] op_sel:[0,0] op_sel_hi:[1,0]
    v_exp_f32 v148, v148
    v_exp_f32 v149, v149
    buffer_store_dwordx4 v[188:191], v10, s[8:11], s56 offen offset:0 sc0 sc1
    v_exp_f32 v150, v150
    v_exp_f32 v151, v151
    v_exp_f32 v152, v152
    v_exp_f32 v153, v153
    v_exp_f32 v154, v154
    v_exp_f32 v155, v155
    v_pk_fma_f32 v[148:149], v[148:149], v[126:127], v[126:127] op_sel:[0,1,1] op_sel_hi:[1,1,1]
    v_pk_fma_f32 v[150:151], v[150:151], v[126:127], v[126:127] op_sel:[0,1,1] op_sel_hi:[1,1,1]
    v_pk_fma_f32 v[152:153], v[152:153], v[126:127], v[126:127] op_sel:[0,1,1] op_sel_hi:[1,1,1]
    v_pk_fma_f32 v[154:155], v[154:155], v[126:127], v[126:127] op_sel:[0,1,1] op_sel_hi:[1,1,1]
    v_rcp_f32 v148, v148
    v_rcp_f32 v149, v149
    ds_write_b128 v6, v[188:191] offset:0
    v_rcp_f32 v150, v150
    v_rcp_f32 v151, v151
    v_rcp_f32 v152, v152
    v_rcp_f32 v153, v153
    v_rcp_f32 v154, v154
    v_rcp_f32 v155, v155
    v_pk_mul_f32 v[148:149], v[148:149], v[44:45]
    v_pk_mul_f32 v[150:151], v[150:151], v[46:47]
    v_pk_mul_f32 v[152:153], v[152:153], v[48:49]
    v_pk_mul_f32 v[154:155], v[154:155], v[50:51]
    v_cvt_pk_bf16_f32 v192, v148, v149
    v_cvt_pk_bf16_f32 v193, v150, v151
    v_cvt_pk_bf16_f32 v194, v152, v153
    v_cvt_pk_bf16_f32 v195, v154, v155
    v_pk_fma_f32 v[76:77], v[156:157], v[128:129], v[76:77] op_sel:[0,0,0] op_sel_hi:[1,0,1]
    v_pk_fma_f32 v[78:79], v[158:159], v[128:129], v[78:79] op_sel:[0,0,0] op_sel_hi:[1,0,1]
    v_pk_fma_f32 v[80:81], v[160:161], v[128:129], v[80:81] op_sel:[0,0,0] op_sel_hi:[1,0,1]
    v_pk_fma_f32 v[82:83], v[162:163], v[128:129], v[82:83] op_sel:[0,0,0] op_sel_hi:[1,0,1]
    v_pk_mul_f32 v[140:141], v[76:77], v[136:137] op_sel:[0,0] op_sel_hi:[1,0]
    v_pk_mul_f32 v[142:143], v[78:79], v[136:137] op_sel:[0,0] op_sel_hi:[1,0]
    v_pk_mul_f32 v[144:145], v[80:81], v[136:137] op_sel:[0,0] op_sel_hi:[1,0]
    v_pk_mul_f32 v[146:147], v[82:83], v[136:137] op_sel:[0,0] op_sel_hi:[1,0]
    v_exp_f32 v140, v140
    v_exp_f32 v141, v141
    buffer_store_dwordx4 v[192:195], v10, s[8:11], s56 offen offset:1024 sc0 sc1
    v_exp_f32 v142, v142
    v_exp_f32 v143, v143
    v_exp_f32 v144, v144
    v_exp_f32 v145, v145
    v_exp_f32 v146, v146
    v_exp_f32 v147, v147
    v_pk_fma_f32 v[140:141], v[140:141], v[128:129], v[128:129] op_sel:[0,1,1] op_sel_hi:[1,1,1]
    v_pk_fma_f32 v[142:143], v[142:143], v[128:129], v[128:129] op_sel:[0,1,1] op_sel_hi:[1,1,1]
    v_pk_fma_f32 v[144:145], v[144:145], v[128:129], v[128:129] op_sel:[0,1,1] op_sel_hi:[1,1,1]
    v_pk_fma_f32 v[146:147], v[146:147], v[128:129], v[128:129] op_sel:[0,1,1] op_sel_hi:[1,1,1]
    v_rcp_f32 v140, v140
    v_rcp_f32 v141, v141
    ds_write_b128 v6, v[192:195] offset:1024
    v_rcp_f32 v142, v142
    v_rcp_f32 v143, v143
    v_rcp_f32 v144, v144
    v_rcp_f32 v145, v145
    v_rcp_f32 v146, v146
    v_rcp_f32 v147, v147
    v_pk_mul_f32 v[140:141], v[140:141], v[76:77]
    v_pk_mul_f32 v[142:143], v[142:143], v[78:79]
    v_pk_mul_f32 v[144:145], v[144:145], v[80:81]
    v_pk_mul_f32 v[146:147], v[146:147], v[82:83]
    v_cvt_pk_bf16_f32 v196, v140, v141
    v_cvt_pk_bf16_f32 v197, v142, v143
    v_cvt_pk_bf16_f32 v198, v144, v145
    v_cvt_pk_bf16_f32 v199, v146, v147
    v_pk_fma_f32 v[100:101], v[156:157], v[130:131], v[100:101] op_sel:[0,0,0] op_sel_hi:[1,0,1]
    v_pk_fma_f32 v[102:103], v[158:159], v[130:131], v[102:103] op_sel:[0,0,0] op_sel_hi:[1,0,1]
    v_pk_fma_f32 v[104:105], v[160:161], v[130:131], v[104:105] op_sel:[0,0,0] op_sel_hi:[1,0,1]
    v_pk_fma_f32 v[106:107], v[162:163], v[130:131], v[106:107] op_sel:[0,0,0] op_sel_hi:[1,0,1]
    v_pk_mul_f32 v[148:149], v[100:101], v[138:139] op_sel:[0,0] op_sel_hi:[1,0]
    v_pk_mul_f32 v[150:151], v[102:103], v[138:139] op_sel:[0,0] op_sel_hi:[1,0]
    v_pk_mul_f32 v[152:153], v[104:105], v[138:139] op_sel:[0,0] op_sel_hi:[1,0]
    v_pk_mul_f32 v[154:155], v[106:107], v[138:139] op_sel:[0,0] op_sel_hi:[1,0]
    v_exp_f32 v148, v148
    v_exp_f32 v149, v149
    buffer_store_dwordx4 v[196:199], v11, s[8:11], s56 offen offset:0 sc0 sc1
    v_exp_f32 v150, v150
    v_exp_f32 v151, v151
    v_exp_f32 v152, v152
    v_exp_f32 v153, v153
    v_exp_f32 v154, v154
    v_exp_f32 v155, v155
    v_pk_fma_f32 v[148:149], v[148:149], v[130:131], v[130:131] op_sel:[0,1,1] op_sel_hi:[1,1,1]
    v_pk_fma_f32 v[150:151], v[150:151], v[130:131], v[130:131] op_sel:[0,1,1] op_sel_hi:[1,1,1]
    v_pk_fma_f32 v[152:153], v[152:153], v[130:131], v[130:131] op_sel:[0,1,1] op_sel_hi:[1,1,1]
    v_pk_fma_f32 v[154:155], v[154:155], v[130:131], v[130:131] op_sel:[0,1,1] op_sel_hi:[1,1,1]
    v_rcp_f32 v148, v148
    v_rcp_f32 v149, v149
    ds_write_b128 v7, v[196:199] offset:0
    v_rcp_f32 v150, v150
    v_rcp_f32 v151, v151
    v_rcp_f32 v152, v152
    v_rcp_f32 v153, v153
    v_rcp_f32 v154, v154
    v_rcp_f32 v155, v155
    v_pk_mul_f32 v[148:149], v[148:149], v[100:101]
    v_pk_mul_f32 v[150:151], v[150:151], v[102:103]
    v_pk_mul_f32 v[152:153], v[152:153], v[104:105]
    v_pk_mul_f32 v[154:155], v[154:155], v[106:107]
    v_cvt_pk_bf16_f32 v200, v148, v149
    v_cvt_pk_bf16_f32 v201, v150, v151
    v_cvt_pk_bf16_f32 v202, v152, v153
    v_cvt_pk_bf16_f32 v203, v154, v155
    v_pk_fma_f32 v[20:21], v[164:165], v[124:125], v[20:21] op_sel:[0,0,0] op_sel_hi:[1,0,1]
    v_pk_fma_f32 v[22:23], v[166:167], v[124:125], v[22:23] op_sel:[0,0,0] op_sel_hi:[1,0,1]
    v_pk_fma_f32 v[24:25], v[168:169], v[124:125], v[24:25] op_sel:[0,0,0] op_sel_hi:[1,0,1]
    v_pk_fma_f32 v[26:27], v[170:171], v[124:125], v[26:27] op_sel:[0,0,0] op_sel_hi:[1,0,1]
    v_pk_mul_f32 v[140:141], v[20:21], v[132:133] op_sel:[0,0] op_sel_hi:[1,0]
    v_pk_mul_f32 v[142:143], v[22:23], v[132:133] op_sel:[0,0] op_sel_hi:[1,0]
    v_pk_mul_f32 v[144:145], v[24:25], v[132:133] op_sel:[0,0] op_sel_hi:[1,0]
    v_pk_mul_f32 v[146:147], v[26:27], v[132:133] op_sel:[0,0] op_sel_hi:[1,0]
    v_exp_f32 v140, v140
    v_exp_f32 v141, v141
    buffer_store_dwordx4 v[200:203], v11, s[8:11], s56 offen offset:1024 sc0 sc1
    v_exp_f32 v142, v142
    v_exp_f32 v143, v143
    v_exp_f32 v144, v144
    v_exp_f32 v145, v145
    v_exp_f32 v146, v146
    v_exp_f32 v147, v147
    v_pk_fma_f32 v[140:141], v[140:141], v[124:125], v[124:125] op_sel:[0,1,1] op_sel_hi:[1,1,1]
    v_pk_fma_f32 v[142:143], v[142:143], v[124:125], v[124:125] op_sel:[0,1,1] op_sel_hi:[1,1,1]
    v_pk_fma_f32 v[144:145], v[144:145], v[124:125], v[124:125] op_sel:[0,1,1] op_sel_hi:[1,1,1]
    v_pk_fma_f32 v[146:147], v[146:147], v[124:125], v[124:125] op_sel:[0,1,1] op_sel_hi:[1,1,1]
    v_rcp_f32 v140, v140
    v_rcp_f32 v141, v141
    ds_write_b128 v7, v[200:203] offset:1024
    v_rcp_f32 v142, v142
    v_rcp_f32 v143, v143
    v_rcp_f32 v144, v144
    v_rcp_f32 v145, v145
    v_rcp_f32 v146, v146
    v_rcp_f32 v147, v147
    v_pk_mul_f32 v[140:141], v[140:141], v[20:21]
    v_pk_mul_f32 v[142:143], v[142:143], v[22:23]
    v_pk_mul_f32 v[144:145], v[144:145], v[24:25]
    v_pk_mul_f32 v[146:147], v[146:147], v[26:27]
    v_cvt_pk_bf16_f32 v204, v140, v141
    v_cvt_pk_bf16_f32 v205, v142, v143
    v_cvt_pk_bf16_f32 v206, v144, v145
    v_cvt_pk_bf16_f32 v207, v146, v147
    v_pk_fma_f32 v[52:53], v[164:165], v[126:127], v[52:53] op_sel:[0,0,0] op_sel_hi:[1,0,1]
    v_pk_fma_f32 v[54:55], v[166:167], v[126:127], v[54:55] op_sel:[0,0,0] op_sel_hi:[1,0,1]
    v_pk_fma_f32 v[56:57], v[168:169], v[126:127], v[56:57] op_sel:[0,0,0] op_sel_hi:[1,0,1]
    v_pk_fma_f32 v[58:59], v[170:171], v[126:127], v[58:59] op_sel:[0,0,0] op_sel_hi:[1,0,1]
    v_pk_mul_f32 v[148:149], v[52:53], v[134:135] op_sel:[0,0] op_sel_hi:[1,0]
    v_pk_mul_f32 v[150:151], v[54:55], v[134:135] op_sel:[0,0] op_sel_hi:[1,0]
    v_pk_mul_f32 v[152:153], v[56:57], v[134:135] op_sel:[0,0] op_sel_hi:[1,0]
    v_pk_mul_f32 v[154:155], v[58:59], v[134:135] op_sel:[0,0] op_sel_hi:[1,0]
    v_exp_f32 v148, v148
    v_exp_f32 v149, v149
    buffer_store_dwordx4 v[204:207], v10, s[8:11], s57 offen offset:0 sc0 sc1
    v_exp_f32 v150, v150
    v_exp_f32 v151, v151
    v_exp_f32 v152, v152
    v_exp_f32 v153, v153
    v_exp_f32 v154, v154
    v_exp_f32 v155, v155
    v_pk_fma_f32 v[148:149], v[148:149], v[126:127], v[126:127] op_sel:[0,1,1] op_sel_hi:[1,1,1]
    v_pk_fma_f32 v[150:151], v[150:151], v[126:127], v[126:127] op_sel:[0,1,1] op_sel_hi:[1,1,1]
    v_pk_fma_f32 v[152:153], v[152:153], v[126:127], v[126:127] op_sel:[0,1,1] op_sel_hi:[1,1,1]
    v_pk_fma_f32 v[154:155], v[154:155], v[126:127], v[126:127] op_sel:[0,1,1] op_sel_hi:[1,1,1]
    v_rcp_f32 v148, v148
    v_rcp_f32 v149, v149
    ds_write_b128 v6, v[204:207] offset:16384
    v_rcp_f32 v150, v150
    v_rcp_f32 v151, v151
    v_rcp_f32 v152, v152
    v_rcp_f32 v153, v153
    v_rcp_f32 v154, v154
    v_rcp_f32 v155, v155
    v_pk_mul_f32 v[148:149], v[148:149], v[52:53]
    v_pk_mul_f32 v[150:151], v[150:151], v[54:55]
    v_pk_mul_f32 v[152:153], v[152:153], v[56:57]
    v_pk_mul_f32 v[154:155], v[154:155], v[58:59]
    v_cvt_pk_bf16_f32 v208, v148, v149
    v_cvt_pk_bf16_f32 v209, v150, v151
    v_cvt_pk_bf16_f32 v210, v152, v153
    v_cvt_pk_bf16_f32 v211, v154, v155
    v_pk_fma_f32 v[84:85], v[164:165], v[128:129], v[84:85] op_sel:[0,0,0] op_sel_hi:[1,0,1]
    v_pk_fma_f32 v[86:87], v[166:167], v[128:129], v[86:87] op_sel:[0,0,0] op_sel_hi:[1,0,1]
    v_pk_fma_f32 v[88:89], v[168:169], v[128:129], v[88:89] op_sel:[0,0,0] op_sel_hi:[1,0,1]
    v_pk_fma_f32 v[90:91], v[170:171], v[128:129], v[90:91] op_sel:[0,0,0] op_sel_hi:[1,0,1]
    v_pk_mul_f32 v[140:141], v[84:85], v[136:137] op_sel:[0,0] op_sel_hi:[1,0]
    v_pk_mul_f32 v[142:143], v[86:87], v[136:137] op_sel:[0,0] op_sel_hi:[1,0]
    v_pk_mul_f32 v[144:145], v[88:89], v[136:137] op_sel:[0,0] op_sel_hi:[1,0]
    v_pk_mul_f32 v[146:147], v[90:91], v[136:137] op_sel:[0,0] op_sel_hi:[1,0]
    v_exp_f32 v140, v140
    v_exp_f32 v141, v141
    buffer_store_dwordx4 v[208:211], v10, s[8:11], s57 offen offset:1024 sc0 sc1
    v_exp_f32 v142, v142
    v_exp_f32 v143, v143
    v_exp_f32 v144, v144
    v_exp_f32 v145, v145
    v_exp_f32 v146, v146
    v_exp_f32 v147, v147
    v_pk_fma_f32 v[140:141], v[140:141], v[128:129], v[128:129] op_sel:[0,1,1] op_sel_hi:[1,1,1]
    v_pk_fma_f32 v[142:143], v[142:143], v[128:129], v[128:129] op_sel:[0,1,1] op_sel_hi:[1,1,1]
    v_pk_fma_f32 v[144:145], v[144:145], v[128:129], v[128:129] op_sel:[0,1,1] op_sel_hi:[1,1,1]
    v_pk_fma_f32 v[146:147], v[146:147], v[128:129], v[128:129] op_sel:[0,1,1] op_sel_hi:[1,1,1]
    v_rcp_f32 v140, v140
    v_rcp_f32 v141, v141
    ds_write_b128 v6, v[208:211] offset:17408
    v_rcp_f32 v142, v142
    v_rcp_f32 v143, v143
    v_rcp_f32 v144, v144
    v_rcp_f32 v145, v145
    v_rcp_f32 v146, v146
    v_rcp_f32 v147, v147
    v_pk_mul_f32 v[140:141], v[140:141], v[84:85]
    v_pk_mul_f32 v[142:143], v[142:143], v[86:87]
    v_pk_mul_f32 v[144:145], v[144:145], v[88:89]
    v_pk_mul_f32 v[146:147], v[146:147], v[90:91]
    v_cvt_pk_bf16_f32 v212, v140, v141
    v_cvt_pk_bf16_f32 v213, v142, v143
    v_cvt_pk_bf16_f32 v214, v144, v145
    v_cvt_pk_bf16_f32 v215, v146, v147
    s_waitcnt vmcnt(2)
    s_barrier
    s_cmp_lg_u32 s6, 0
    s_cbranch_scc1 pub_26
    s_lshl_b32 s60, s4, 11
    s_add_u32 s60, s60, s38
    s_add_u32 s60, s60, 65536
    s_lshl_b32 s61, s5, 2
    s_add_u32 s61, s61, s60
    v_mov_b32 v2, 1
    s_mov_b64 exec, 1
    buffer_store_dword v2, off, s[8:11], s61 sc0 sc1
    s_mov_b64 exec, -1
pub_26:
    v_pk_fma_f32 v[108:109], v[164:165], v[130:131], v[108:109] op_sel:[0,0,0] op_sel_hi:[1,0,1]
    v_pk_fma_f32 v[110:111], v[166:167], v[130:131], v[110:111] op_sel:[0,0,0] op_sel_hi:[1,0,1]
    v_pk_fma_f32 v[112:113], v[168:169], v[130:131], v[112:113] op_sel:[0,0,0] op_sel_hi:[1,0,1]
    v_pk_fma_f32 v[114:115], v[170:171], v[130:131], v[114:115] op_sel:[0,0,0] op_sel_hi:[1,0,1]
    v_pk_mul_f32 v[148:149], v[108:109], v[138:139] op_sel:[0,0] op_sel_hi:[1,0]
    v_pk_mul_f32 v[150:151], v[110:111], v[138:139] op_sel:[0,0] op_sel_hi:[1,0]
    v_pk_mul_f32 v[152:153], v[112:113], v[138:139] op_sel:[0,0] op_sel_hi:[1,0]
    v_pk_mul_f32 v[154:155], v[114:115], v[138:139] op_sel:[0,0] op_sel_hi:[1,0]
    v_exp_f32 v148, v148
    v_exp_f32 v149, v149
    buffer_store_dwordx4 v[212:215], v11, s[8:11], s57 offen offset:0 sc0 sc1
    v_exp_f32 v150, v150
    v_exp_f32 v151, v151
    v_exp_f32 v152, v152
    v_exp_f32 v153, v153
    v_exp_f32 v154, v154
    v_exp_f32 v155, v155
    v_pk_fma_f32 v[148:149], v[148:149], v[130:131], v[130:131] op_sel:[0,1,1] op_sel_hi:[1,1,1]
    v_pk_fma_f32 v[150:151], v[150:151], v[130:131], v[130:131] op_sel:[0,1,1] op_sel_hi:[1,1,1]
    v_pk_fma_f32 v[152:153], v[152:153], v[130:131], v[130:131] op_sel:[0,1,1] op_sel_hi:[1,1,1]
    v_pk_fma_f32 v[154:155], v[154:155], v[130:131], v[130:131] op_sel:[0,1,1] op_sel_hi:[1,1,1]
    v_rcp_f32 v148, v148
    v_rcp_f32 v149, v149
    ds_write_b128 v7, v[212:215] offset:16384
    v_rcp_f32 v150, v150
    v_rcp_f32 v151, v151
    v_rcp_f32 v152, v152
    v_rcp_f32 v153, v153
    v_rcp_f32 v154, v154
    v_rcp_f32 v155, v155
    v_pk_mul_f32 v[148:149], v[148:149], v[108:109]
    v_pk_mul_f32 v[150:151], v[150:151], v[110:111]
    v_pk_mul_f32 v[152:153], v[152:153], v[112:113]
    v_pk_mul_f32 v[154:155], v[154:155], v[114:115]
    v_cvt_pk_bf16_f32 v216, v148, v149
    v_cvt_pk_bf16_f32 v217, v150, v151
    v_cvt_pk_bf16_f32 v218, v152, v153
    v_cvt_pk_bf16_f32 v219, v154, v155
    v_pk_fma_f32 v[28:29], v[172:173], v[124:125], v[28:29] op_sel:[0,0,0] op_sel_hi:[1,0,1]
    v_pk_fma_f32 v[30:31], v[174:175], v[124:125], v[30:31] op_sel:[0,0,0] op_sel_hi:[1,0,1]
    v_pk_fma_f32 v[32:33], v[176:177], v[124:125], v[32:33] op_sel:[0,0,0] op_sel_hi:[1,0,1]
    v_pk_fma_f32 v[34:35], v[178:179], v[124:125], v[34:35] op_sel:[0,0,0] op_sel_hi:[1,0,1]
    v_pk_mul_f32 v[140:141], v[28:29], v[132:133] op_sel:[0,0] op_sel_hi:[1,0]
    v_pk_mul_f32 v[142:143], v[30:31], v[132:133] op_sel:[0,0] op_sel_hi:[1,0]
    v_pk_mul_f32 v[144:145], v[32:33], v[132:133] op_sel:[0,0] op_sel_hi:[1,0]
    v_pk_mul_f32 v[146:147], v[34:35], v[132:133] op_sel:[0,0] op_sel_hi:[1,0]
    v_exp_f32 v140, v140
    v_exp_f32 v141, v141
    buffer_store_dwordx4 v[216:219], v11, s[8:11], s57 offen offset:1024 sc0 sc1
    v_exp_f32 v142, v142
    v_exp_f32 v143, v143
    v_exp_f32 v144, v144
    v_exp_f32 v145, v145
    v_exp_f32 v146, v146
    v_exp_f32 v147, v147
    v_pk_fma_f32 v[140:141], v[140:141], v[124:125], v[124:125] op_sel:[0,1,1] op_sel_hi:[1,1,1]
    v_pk_fma_f32 v[142:143], v[142:143], v[124:125], v[124:125] op_sel:[0,1,1] op_sel_hi:[1,1,1]
    v_pk_fma_f32 v[144:145], v[144:145], v[124:125], v[124:125] op_sel:[0,1,1] op_sel_hi:[1,1,1]
    v_pk_fma_f32 v[146:147], v[146:147], v[124:125], v[124:125] op_sel:[0,1,1] op_sel_hi:[1,1,1]
    v_rcp_f32 v140, v140
    v_rcp_f32 v141, v141
    ds_write_b128 v7, v[216:219] offset:17408
    v_rcp_f32 v142, v142
    v_rcp_f32 v143, v143
    v_rcp_f32 v144, v144
    v_rcp_f32 v145, v145
    v_rcp_f32 v146, v146
    v_rcp_f32 v147, v147
    v_pk_mul_f32 v[140:141], v[140:141], v[28:29]
    v_pk_mul_f32 v[142:143], v[142:143], v[30:31]
    v_pk_mul_f32 v[144:145], v[144:145], v[32:33]
    v_pk_mul_f32 v[146:147], v[146:147], v[34:35]
    v_cvt_pk_bf16_f32 v188, v140, v141
    v_cvt_pk_bf16_f32 v189, v142, v143
    v_cvt_pk_bf16_f32 v190, v144, v145
    v_cvt_pk_bf16_f32 v191, v146, v147
    v_pk_fma_f32 v[60:61], v[172:173], v[126:127], v[60:61] op_sel:[0,0,0] op_sel_hi:[1,0,1]
    v_pk_fma_f32 v[62:63], v[174:175], v[126:127], v[62:63] op_sel:[0,0,0] op_sel_hi:[1,0,1]
    v_pk_fma_f32 v[64:65], v[176:177], v[126:127], v[64:65] op_sel:[0,0,0] op_sel_hi:[1,0,1]
    v_pk_fma_f32 v[66:67], v[178:179], v[126:127], v[66:67] op_sel:[0,0,0] op_sel_hi:[1,0,1]
    v_pk_mul_f32 v[148:149], v[60:61], v[134:135] op_sel:[0,0] op_sel_hi:[1,0]
    v_pk_mul_f32 v[150:151], v[62:63], v[134:135] op_sel:[0,0] op_sel_hi:[1,0]
    v_pk_mul_f32 v[152:153], v[64:65], v[134:135] op_sel:[0,0] op_sel_hi:[1,0]
    v_pk_mul_f32 v[154:155], v[66:67], v[134:135] op_sel:[0,0] op_sel_hi:[1,0]
    v_exp_f32 v148, v148
    v_exp_f32 v149, v149
    buffer_store_dwordx4 v[188:191], v10, s[8:11], s58 offen offset:0 sc0 sc1
    v_exp_f32 v150, v150
    v_exp_f32 v151, v151
    v_exp_f32 v152, v152
    v_exp_f32 v153, v153
    v_exp_f32 v154, v154
    v_exp_f32 v155, v155
    v_pk_fma_f32 v[148:149], v[148:149], v[126:127], v[126:127] op_sel:[0,1,1] op_sel_hi:[1,1,1]
    v_pk_fma_f32 v[150:151], v[150:151], v[126:127], v[126:127] op_sel:[0,1,1] op_sel_hi:[1,1,1]
    v_pk_fma_f32 v[152:153], v[152:153], v[126:127], v[126:127] op_sel:[0,1,1] op_sel_hi:[1,1,1]
    v_pk_fma_f32 v[154:155], v[154:155], v[126:127], v[126:127] op_sel:[0,1,1] op_sel_hi:[1,1,1]
    v_rcp_f32 v148, v148
    v_rcp_f32 v149, v149
    ds_write_b128 v6, v[188:191] offset:32768
    v_rcp_f32 v150, v150
    v_rcp_f32 v151, v151
    v_rcp_f32 v152, v152
    v_rcp_f32 v153, v153
    v_rcp_f32 v154, v154
    v_rcp_f32 v155, v155
    v_pk_mul_f32 v[148:149], v[148:149], v[60:61]
    v_pk_mul_f32 v[150:151], v[150:151], v[62:63]
    v_pk_mul_f32 v[152:153], v[152:153], v[64:65]
    v_pk_mul_f32 v[154:155], v[154:155], v[66:67]
    v_cvt_pk_bf16_f32 v192, v148, v149
    v_cvt_pk_bf16_f32 v193, v150, v151
    v_cvt_pk_bf16_f32 v194, v152, v153
    v_cvt_pk_bf16_f32 v195, v154, v155
    v_pk_fma_f32 v[92:93], v[172:173], v[128:129], v[92:93] op_sel:[0,0,0] op_sel_hi:[1,0,1]
    v_pk_fma_f32 v[94:95], v[174:175], v[128:129], v[94:95] op_sel:[0,0,0] op_sel_hi:[1,0,1]
    v_pk_fma_f32 v[96:97], v[176:177], v[128:129], v[96:97] op_sel:[0,0,0] op_sel_hi:[1,0,1]
    v_pk_fma_f32 v[98:99], v[178:179], v[128:129], v[98:99] op_sel:[0,0,0] op_sel_hi:[1,0,1]
    v_pk_mul_f32 v[140:141], v[92:93], v[136:137] op_sel:[0,0] op_sel_hi:[1,0]
    v_pk_mul_f32 v[142:143], v[94:95], v[136:137] op_sel:[0,0] op_sel_hi:[1,0]
    v_pk_mul_f32 v[144:145], v[96:97], v[136:137] op_sel:[0,0] op_sel_hi:[1,0]
    v_pk_mul_f32 v[146:147], v[98:99], v[136:137] op_sel:[0,0] op_sel_hi:[1,0]
    v_exp_f32 v140, v140
    v_exp_f32 v141, v141
    buffer_store_dwordx4 v[192:195], v10, s[8:11], s58 offen offset:1024 sc0 sc1
    v_exp_f32 v142, v142
    v_exp_f32 v143, v143
    v_exp_f32 v144, v144
    v_exp_f32 v145, v145
    v_exp_f32 v146, v146
    v_exp_f32 v147, v147
    v_pk_fma_f32 v[140:141], v[140:141], v[128:129], v[128:129] op_sel:[0,1,1] op_sel_hi:[1,1,1]
    v_pk_fma_f32 v[142:143], v[142:143], v[128:129], v[128:129] op_sel:[0,1,1] op_sel_hi:[1,1,1]
    v_pk_fma_f32 v[144:145], v[144:145], v[128:129], v[128:129] op_sel:[0,1,1] op_sel_hi:[1,1,1]
    v_pk_fma_f32 v[146:147], v[146:147], v[128:129], v[128:129] op_sel:[0,1,1] op_sel_hi:[1,1,1]
    v_rcp_f32 v140, v140
    v_rcp_f32 v141, v141
    ds_write_b128 v6, v[192:195] offset:33792
    v_rcp_f32 v142, v142
    v_rcp_f32 v143, v143
    v_rcp_f32 v144, v144
    v_rcp_f32 v145, v145
    v_rcp_f32 v146, v146
    v_rcp_f32 v147, v147
    v_pk_mul_f32 v[140:141], v[140:141], v[92:93]
    v_pk_mul_f32 v[142:143], v[142:143], v[94:95]
    v_pk_mul_f32 v[144:145], v[144:145], v[96:97]
    v_pk_mul_f32 v[146:147], v[146:147], v[98:99]
    v_cvt_pk_bf16_f32 v196, v140, v141
    v_cvt_pk_bf16_f32 v197, v142, v143
    v_cvt_pk_bf16_f32 v198, v144, v145
    v_cvt_pk_bf16_f32 v199, v146, v147
    v_pk_fma_f32 v[116:117], v[172:173], v[130:131], v[116:117] op_sel:[0,0,0] op_sel_hi:[1,0,1]
    v_pk_fma_f32 v[118:119], v[174:175], v[130:131], v[118:119] op_sel:[0,0,0] op_sel_hi:[1,0,1]
    v_pk_fma_f32 v[120:121], v[176:177], v[130:131], v[120:121] op_sel:[0,0,0] op_sel_hi:[1,0,1]
    v_pk_fma_f32 v[122:123], v[178:179], v[130:131], v[122:123] op_sel:[0,0,0] op_sel_hi:[1,0,1]
    v_pk_mul_f32 v[148:149], v[116:117], v[138:139] op_sel:[0,0] op_sel_hi:[1,0]
    v_pk_mul_f32 v[150:151], v[118:119], v[138:139] op_sel:[0,0] op_sel_hi:[1,0]
    v_pk_mul_f32 v[152:153], v[120:121], v[138:139] op_sel:[0,0] op_sel_hi:[1,0]
    v_pk_mul_f32 v[154:155], v[122:123], v[138:139] op_sel:[0,0] op_sel_hi:[1,0]
    v_exp_f32 v148, v148
    v_exp_f32 v149, v149
    buffer_store_dwordx4 v[196:199], v11, s[8:11], s58 offen offset:0 sc0 sc1
    v_exp_f32 v150, v150
    v_exp_f32 v151, v151
    v_exp_f32 v152, v152
    v_exp_f32 v153, v153
    v_exp_f32 v154, v154
    v_exp_f32 v155, v155
    v_pk_fma_f32 v[148:149], v[148:149], v[130:131], v[130:131] op_sel:[0,1,1] op_sel_hi:[1,1,1]
    v_pk_fma_f32 v[150:151], v[150:151], v[130:131], v[130:131] op_sel:[0,1,1] op_sel_hi:[1,1,1]
    v_pk_fma_f32 v[152:153], v[152:153], v[130:131], v[130:131] op_sel:[0,1,1] op_sel_hi:[1,1,1]
    v_pk_fma_f32 v[154:155], v[154:155], v[130:131], v[130:131] op_sel:[0,1,1] op_sel_hi:[1,1,1]
    v_rcp_f32 v148, v148
    v_rcp_f32 v149, v149
    ds_write_b128 v7, v[196:199] offset:32768
    v_rcp_f32 v150, v150
    v_rcp_f32 v151, v151
    v_rcp_f32 v152, v152
    v_rcp_f32 v153, v153
    v_rcp_f32 v154, v154
    v_rcp_f32 v155, v155
    v_pk_mul_f32 v[148:149], v[148:149], v[116:117]
    v_pk_mul_f32 v[150:151], v[150:151], v[118:119]
    v_pk_mul_f32 v[152:153], v[152:153], v[120:121]
    v_pk_mul_f32 v[154:155], v[154:155], v[122:123]
    v_cvt_pk_bf16_f32 v200, v148, v149
    v_cvt_pk_bf16_f32 v201, v150, v151
    v_cvt_pk_bf16_f32 v202, v152, v153
    v_cvt_pk_bf16_f32 v203, v154, v155
    v_pk_fma_f32 v[36:37], v[180:181], v[124:125], v[36:37] op_sel:[0,0,0] op_sel_hi:[1,0,1]
    v_pk_fma_f32 v[38:39], v[182:183], v[124:125], v[38:39] op_sel:[0,0,0] op_sel_hi:[1,0,1]
    v_pk_fma_f32 v[40:41], v[184:185], v[124:125], v[40:41] op_sel:[0,0,0] op_sel_hi:[1,0,1]
    v_pk_fma_f32 v[42:43], v[186:187], v[124:125], v[42:43] op_sel:[0,0,0] op_sel_hi:[1,0,1]
    v_pk_mul_f32 v[140:141], v[36:37], v[132:133] op_sel:[0,0] op_sel_hi:[1,0]
    v_pk_mul_f32 v[142:143], v[38:39], v[132:133] op_sel:[0,0] op_sel_hi:[1,0]
    v_pk_mul_f32 v[144:145], v[40:41], v[132:133] op_sel:[0,0] op_sel_hi:[1,0]
    v_pk_mul_f32 v[146:147], v[42:43], v[132:133] op_sel:[0,0] op_sel_hi:[1,0]
    v_exp_f32 v140, v140
    v_exp_f32 v141, v141
    buffer_store_dwordx4 v[200:203], v11, s[8:11], s58 offen offset:1024 sc0 sc1
    v_exp_f32 v142, v142
    v_exp_f32 v143, v143
    v_exp_f32 v144, v144
    v_exp_f32 v145, v145
    v_exp_f32 v146, v146
    v_exp_f32 v147, v147
    v_pk_fma_f32 v[140:141], v[140:141], v[124:125], v[124:125] op_sel:[0,1,1] op_sel_hi:[1,1,1]
    v_pk_fma_f32 v[142:143], v[142:143], v[124:125], v[124:125] op_sel:[0,1,1] op_sel_hi:[1,1,1]
    v_pk_fma_f32 v[144:145], v[144:145], v[124:125], v[124:125] op_sel:[0,1,1] op_sel_hi:[1,1,1]
    v_pk_fma_f32 v[146:147], v[146:147], v[124:125], v[124:125] op_sel:[0,1,1] op_sel_hi:[1,1,1]
    v_rcp_f32 v140, v140
    v_rcp_f32 v141, v141
    ds_write_b128 v7, v[200:203] offset:33792
    v_rcp_f32 v142, v142
    v_rcp_f32 v143, v143
    v_rcp_f32 v144, v144
    v_rcp_f32 v145, v145
    v_rcp_f32 v146, v146
    v_rcp_f32 v147, v147
    v_pk_mul_f32 v[140:141], v[140:141], v[36:37]
    v_pk_mul_f32 v[142:143], v[142:143], v[38:39]
    v_pk_mul_f32 v[144:145], v[144:145], v[40:41]
    v_pk_mul_f32 v[146:147], v[146:147], v[42:43]
    v_cvt_pk_bf16_f32 v204, v140, v141
    v_cvt_pk_bf16_f32 v205, v142, v143
    v_cvt_pk_bf16_f32 v206, v144, v145
    v_cvt_pk_bf16_f32 v207, v146, v147
    v_pk_fma_f32 v[68:69], v[180:181], v[126:127], v[68:69] op_sel:[0,0,0] op_sel_hi:[1,0,1]
    v_pk_fma_f32 v[70:71], v[182:183], v[126:127], v[70:71] op_sel:[0,0,0] op_sel_hi:[1,0,1]
    v_pk_fma_f32 v[72:73], v[184:185], v[126:127], v[72:73] op_sel:[0,0,0] op_sel_hi:[1,0,1]
    v_pk_fma_f32 v[74:75], v[186:187], v[126:127], v[74:75] op_sel:[0,0,0] op_sel_hi:[1,0,1]
    v_pk_mul_f32 v[148:149], v[68:69], v[134:135] op_sel:[0,0] op_sel_hi:[1,0]
    v_pk_mul_f32 v[150:151], v[70:71], v[134:135] op_sel:[0,0] op_sel_hi:[1,0]
    v_pk_mul_f32 v[152:153], v[72:73], v[134:135] op_sel:[0,0] op_sel_hi:[1,0]
    v_pk_mul_f32 v[154:155], v[74:75], v[134:135] op_sel:[0,0] op_sel_hi:[1,0]
    v_exp_f32 v148, v148
    v_exp_f32 v149, v149
    buffer_store_dwordx4 v[204:207], v10, s[8:11], s59 offen offset:0 sc0 sc1
    v_exp_f32 v150, v150
    v_exp_f32 v151, v151
    v_exp_f32 v152, v152
    v_exp_f32 v153, v153
    v_exp_f32 v154, v154
    v_exp_f32 v155, v155
    v_pk_fma_f32 v[148:149], v[148:149], v[126:127], v[126:127] op_sel:[0,1,1] op_sel_hi:[1,1,1]
    v_pk_fma_f32 v[150:151], v[150:151], v[126:127], v[126:127] op_sel:[0,1,1] op_sel_hi:[1,1,1]
    v_pk_fma_f32 v[152:153], v[152:153], v[126:127], v[126:127] op_sel:[0,1,1] op_sel_hi:[1,1,1]
    v_pk_fma_f32 v[154:155], v[154:155], v[126:127], v[126:127] op_sel:[0,1,1] op_sel_hi:[1,1,1]
    v_rcp_f32 v148, v148
    v_rcp_f32 v149, v149
    v_rcp_f32 v150, v150
    v_rcp_f32 v151, v151
    v_rcp_f32 v152, v152
    v_rcp_f32 v153, v153
    v_rcp_f32 v154, v154
    v_rcp_f32 v155, v155
    v_pk_mul_f32 v[148:149], v[148:149], v[68:69]
    v_pk_mul_f32 v[150:151], v[150:151], v[70:71]
    v_pk_mul_f32 v[152:153], v[152:153], v[72:73]
    v_pk_mul_f32 v[154:155], v[154:155], v[74:75]
    v_cvt_pk_bf16_f32 v208, v148, v149
    v_cvt_pk_bf16_f32 v209, v150, v151
    v_cvt_pk_bf16_f32 v210, v152, v153
    v_cvt_pk_bf16_f32 v211, v154, v155
    buffer_store_dwordx4 v[208:211], v10, s[8:11], s59 offen offset:1024 sc0 sc1
    s_waitcnt lgkmcnt(0)
ffn2_compute:
    s_lshr_b32 s48, s7, 1
    s_and_b32 s49, s7, 1
    v_lshlrev_b32 v7, 4, v0
    s_lshl_b32 s41, s48, 12
    v_add_u32 v8, s41, v7
    s_and_b32 s41, s5, 1
    s_lshl_b32 s41, s41, 12
    s_lshl_b32 s42, s49, 11
    s_add_u32 s41, s41, s42
    s_add_u32 s41, s41, 65536
    s_xor_b32 s42, s41, 4096
    v_add_u32 v9, s42, v7
    v_add_u32 v10, s41, v7
    s_xor_b32 s46, s37, 0
    s_lshl_b32 s46, s46, 2
    s_add_u32 s46, s46, s7
    s_lshl_b32 s46, s46, 12
    s_add_u32 s46, s46, s36
    s_add_u32 s46, s46, 0x800000
    s_mov_b32 s50, 0
    s_mov_b32 s51, 0
    s_mov_b32 s52, 13
    s_add_u32 s50, s50, 1
    s_mov_b32 s53, 16384
    s_cmp_eq_u32 s50, 4
    s_cselect_b32 s53, -49152, s53
    s_cselect_b32 s50, 0, s50
    s_add_u32 s51, s51, 1
    s_mov_b32 s54, 16384
    s_cmp_eq_u32 s51, 5
    s_cselect_b32 s54, -65536, s54
    s_cselect_b32 s51, 0, s51
    s_barrier
    ds_read_b128 v[108:111], v9 offset:0
    ds_read_b128 v[76:79], v8 offset:0
    ds_read_b128 v[80:83], v8 offset:1024
    ds_read_b128 v[84:87], v8 offset:2048
    ds_read_b128 v[88:91], v8 offset:3072
    ds_read_b128 v[112:115], v9 offset:1024
    ds_read_b128 v[116:119], v10 offset:0
    ds_read_b128 v[120:123], v10 offset:1024
    s_waitcnt lgkmcnt(0)
    v_mfma_f32_16x16x32_bf16 v[44:47], v[108:111], v[76:79], 0
    ds_read_b128 v[124:127], v9 offset:8192
    v_mfma_f32_16x16x32_bf16 v[52:55], v[108:111], v[80:83], 0
    ds_read_b128 v[92:95], v8 offset:8192
    v_mfma_f32_16x16x32_bf16 v[60:63], v[108:111], v[84:87], 0
    ds_read_b128 v[96:99], v8 offset:9216
    v_mfma_f32_16x16x32_bf16 v[68:71], v[108:111], v[88:91], 0
    ds_read_b128 v[100:103], v8 offset:10240
    v_mfma_f32_16x16x32_bf16 v[72:75], v[112:115], v[88:91], 0
    ds_read_b128 v[104:107], v8 offset:11264
    v_mfma_f32_16x16x32_bf16 v[64:67], v[112:115], v[84:87], 0
    ds_read_b128 v[128:131], v9 offset:9216
    v_mfma_f32_16x16x32_bf16 v[56:59], v[112:115], v[80:83], 0
    ds_read_b128 v[132:135], v10 offset:8192
    v_mfma_f32_16x16x32_bf16 v[48:51], v[112:115], v[76:79], 0
    ds_read_b128 v[136:139], v10 offset:9216
    v_mfma_f32_16x16x32_bf16 v[12:15], v[116:119], v[76:79], 0
    v_add_u32 v8, s53, v8
    v_mfma_f32_16x16x32_bf16 v[20:23], v[116:119], v[80:83], 0
    v_add_u32 v9, s54, v9
    v_mfma_f32_16x16x32_bf16 v[28:31], v[116:119], v[84:87], 0
    v_add_u32 v10, s54, v10
    v_mfma_f32_16x16x32_bf16 v[36:39], v[116:119], v[88:91], 0
    v_mfma_f32_16x16x32_bf16 v[40:43], v[120:123], v[88:91], 0
    v_mfma_f32_16x16x32_bf16 v[32:35], v[120:123], v[84:87], 0
    v_mfma_f32_16x16x32_bf16 v[24:27], v[120:123], v[80:83], 0
    v_mfma_f32_16x16x32_bf16 v[16:19], v[120:123], v[76:79], 0
    s_waitcnt lgkmcnt(0)
    s_barrier
    v_mfma_f32_16x16x32_bf16 v[44:47], v[124:127], v[92:95], v[44:47]
    ds_read_b128 v[108:111], v9 offset:0
    v_mfma_f32_16x16x32_bf16 v[52:55], v[124:127], v[96:99], v[52:55]
    ds_read_b128 v[76:79], v8 offset:0
    v_mfma_f32_16x16x32_bf16 v[60:63], v[124:127], v[100:103], v[60:63]
    ds_read_b128 v[80:83], v8 offset:1024
    v_mfma_f32_16x16x32_bf16 v[68:71], v[124:127], v[104:107], v[68:71]
    ds_read_b128 v[84:87], v8 offset:2048
    v_mfma_f32_16x16x32_bf16 v[72:75], v[128:131], v[104:107], v[72:75]
    ds_read_b128 v[88:91], v8 offset:3072
    v_mfma_f32_16x16x32_bf16 v[64:67], v[128:131], v[100:103], v[64:67]
    ds_read_b128 v[112:115], v9 offset:1024
    v_mfma_f32_16x16x32_bf16 v[56:59], v[128:131], v[96:99], v[56:59]
    ds_read_b128 v[116:119], v10 offset:0
    v_mfma_f32_16x16x32_bf16 v[48:51], v[128:131], v[92:95], v[48:51]
    ds_read_b128 v[120:123], v10 offset:1024
    v_mfma_f32_16x16x32_bf16 v[12:15], v[132:135], v[92:95], v[12:15]
    s_add_u32 s50, s50, 1
    s_mov_b32 s53, 16384
    v_mfma_f32_16x16x32_bf16 v[20:23], v[132:135], v[96:99], v[20:23]
    s_cmp_eq_u32 s50, 4
    s_cselect_b32 s53, -49152, s53
    v_mfma_f32_16x16x32_bf16 v[28:31], v[132:135], v[100:103], v[28:31]
    s_cselect_b32 s50, 0, s50
    v_mfma_f32_16x16x32_bf16 v[36:39], v[132:135], v[104:107], v[36:39]
    s_add_u32 s51, s51, 1
    s_mov_b32 s54, 16384
    v_mfma_f32_16x16x32_bf16 v[40:43], v[136:139], v[104:107], v[40:43]
    s_cmp_eq_u32 s51, 5
    s_cselect_b32 s54, -65536, s54
    v_mfma_f32_16x16x32_bf16 v[32:35], v[136:139], v[100:103], v[32:35]
    s_cselect_b32 s51, 0, s51
    v_mfma_f32_16x16x32_bf16 v[24:27], v[136:139], v[96:99], v[24:27]
    v_mfma_f32_16x16x32_bf16 v[16:19], v[136:139], v[92:95], v[16:19]
    .p2align 6
ffn2_loop:
    s_waitcnt lgkmcnt(0)
    v_mfma_f32_16x16x32_bf16 v[44:47], v[108:111], v[76:79], v[44:47]
    ds_read_b128 v[124:127], v9 offset:8192
    v_mfma_f32_16x16x32_bf16 v[52:55], v[108:111], v[80:83], v[52:55]
    ds_read_b128 v[92:95], v8 offset:8192
    v_mfma_f32_16x16x32_bf16 v[60:63], v[108:111], v[84:87], v[60:63]
    ds_read_b128 v[96:99], v8 offset:9216
    v_mfma_f32_16x16x32_bf16 v[68:71], v[108:111], v[88:91], v[68:71]
    ds_read_b128 v[100:103], v8 offset:10240
    v_mfma_f32_16x16x32_bf16 v[72:75], v[112:115], v[88:91], v[72:75]
    ds_read_b128 v[104:107], v8 offset:11264
    v_mfma_f32_16x16x32_bf16 v[64:67], v[112:115], v[84:87], v[64:67]
    ds_read_b128 v[128:131], v9 offset:9216
    v_mfma_f32_16x16x32_bf16 v[56:59], v[112:115], v[80:83], v[56:59]
    ds_read_b128 v[132:135], v10 offset:8192
    v_mfma_f32_16x16x32_bf16 v[48:51], v[112:115], v[76:79], v[48:51]
    ds_read_b128 v[136:139], v10 offset:9216
    v_mfma_f32_16x16x32_bf16 v[12:15], v[116:119], v[76:79], v[12:15]
    v_add_u32 v8, s53, v8
    v_mfma_f32_16x16x32_bf16 v[20:23], v[116:119], v[80:83], v[20:23]
    v_add_u32 v9, s54, v9
    v_mfma_f32_16x16x32_bf16 v[28:31], v[116:119], v[84:87], v[28:31]
    v_add_u32 v10, s54, v10
    v_mfma_f32_16x16x32_bf16 v[36:39], v[116:119], v[88:91], v[36:39]
    v_mfma_f32_16x16x32_bf16 v[40:43], v[120:123], v[88:91], v[40:43]
    v_mfma_f32_16x16x32_bf16 v[32:35], v[120:123], v[84:87], v[32:35]
    v_mfma_f32_16x16x32_bf16 v[24:27], v[120:123], v[80:83], v[24:27]
    v_mfma_f32_16x16x32_bf16 v[16:19], v[120:123], v[76:79], v[16:19]
    s_waitcnt lgkmcnt(0)
    s_barrier
    v_mfma_f32_16x16x32_bf16 v[44:47], v[124:127], v[92:95], v[44:47]
    ds_read_b128 v[108:111], v9 offset:0
    v_mfma_f32_16x16x32_bf16 v[52:55], v[124:127], v[96:99], v[52:55]
    ds_read_b128 v[76:79], v8 offset:0
    v_mfma_f32_16x16x32_bf16 v[60:63], v[124:127], v[100:103], v[60:63]
    ds_read_b128 v[80:83], v8 offset:1024
    v_mfma_f32_16x16x32_bf16 v[68:71], v[124:127], v[104:107], v[68:71]
    ds_read_b128 v[84:87], v8 offset:2048
    v_mfma_f32_16x16x32_bf16 v[72:75], v[128:131], v[104:107], v[72:75]
    ds_read_b128 v[88:91], v8 offset:3072
    v_mfma_f32_16x16x32_bf16 v[64:67], v[128:131], v[100:103], v[64:67]
    ds_read_b128 v[112:115], v9 offset:1024
    v_mfma_f32_16x16x32_bf16 v[56:59], v[128:131], v[96:99], v[56:59]
    ds_read_b128 v[116:119], v10 offset:0
    v_mfma_f32_16x16x32_bf16 v[48:51], v[128:131], v[92:95], v[48:51]
    ds_read_b128 v[120:123], v10 offset:1024
    v_mfma_f32_16x16x32_bf16 v[12:15], v[132:135], v[92:95], v[12:15]
    s_add_u32 s50, s50, 1
    s_mov_b32 s53, 16384
    v_mfma_f32_16x16x32_bf16 v[20:23], v[132:135], v[96:99], v[20:23]
    s_cmp_eq_u32 s50, 4
    s_cselect_b32 s53, -49152, s53
    v_mfma_f32_16x16x32_bf16 v[28:31], v[132:135], v[100:103], v[28:31]
    s_cselect_b32 s50, 0, s50
    v_mfma_f32_16x16x32_bf16 v[36:39], v[132:135], v[104:107], v[36:39]
    s_add_u32 s51, s51, 1
    s_mov_b32 s54, 16384
    v_mfma_f32_16x16x32_bf16 v[40:43], v[136:139], v[104:107], v[40:43]
    s_cmp_eq_u32 s51, 5
    s_cselect_b32 s54, -65536, s54
    v_mfma_f32_16x16x32_bf16 v[32:35], v[136:139], v[100:103], v[32:35]
    s_cselect_b32 s51, 0, s51
    v_mfma_f32_16x16x32_bf16 v[24:27], v[136:139], v[96:99], v[24:27]
    v_mfma_f32_16x16x32_bf16 v[16:19], v[136:139], v[92:95], v[16:19]
    s_waitcnt lgkmcnt(0)
    v_mfma_f32_16x16x32_bf16 v[44:47], v[108:111], v[76:79], v[44:47]
    ds_read_b128 v[124:127], v9 offset:8192
    v_mfma_f32_16x16x32_bf16 v[52:55], v[108:111], v[80:83], v[52:55]
    ds_read_b128 v[92:95], v8 offset:8192
    v_mfma_f32_16x16x32_bf16 v[60:63], v[108:111], v[84:87], v[60:63]
    ds_read_b128 v[96:99], v8 offset:9216
    v_mfma_f32_16x16x32_bf16 v[68:71], v[108:111], v[88:91], v[68:71]
    ds_read_b128 v[100:103], v8 offset:10240
    v_mfma_f32_16x16x32_bf16 v[72:75], v[112:115], v[88:91], v[72:75]
    ds_read_b128 v[104:107], v8 offset:11264
    v_mfma_f32_16x16x32_bf16 v[64:67], v[112:115], v[84:87], v[64:67]
    ds_read_b128 v[128:131], v9 offset:9216
    v_mfma_f32_16x16x32_bf16 v[56:59], v[112:115], v[80:83], v[56:59]
    ds_read_b128 v[132:135], v10 offset:8192
    v_mfma_f32_16x16x32_bf16 v[48:51], v[112:115], v[76:79], v[48:51]
    ds_read_b128 v[136:139], v10 offset:9216
    v_mfma_f32_16x16x32_bf16 v[12:15], v[116:119], v[76:79], v[12:15]
    v_add_u32 v8, s53, v8
    v_mfma_f32_16x16x32_bf16 v[20:23], v[116:119], v[80:83], v[20:23]
    v_add_u32 v9, s54, v9
    v_mfma_f32_16x16x32_bf16 v[28:31], v[116:119], v[84:87], v[28:31]
    v_add_u32 v10, s54, v10
    v_mfma_f32_16x16x32_bf16 v[36:39], v[116:119], v[88:91], v[36:39]
    s_cmp_lg_u32 s52, 13
    v_mfma_f32_16x16x32_bf16 v[40:43], v[120:123], v[88:91], v[40:43]
    v_mfma_f32_16x16x32_bf16 v[32:35], v[120:123], v[84:87], v[32:35]
    v_mfma_f32_16x16x32_bf16 v[24:27], v[120:123], v[80:83], v[24:27]
    v_mfma_f32_16x16x32_bf16 v[16:19], v[120:123], v[76:79], v[16:19]
    s_cbranch_scc1 ffn2_nodr
    s_waitcnt vmcnt(0)
ffn2_nodr:
    s_waitcnt lgkmcnt(0)
    s_barrier
    v_mfma_f32_16x16x32_bf16 v[44:47], v[124:127], v[92:95], v[44:47]
    ds_read_b128 v[108:111], v9 offset:0
    v_mfma_f32_16x16x32_bf16 v[52:55], v[124:127], v[96:99], v[52:55]
    ds_read_b128 v[76:79], v8 offset:0
    v_mfma_f32_16x16x32_bf16 v[60:63], v[124:127], v[100:103], v[60:63]
    ds_read_b128 v[80:83], v8 offset:1024
    v_mfma_f32_16x16x32_bf16 v[68:71], v[124:127], v[104:107], v[68:71]
    ds_read_b128 v[84:87], v8 offset:2048
    v_mfma_f32_16x16x32_bf16 v[72:75], v[128:131], v[104:107], v[72:75]
    ds_read_b128 v[88:91], v8 offset:3072
    v_mfma_f32_16x16x32_bf16 v[64:67], v[128:131], v[100:103], v[64:67]
    ds_read_b128 v[112:115], v9 offset:1024
    v_mfma_f32_16x16x32_bf16 v[56:59], v[128:131], v[96:99], v[56:59]
    ds_read_b128 v[116:119], v10 offset:0
    v_mfma_f32_16x16x32_bf16 v[48:51], v[128:131], v[92:95], v[48:51]
    ds_read_b128 v[120:123], v10 offset:1024
    v_mfma_f32_16x16x32_bf16 v[12:15], v[132:135], v[92:95], v[12:15]
    s_add_u32 s50, s50, 1
    s_mov_b32 s53, 16384
    v_mfma_f32_16x16x32_bf16 v[20:23], v[132:135], v[96:99], v[20:23]
    s_cmp_eq_u32 s50, 4
    s_cselect_b32 s53, -49152, s53
    v_mfma_f32_16x16x32_bf16 v[28:31], v[132:135], v[100:103], v[28:31]
    s_cselect_b32 s50, 0, s50
    v_mfma_f32_16x16x32_bf16 v[36:39], v[132:135], v[104:107], v[36:39]
    s_add_u32 s51, s51, 1
    s_mov_b32 s54, 16384
    v_mfma_f32_16x16x32_bf16 v[40:43], v[136:139], v[104:107], v[40:43]
    s_cmp_eq_u32 s51, 5
    s_cselect_b32 s54, -65536, s54
    v_mfma_f32_16x16x32_bf16 v[32:35], v[136:139], v[100:103], v[32:35]
    s_cselect_b32 s51, 0, s51
    v_mfma_f32_16x16x32_bf16 v[24:27], v[136:139], v[96:99], v[24:27]
    s_sub_u32 s52, s52, 1
    s_cmp_lg_u32 s52, 0
    v_mfma_f32_16x16x32_bf16 v[16:19], v[136:139], v[92:95], v[16:19]
    s_cbranch_scc1 ffn2_loop
    s_waitcnt lgkmcnt(0)
    v_mfma_f32_16x16x32_bf16 v[44:47], v[108:111], v[76:79], v[44:47]
    ds_read_b128 v[124:127], v9 offset:8192
    v_mfma_f32_16x16x32_bf16 v[52:55], v[108:111], v[80:83], v[52:55]
    ds_read_b128 v[92:95], v8 offset:8192
    v_mfma_f32_16x16x32_bf16 v[60:63], v[108:111], v[84:87], v[60:63]
    ds_read_b128 v[96:99], v8 offset:9216
    v_mfma_f32_16x16x32_bf16 v[68:71], v[108:111], v[88:91], v[68:71]
    ds_read_b128 v[100:103], v8 offset:10240
    v_mfma_f32_16x16x32_bf16 v[72:75], v[112:115], v[88:91], v[72:75]
    ds_read_b128 v[104:107], v8 offset:11264
    v_mfma_f32_16x16x32_bf16 v[64:67], v[112:115], v[84:87], v[64:67]
    ds_read_b128 v[128:131], v9 offset:9216
    v_mfma_f32_16x16x32_bf16 v[56:59], v[112:115], v[80:83], v[56:59]
    ds_read_b128 v[132:135], v10 offset:8192
    v_mfma_f32_16x16x32_bf16 v[48:51], v[112:115], v[76:79], v[48:51]
    ds_read_b128 v[136:139], v10 offset:9216
    v_mfma_f32_16x16x32_bf16 v[12:15], v[116:119], v[76:79], v[12:15]
    v_mfma_f32_16x16x32_bf16 v[20:23], v[116:119], v[80:83], v[20:23]
    v_mfma_f32_16x16x32_bf16 v[28:31], v[116:119], v[84:87], v[28:31]
    v_mfma_f32_16x16x32_bf16 v[36:39], v[116:119], v[88:91], v[36:39]
    v_mfma_f32_16x16x32_bf16 v[40:43], v[120:123], v[88:91], v[40:43]
    v_mfma_f32_16x16x32_bf16 v[32:35], v[120:123], v[84:87], v[32:35]
    v_mfma_f32_16x16x32_bf16 v[24:27], v[120:123], v[80:83], v[24:27]
    v_mfma_f32_16x16x32_bf16 v[16:19], v[120:123], v[76:79], v[16:19]
    s_waitcnt lgkmcnt(0)
    s_barrier
    v_mfma_f32_16x16x32_bf16 v[44:47], v[124:127], v[92:95], v[44:47]
    v_mfma_f32_16x16x32_bf16 v[52:55], v[124:127], v[96:99], v[52:55]
    v_mfma_f32_16x16x32_bf16 v[60:63], v[124:127], v[100:103], v[60:63]
    v_mfma_f32_16x16x32_bf16 v[68:71], v[124:127], v[104:107], v[68:71]
    v_mfma_f32_16x16x32_bf16 v[72:75], v[128:131], v[104:107], v[72:75]
    v_mfma_f32_16x16x32_bf16 v[64:67], v[128:131], v[100:103], v[64:67]
    v_mfma_f32_16x16x32_bf16 v[56:59], v[128:131], v[96:99], v[56:59]
    v_mfma_f32_16x16x32_bf16 v[48:51], v[128:131], v[92:95], v[48:51]
    s_nop 4
    v_cvt_pk_bf16_f32 v152, v68, v69
    v_cvt_pk_bf16_f32 v153, v70, v71
    v_cvt_pk_bf16_f32 v154, v72, v73
    v_mfma_f32_16x16x32_bf16 v[12:15], v[132:135], v[92:95], v[12:15]
    v_cvt_pk_bf16_f32 v155, v74, v75
    v_min_u32 v152, -2, v152
    v_min_u32 v153, -2, v153
    v_min_u32 v154, -2, v154
    v_mfma_f32_16x16x32_bf16 v[20:23], v[132:135], v[96:99], v[20:23]
    v_min_u32 v155, -2, v155
    buffer_store_dwordx4 v[152:155], v7, s[8:11], s46 offen offset:3072 sc0 sc1
    v_cvt_pk_bf16_f32 v148, v60, v61
    v_cvt_pk_bf16_f32 v149, v62, v63
    v_mfma_f32_16x16x32_bf16 v[28:31], v[132:135], v[100:103], v[28:31]
    v_cvt_pk_bf16_f32 v150, v64, v65
    v_cvt_pk_bf16_f32 v151, v66, v67
    v_min_u32 v148, -2, v148
    v_min_u32 v149, -2, v149
    v_mfma_f32_16x16x32_bf16 v[36:39], v[132:135], v[104:107], v[36:39]
    v_min_u32 v150, -2, v150
    v_min_u32 v151, -2, v151
    buffer_store_dwordx4 v[148:151], v7, s[8:11], s46 offen offset:2048 sc0 sc1
    v_cvt_pk_bf16_f32 v144, v52, v53
    v_mfma_f32_16x16x32_bf16 v[40:43], v[136:139], v[104:107], v[40:43]
    v_cvt_pk_bf16_f32 v145, v54, v55
    v_cvt_pk_bf16_f32 v146, v56, v57
    v_cvt_pk_bf16_f32 v147, v58, v59
    v_min_u32 v144, -2, v144
    v_mfma_f32_16x16x32_bf16 v[32:35], v[136:139], v[100:103], v[32:35]
    v_min_u32 v145, -2, v145
    v_min_u32 v146, -2, v146
    v_min_u32 v147, -2, v147
    buffer_store_dwordx4 v[144:147], v7, s[8:11], s46 offen offset:1024 sc0 sc1
    v_mfma_f32_16x16x32_bf16 v[24:27], v[136:139], v[96:99], v[24:27]
    v_cvt_pk_bf16_f32 v140, v44, v45
    v_cvt_pk_bf16_f32 v141, v46, v47
    v_cvt_pk_bf16_f32 v142, v48, v49
    v_cvt_pk_bf16_f32 v143, v50, v51
    v_mfma_f32_16x16x32_bf16 v[16:19], v[136:139], v[92:95], v[16:19]
    v_min_u32 v140, -2, v140
    v_min_u32 v141, -2, v141
    v_min_u32 v142, -2, v142
    v_min_u32 v143, -2, v143
    buffer_store_dwordx4 v[140:143], v7, s[8:11], s46 offen offset:0 sc0 sc1
    s_xor_b32 s47, s37, 1
    s_lshl_b32 s47, s47, 2
    s_add_u32 s47, s47, s7
    s_lshl_b32 s47, s47, 12
    s_add_u32 s47, s47, s36
    s_add_u32 s47, s47, 0x800000
    s_lshl_b32 s40, s4, 7
    s_lshl_b32 s41, s48, 6
    s_add_u32 s40, s40, s41
    v_and_b32 v2, 15, v0
    v_add_u32 v2, s40, v2
    v_lshlrev_b32 v6, 11, v2
    v_lshrrev_b32 v3, 4, v0
    s_lshl_b32 s42, s5, 7
    s_lshl_b32 s41, s49, 6
    s_add_u32 s42, s42, s41
    s_add_u32 s43, s42, 32768
    s_add_u32 s44, s42, 65536
    s_add_u32 s45, s42, 98304
    v_and_b32 v4, 1, v3
    v_lshlrev_b32 v4, 5, v4
    v_lshrrev_b32 v3, 1, v3
    v_lshl_add_u32 v4, v3, 4, v4
    s_cmp_lg_u32 s3, 0
    s_cbranch_scc1 ffn2_rowmajor
    v_and_b32 v6, 127, v2
    v_lshlrev_b32 v6, 7, v6
    v_add_u32 v4, s41, v4
    v_and_b32 v3, 7, v0
    v_lshlrev_b32 v3, 4, v3
    v_xor_b32 v4, v4, v3
    s_lshl_b32 s42, s37, 14
    s_add_u32 s43, s42, 2048
    s_add_u32 s44, s42, 4096
    s_add_u32 s45, s42, 6144
ffn2_rowmajor:
    v_add_u32 v6, v6, v4
    v_lshlrev_b32 v44, 16, v232
    v_and_b32 v45, 0xffff0000, v232
    v_lshlrev_b32 v46, 16, v233
    v_and_b32 v47, 0xffff0000, v233
    v_lshlrev_b32 v48, 16, v234
    v_and_b32 v49, 0xffff0000, v234
    v_lshlrev_b32 v50, 16, v235
    v_and_b32 v51, 0xffff0000, v235
    v_lshlrev_b32 v52, 16, v236
    v_and_b32 v53, 0xffff0000, v236
    v_lshlrev_b32 v54, 16, v237
    v_and_b32 v55, 0xffff0000, v237
    v_lshlrev_b32 v56, 16, v238
    v_and_b32 v57, 0xffff0000, v238
    v_lshlrev_b32 v58, 16, v239
    v_and_b32 v59, 0xffff0000, v239
    v_lshlrev_b32 v60, 16, v240
    v_and_b32 v61, 0xffff0000, v240
    v_lshlrev_b32 v62, 16, v241
    v_and_b32 v63, 0xffff0000, v241
    v_lshlrev_b32 v64, 16, v242
    v_and_b32 v65, 0xffff0000, v242
    v_lshlrev_b32 v66, 16, v243
    v_and_b32 v67, 0xffff0000, v243
    v_lshlrev_b32 v68, 16, v244
    v_and_b32 v69, 0xffff0000, v244
    v_lshlrev_b32 v70, 16, v245
    v_and_b32 v71, 0xffff0000, v245
    v_lshlrev_b32 v72, 16, v246
    v_and_b32 v73, 0xffff0000, v246
    v_lshlrev_b32 v74, 16, v247
    v_and_b32 v75, 0xffff0000, v247
    v_pk_add_f32 v[12:13], v[12:13], v[44:45]
    v_pk_add_f32 v[14:15], v[14:15], v[46:47]
    v_pk_add_f32 v[16:17], v[16:17], v[48:49]
    v_pk_add_f32 v[18:19], v[18:19], v[50:51]
    v_pk_add_f32 v[20:21], v[20:21], v[52:53]
    v_pk_add_f32 v[22:23], v[22:23], v[54:55]
    v_pk_add_f32 v[24:25], v[24:25], v[56:57]
    v_pk_add_f32 v[26:27], v[26:27], v[58:59]
    v_pk_add_f32 v[28:29], v[28:29], v[60:61]
    v_pk_add_f32 v[30:31], v[30:31], v[62:63]
    v_pk_add_f32 v[32:33], v[32:33], v[64:65]
    v_pk_add_f32 v[34:35], v[34:35], v[66:67]
    v_pk_add_f32 v[36:37], v[36:37], v[68:69]
    v_pk_add_f32 v[38:39], v[38:39], v[70:71]
    v_pk_add_f32 v[40:41], v[40:41], v[72:73]
    v_pk_add_f32 v[42:43], v[42:43], v[74:75]
    s_sleep 9
    s_mov_b32 s41, 100000
ffn2_pxw:
    buffer_load_dwordx4 v[76:79], v7, s[8:11], s47 offen offset:0 sc1
    buffer_load_dwordx4 v[80:83], v7, s[8:11], s47 offen offset:1024 sc1
    buffer_load_dwordx4 v[84:87], v7, s[8:11], s47 offen offset:2048 sc1
    buffer_load_dwordx4 v[88:91], v7, s[8:11], s47 offen offset:3072 sc1
    s_waitcnt vmcnt(0)
    v_max3_u32 v2, v76, v77, v78
    v_max_u32 v2, v2, v79
    v_max3_u32 v2, v2, v80, v81
    v_max3_u32 v2, v2, v82, v83
    v_max3_u32 v2, v2, v84, v85
    v_max3_u32 v2, v2, v86, v87
    v_max3_u32 v2, v2, v88, v89
    v_max3_u32 v2, v2, v90, v91
    v_cmp_eq_u32 vcc, -1, v2
    s_sub_u32 s41, s41, 1
    s_cbranch_scc1 ffn2_pxd
    s_nop 1
    s_cbranch_vccnz ffn2_pxw
ffn2_pxd:
    v_lshlrev_b32 v44, 16, v76
    v_and_b32 v45, 0xffff0000, v76
    v_lshlrev_b32 v46, 16, v77
    v_and_b32 v47, 0xffff0000, v77
    v_lshlrev_b32 v48, 16, v78
    v_and_b32 v49, 0xffff0000, v78
    v_lshlrev_b32 v50, 16, v79
    v_and_b32 v51, 0xffff0000, v79
    v_pk_add_f32 v[12:13], v[12:13], v[44:45]
    v_pk_add_f32 v[14:15], v[14:15], v[46:47]
    v_pk_add_f32 v[16:17], v[16:17], v[48:49]
    v_pk_add_f32 v[18:19], v[18:19], v[50:51]
    v_cvt_pk_bf16_f32 v140, v12, v13
    v_cvt_pk_bf16_f32 v141, v14, v15
    v_cvt_pk_bf16_f32 v142, v16, v17
    v_cvt_pk_bf16_f32 v143, v18, v19
    s_nop 1
    v_permlane16_swap_b32 v140, v142
    v_permlane16_swap_b32 v141, v143
    buffer_store_dwordx4 v[140:143], v6, s[16:19], s42 offen sc0 sc1
    v_lshlrev_b32 v52, 16, v80
    v_and_b32 v53, 0xffff0000, v80
    v_lshlrev_b32 v54, 16, v81
    v_and_b32 v55, 0xffff0000, v81
    v_lshlrev_b32 v56, 16, v82
    v_and_b32 v57, 0xffff0000, v82
    v_lshlrev_b32 v58, 16, v83
    v_and_b32 v59, 0xffff0000, v83
    v_pk_add_f32 v[20:21], v[20:21], v[52:53]
    v_pk_add_f32 v[22:23], v[22:23], v[54:55]
    v_pk_add_f32 v[24:25], v[24:25], v[56:57]
    v_pk_add_f32 v[26:27], v[26:27], v[58:59]
    v_cvt_pk_bf16_f32 v144, v20, v21
    v_cvt_pk_bf16_f32 v145, v22, v23
    v_cvt_pk_bf16_f32 v146, v24, v25
    v_cvt_pk_bf16_f32 v147, v26, v27
    s_nop 1
    v_permlane16_swap_b32 v144, v146
    v_permlane16_swap_b32 v145, v147
    buffer_store_dwordx4 v[144:147], v6, s[16:19], s43 offen sc0 sc1
    v_lshlrev_b32 v60, 16, v84
    v_and_b32 v61, 0xffff0000, v84
    v_lshlrev_b32 v62, 16, v85
    v_and_b32 v63, 0xffff0000, v85
    v_lshlrev_b32 v64, 16, v86
    v_and_b32 v65, 0xffff0000, v86
    v_lshlrev_b32 v66, 16, v87
    v_and_b32 v67, 0xffff0000, v87
    v_pk_add_f32 v[28:29], v[28:29], v[60:61]
    v_pk_add_f32 v[30:31], v[30:31], v[62:63]
    v_pk_add_f32 v[32:33], v[32:33], v[64:65]
    v_pk_add_f32 v[34:35], v[34:35], v[66:67]
    v_cvt_pk_bf16_f32 v148, v28, v29
    v_cvt_pk_bf16_f32 v149, v30, v31
    v_cvt_pk_bf16_f32 v150, v32, v33
    v_cvt_pk_bf16_f32 v151, v34, v35
    s_nop 1
    v_permlane16_swap_b32 v148, v150
    v_permlane16_swap_b32 v149, v151
    buffer_store_dwordx4 v[148:151], v6, s[16:19], s44 offen sc0 sc1
    v_lshlrev_b32 v68, 16, v88
    v_and_b32 v69, 0xffff0000, v88
    v_lshlrev_b32 v70, 16, v89
    v_and_b32 v71, 0xffff0000, v89
    v_lshlrev_b32 v72, 16, v90
    v_and_b32 v73, 0xffff0000, v90
    v_lshlrev_b32 v74, 16, v91
    v_and_b32 v75, 0xffff0000, v91
    v_pk_add_f32 v[36:37], v[36:37], v[68:69]
    v_pk_add_f32 v[38:39], v[38:39], v[70:71]
    v_pk_add_f32 v[40:41], v[40:41], v[72:73]
    v_pk_add_f32 v[42:43], v[42:43], v[74:75]
    v_cvt_pk_bf16_f32 v152, v36, v37
    v_cvt_pk_bf16_f32 v153, v38, v39
    v_cvt_pk_bf16_f32 v154, v40, v41
    v_cvt_pk_bf16_f32 v155, v42, v43
    s_nop 1
    v_permlane16_swap_b32 v152, v154
    v_permlane16_swap_b32 v153, v155
    buffer_store_dwordx4 v[152:155], v6, s[16:19], s45 offen sc0 sc1
    s_cmp_lg_u32 s3, 0
    s_cbranch_scc1 k_done
    v_cvt_pk_bf16_f32 v232, v12, v13
    v_cvt_pk_bf16_f32 v233, v14, v15
    v_cvt_pk_bf16_f32 v234, v16, v17
    v_cvt_pk_bf16_f32 v235, v18, v19
    v_cvt_pk_bf16_f32 v236, v20, v21
    v_cvt_pk_bf16_f32 v237, v22, v23
    v_cvt_pk_bf16_f32 v238, v24, v25
    v_cvt_pk_bf16_f32 v239, v26, v27
    v_cvt_pk_bf16_f32 v240, v28, v29
    v_cvt_pk_bf16_f32 v241, v30, v31
    v_cvt_pk_bf16_f32 v242, v32, v33
    v_cvt_pk_bf16_f32 v243, v34, v35
    v_cvt_pk_bf16_f32 v244, v36, v37
    v_cvt_pk_bf16_f32 v245, v38, v39
    v_cvt_pk_bf16_f32 v246, v40, v41
    v_cvt_pk_bf16_f32 v247, v42, v43
    s_waitcnt vmcnt(0)
    s_barrier
    s_branch layer_end
wo_loader:
    s_lshl_b32 s40, s7, 12
    v_lshl_add_u32 v2, v0, 4, s40
    s_lshl_b32 s41, s7, 11
    v_lshl_add_u32 v3, v0, 4, s41
    s_lshl_b32 s42, s4, 18
    s_add_u32 s42, s42, s36
    s_add_u32 s42, s42, 0x0
    s_lshl_b32 s43, s5, 17
    s_add_u32 s43, s43, 0x6000000
    s_lshl_b32 s60, s4, 11
    s_add_u32 s60, s60, s38
    s_lshl_b32 s61, s5, 2
    s_add_u32 s61, s61, s7
    s_lshl_b32 s61, s61, 2
    s_add_u32 s61, s61, s60
    s_add_u32 s61, s61, 1024
    s_waitcnt vmcnt(0)
    v_mov_b32 v15, 1
    s_mov_b64 exec, 1
    buffer_store_dword v15, off, s[8:11], s61 sc0 sc1
    s_mov_b64 exec, -1
    s_xor_b32 s48, s37, 0
    s_lshl_b32 s48, s48, 2
    s_add_u32 s48, s48, s7
    s_lshl_b32 s48, s48, 12
    s_add_u32 s48, s48, s36
    s_add_u32 s48, s48, 0x800000
    v_lshlrev_b32 v12, 4, v0
    v_mov_b32 v16, -1
    v_mov_b32 v17, -1
    v_mov_b32 v18, -1
    v_mov_b32 v19, -1
    buffer_store_dwordx4 v[16:19], v12, s[8:11], s48 offen offset:0 sc0 sc1
    buffer_store_dwordx4 v[16:19], v12, s[8:11], s48 offen offset:1024 sc0 sc1
    buffer_store_dwordx4 v[16:19], v12, s[8:11], s48 offen offset:2048 sc0 sc1
    buffer_store_dwordx4 v[16:19], v12, s[8:11], s48 offen offset:3072 sc0 sc1
    s_cmp_lg_u32 s3, 0
    s_cbranch_scc1 wo_wok_27
    s_mov_b32 s48, 0x4551800
    v_lshrrev_b32 v5, 2, v0
    v_lshlrev_b32 v5, 7, v5
    v_and_b32 v8, 3, v0
    v_lshl_add_u32 v5, v8, 4, v5
    s_mov_b32 s49, 100000
poll_28:
    buffer_load_dwordx4 v[8:11], v5, s[8:11], s48 offen sc1
    s_waitcnt vmcnt(0)
    v_min_u32 v8, v8, v9
    v_min_u32 v8, v8, v10
    v_min_u32 v8, v8, v11
    v_cmp_eq_u32 vcc, 0, v8
    s_sub_u32 s49, s49, 1
    s_cbranch_scc1 polld_29
    s_nop 1
    s_cbranch_vccz polld_29
    s_sleep 16
    s_branch poll_28
polld_29:
wo_wok_27:
    s_mov_b32 s44, 0
    s_mov_b32 s45, 131072
    s_mov_b32 s46, 4
wo_wpre_30:
    s_add_u32 m0, s45, s41
    s_nop 0
    buffer_load_dwordx4 v3, s[8:11], s43 offen offset:0 sc1 lds
    buffer_load_dwordx4 v3, s[8:11], s43 offen offset:1024 sc1 lds
    s_add_u32 s43, s43, 8192
    s_add_u32 s45, s45, 8192
    s_cmp_ge_u32 s45, 163840
    s_cselect_b32 s45, 65536, s45
    s_sub_u32 s46, s46, 1
    s_cmp_lg_u32 s46, 0
    s_cbranch_scc1 wo_wpre_30
    v_lshlrev_b32 v14, 2, v0
    v_mov_b32 v6, s40
slot_31:
    s_sleep 1
    ds_read_b32 v7, v6
    s_waitcnt lgkmcnt(0)
    v_cmp_gt_u32 vcc, 8, v7
    s_nop 4
    s_cbranch_vccnz slot_31
    s_add_u32 m0, s45, s41
    s_nop 0
    buffer_load_dwordx4 v3, s[8:11], s43 offen offset:0 sc1 lds
    buffer_load_dwordx4 v3, s[8:11], s43 offen offset:1024 sc1 lds
    s_add_u32 s43, s43, 8192
    s_add_u32 s45, s45, 8192
    s_cmp_ge_u32 s45, 163840
    s_cselect_b32 s45, 65536, s45
    s_add_u32 m0, s45, s41
    s_nop 0
    buffer_load_dwordx4 v3, s[8:11], s43 offen offset:0 sc1 lds
    buffer_load_dwordx4 v3, s[8:11], s43 offen offset:1024 sc1 lds
    s_add_u32 s43, s43, 8192
    s_add_u32 s45, s45, 8192
    s_cmp_ge_u32 s45, 163840
    s_cselect_b32 s45, 65536, s45
    s_add_u32 m0, s45, s41
    s_nop 0
    buffer_load_dwordx4 v3, s[8:11], s43 offen offset:0 sc1 lds
    buffer_load_dwordx4 v3, s[8:11], s43 offen offset:1024 sc1 lds
    s_add_u32 s43, s43, 8192
    s_add_u32 s45, s45, 8192
    s_cmp_ge_u32 s45, 163840
    s_cselect_b32 s45, 65536, s45
    s_add_u32 m0, s45, s41
    s_nop 0
    buffer_load_dwordx4 v3, s[8:11], s43 offen offset:0 sc1 lds
    buffer_load_dwordx4 v3, s[8:11], s43 offen offset:1024 sc1 lds
    s_add_u32 s43, s43, 8192
    s_add_u32 s45, s45, 8192
    s_cmp_ge_u32 s45, 163840
    s_cselect_b32 s45, 65536, s45
    s_mov_b32 s61, 100000
poll_32:
    buffer_load_dword v15, v14, s[8:11], s60 offen offset:1024 sc1
    s_waitcnt vmcnt(0)
    v_cmp_eq_u32 vcc, 0, v15
    s_sub_u32 s61, s61, 1
    s_cbranch_scc1 polld_33
    s_nop 1
    s_cbranch_vccz polld_33
    s_sleep 2
    s_branch poll_32
polld_33:
    s_add_u32 m0, s44, s40
    s_nop 0
    buffer_load_dwordx4 v2, s[8:11], s42 offen offset:0 sc1 lds
    buffer_load_dwordx4 v2, s[8:11], s42 offen offset:1024 sc1 lds
    buffer_load_dwordx4 v2, s[8:11], s42 offen offset:2048 sc1 lds
    buffer_load_dwordx4 v2, s[8:11], s42 offen offset:3072 sc1 lds
    s_add_u32 s42, s42, 16384
    s_add_u32 s44, s44, 16384
    s_cmp_ge_u32 s44, 65536
    s_cselect_b32 s44, 0, s44
    s_add_u32 m0, s44, s40
    s_nop 0
    buffer_load_dwordx4 v2, s[8:11], s42 offen offset:0 sc1 lds
    buffer_load_dwordx4 v2, s[8:11], s42 offen offset:1024 sc1 lds
    buffer_load_dwordx4 v2, s[8:11], s42 offen offset:2048 sc1 lds
    buffer_load_dwordx4 v2, s[8:11], s42 offen offset:3072 sc1 lds
    s_add_u32 s42, s42, 16384
    s_add_u32 s44, s44, 16384
    s_cmp_ge_u32 s44, 65536
    s_cselect_b32 s44, 0, s44
    s_add_u32 m0, s44, s40
    s_nop 0
    buffer_load_dwordx4 v2, s[8:11], s42 offen offset:0 sc1 lds
    buffer_load_dwordx4 v2, s[8:11], s42 offen offset:1024 sc1 lds
    buffer_load_dwordx4 v2, s[8:11], s42 offen offset:2048 sc1 lds
    buffer_load_dwordx4 v2, s[8:11], s42 offen offset:3072 sc1 lds
    s_add_u32 s42, s42, 16384
    s_add_u32 s44, s44, 16384
    s_cmp_ge_u32 s44, 65536
    s_cselect_b32 s44, 0, s44
    s_add_u32 m0, s44, s40
    s_nop 0
    buffer_load_dwordx4 v2, s[8:11], s42 offen offset:0 sc1 lds
    buffer_load_dwordx4 v2, s[8:11], s42 offen offset:1024 sc1 lds
    buffer_load_dwordx4 v2, s[8:11], s42 offen offset:2048 sc1 lds
    buffer_load_dwordx4 v2, s[8:11], s42 offen offset:3072 sc1 lds
    s_add_u32 s42, s42, 16384
    s_add_u32 s44, s44, 16384
    s_cmp_ge_u32 s44, 65536
    s_cselect_b32 s44, 0, s44
    s_waitcnt vmcnt(12)
    s_barrier
    s_setprio 0
    s_cmp_lg_u32 s6, 5
    s_cbranch_scc1 pubo_34
    s_lshl_b32 s61, s5, 2
    s_add_u32 s61, s61, s60
    v_mov_b32 v15, 1
    s_mov_b64 exec, 1
    buffer_store_dword v15, off, s[8:11], s61 sc0 sc1
    s_mov_b64 exec, -1
pubo_34:
    s_cmp_lg_u32 s6, 7
    s_cbranch_scc1 pubw_35
    s_cmp_lg_u32 s3, 0
    s_cbranch_scc1 pubw_35
    s_lshl_b32 s48, s4, 7
    s_lshl_b32 s49, s5, 2
    s_add_u32 s48, s48, s49
    s_add_u32 s48, s48, 0x4551000
    v_mov_b32 v15, 1
    s_mov_b64 exec, 1
    buffer_store_dword v15, off, s[8:11], s48 sc0 sc1
    s_mov_b64 exec, -1
pubw_35:
    s_waitcnt vmcnt(8)
    s_barrier
    s_add_u32 m0, s45, s41
    s_nop 0
    buffer_load_dwordx4 v3, s[8:11], s43 offen offset:0 sc1 lds
    buffer_load_dwordx4 v3, s[8:11], s43 offen offset:1024 sc1 lds
    s_add_u32 s43, s43, 8192
    s_add_u32 s45, s45, 8192
    s_cmp_ge_u32 s45, 163840
    s_cselect_b32 s45, 65536, s45
    s_add_u32 m0, s44, s40
    s_nop 0
    buffer_load_dwordx4 v2, s[8:11], s42 offen offset:0 sc1 lds
    buffer_load_dwordx4 v2, s[8:11], s42 offen offset:1024 sc1 lds
    buffer_load_dwordx4 v2, s[8:11], s42 offen offset:2048 sc1 lds
    buffer_load_dwordx4 v2, s[8:11], s42 offen offset:3072 sc1 lds
    s_add_u32 s42, s42, 16384
    s_add_u32 s44, s44, 16384
    s_cmp_ge_u32 s44, 65536
    s_cselect_b32 s44, 0, s44
    s_waitcnt vmcnt(10)
    s_barrier
    s_add_u32 m0, s45, s41
    s_nop 0
    buffer_load_dwordx4 v3, s[8:11], s43 offen offset:0 sc1 lds
    buffer_load_dwordx4 v3, s[8:11], s43 offen offset:1024 sc1 lds
    s_add_u32 s43, s43, 8192
    s_add_u32 s45, s45, 8192
    s_cmp_ge_u32 s45, 163840
    s_cselect_b32 s45, 65536, s45
    s_add_u32 m0, s44, s40
    s_nop 0
    buffer_load_dwordx4 v2, s[8:11], s42 offen offset:0 sc1 lds
    buffer_load_dwordx4 v2, s[8:11], s42 offen offset:1024 sc1 lds
    buffer_load_dwordx4 v2, s[8:11], s42 offen offset:2048 sc1 lds
    buffer_load_dwordx4 v2, s[8:11], s42 offen offset:3072 sc1 lds
    s_add_u32 s42, s42, 16384
    s_add_u32 s44, s44, 16384
    s_cmp_ge_u32 s44, 65536
    s_cselect_b32 s44, 0, s44
    s_waitcnt vmcnt(12)
    s_barrier
    s_add_u32 m0, s45, s41
    s_nop 0
    buffer_load_dwordx4 v3, s[8:11], s43 offen offset:0 sc1 lds
    buffer_load_dwordx4 v3, s[8:11], s43 offen offset:1024 sc1 lds
    s_add_u32 s43, s43, 8192
    s_add_u32 s45, s45, 8192
    s_cmp_ge_u32 s45, 163840
    s_cselect_b32 s45, 65536, s45
    s_add_u32 m0, s44, s40
    s_nop 0
    buffer_load_dwordx4 v2, s[8:11], s42 offen offset:0 sc1 lds
    buffer_load_dwordx4 v2, s[8:11], s42 offen offset:1024 sc1 lds
    buffer_load_dwordx4 v2, s[8:11], s42 offen offset:2048 sc1 lds
    buffer_load_dwordx4 v2, s[8:11], s42 offen offset:3072 sc1 lds
    s_add_u32 s42, s42, 16384
    s_add_u32 s44, s44, 16384
    s_cmp_ge_u32 s44, 65536
    s_cselect_b32 s44, 0, s44
    s_waitcnt vmcnt(12)
    s_barrier
    s_add_u32 m0, s45, s41
    s_nop 0
    buffer_load_dwordx4 v3, s[8:11], s43 offen offset:0 sc1 lds
    buffer_load_dwordx4 v3, s[8:11], s43 offen offset:1024 sc1 lds
    s_add_u32 s43, s43, 8192
    s_add_u32 s45, s45, 8192
    s_cmp_ge_u32 s45, 163840
    s_cselect_b32 s45, 65536, s45
    s_add_u32 m0, s44, s40
    s_nop 0
    buffer_load_dwordx4 v2, s[8:11], s42 offen offset:0 sc1 lds
    buffer_load_dwordx4 v2, s[8:11], s42 offen offset:1024 sc1 lds
    buffer_load_dwordx4 v2, s[8:11], s42 offen offset:2048 sc1 lds
    buffer_load_dwordx4 v2, s[8:11], s42 offen offset:3072 sc1 lds
    s_add_u32 s42, s42, 16384
    s_add_u32 s44, s44, 16384
    s_cmp_ge_u32 s44, 65536
    s_cselect_b32 s44, 0, s44
    s_cmp_lg_u32 s6, 4
    s_cbranch_scc1 looko_36
    v_and_b32 v13, 15, v0
    v_lshlrev_b32 v13, 2, v13
    buffer_load_dword v15, v13, s[8:11], s60 offen sc1
looko_36:
    s_waitcnt vmcnt(12)
    s_barrier
    s_add_u32 m0, s45, s41
    s_nop 0
    buffer_load_dwordx4 v3, s[8:11], s43 offen offset:0 sc1 lds
    buffer_load_dwordx4 v3, s[8:11], s43 offen offset:1024 sc1 lds
    s_add_u32 s43, s43, 8192
    s_add_u32 s45, s45, 8192
    s_cmp_ge_u32 s45, 163840
    s_cselect_b32 s45, 65536, s45
    s_cmp_lg_u32 s6, 4
    s_cbranch_scc1 chko_37
    s_waitcnt vmcnt(0)
    v_cmp_eq_u32 vcc, 0, v15
    s_nop 4
    s_cbranch_vccz chkd_38
    s_mov_b32 s61, 100000
poll_39:
    buffer_load_dword v15, v13, s[8:11], s60 offen sc1
    s_waitcnt vmcnt(0)
    v_cmp_eq_u32 vcc, 0, v15
    s_sub_u32 s61, s61, 1
    s_cbranch_scc1 polld_40
    s_nop 1
    s_cbranch_vccz polld_40
    s_sleep 2
    s_branch poll_39
polld_40:
chkd_38:
chko_37:
    s_waitcnt vmcnt(8)
    s_barrier
    s_add_u32 m0, s45, s41
    s_nop 0
    buffer_load_dwordx4 v3, s[8:11], s43 offen offset:0 sc1 lds
    buffer_load_dwordx4 v3, s[8:11], s43 offen offset:1024 sc1 lds
    s_add_u32 s43, s43, 8192
    s_add_u32 s45, s45, 8192
    s_cmp_ge_u32 s45, 163840
    s_cselect_b32 s45, 65536, s45
    s_add_u32 m0, s44, s40
    s_nop 0
    buffer_load_dwordx4 v2, s[8:11], s42 offen offset:0 sc1 lds
    buffer_load_dwordx4 v2, s[8:11], s42 offen offset:1024 sc1 lds
    buffer_load_dwordx4 v2, s[8:11], s42 offen offset:2048 sc1 lds
    buffer_load_dwordx4 v2, s[8:11], s42 offen offset:3072 sc1 lds
    s_add_u32 s42, s42, 16384
    s_add_u32 s44, s44, 16384
    s_cmp_ge_u32 s44, 65536
    s_cselect_b32 s44, 0, s44
    s_add_u32 m0, s44, s40
    s_nop 0
    buffer_load_dwordx4 v2, s[8:11], s42 offen offset:0 sc1 lds
    buffer_load_dwordx4 v2, s[8:11], s42 offen offset:1024 sc1 lds
    buffer_load_dwordx4 v2, s[8:11], s42 offen offset:2048 sc1 lds
    buffer_load_dwordx4 v2, s[8:11], s42 offen offset:3072 sc1 lds
    s_add_u32 s42, s42, 16384
    s_add_u32 s44, s44, 16384
    s_cmp_ge_u32 s44, 65536
    s_cselect_b32 s44, 0, s44
    s_waitcnt vmcnt(12)
    s_barrier
    s_add_u32 m0, s45, s41
    s_nop 0
    buffer_load_dwordx4 v3, s[8:11], s43 offen offset:0 sc1 lds
    buffer_load_dwordx4 v3, s[8:11], s43 offen offset:1024 sc1 lds
    s_add_u32 s43, s43, 8192
    s_add_u32 s45, s45, 8192
    s_cmp_ge_u32 s45, 163840
    s_cselect_b32 s45, 65536, s45
    s_add_u32 m0, s44, s40
    s_nop 0
    buffer_load_dwordx4 v2, s[8:11], s42 offen offset:0 sc1 lds
    buffer_load_dwordx4 v2, s[8:11], s42 offen offset:1024 sc1 lds
    buffer_load_dwordx4 v2, s[8:11], s42 offen offset:2048 sc1 lds
    buffer_load_dwordx4 v2, s[8:11], s42 offen offset:3072 sc1 lds
    s_add_u32 s42, s42, 16384
    s_add_u32 s44, s44, 16384
    s_cmp_ge_u32 s44, 65536
    s_cselect_b32 s44, 0, s44
    s_waitcnt vmcnt(10)
    s_barrier
    s_add_u32 m0, s45, s41
    s_nop 0
    buffer_load_dwordx4 v3, s[8:11], s43 offen offset:0 sc1 lds
    buffer_load_dwordx4 v3, s[8:11], s43 offen offset:1024 sc1 lds
    s_add_u32 s43, s43, 8192
    s_add_u32 s45, s45, 8192
    s_cmp_ge_u32 s45, 163840
    s_cselect_b32 s45, 65536, s45
    s_add_u32 m0, s44, s40
    s_nop 0
    buffer_load_dwordx4 v2, s[8:11], s42 offen offset:0 sc1 lds
    buffer_load_dwordx4 v2, s[8:11], s42 offen offset:1024 sc1 lds
    buffer_load_dwordx4 v2, s[8:11], s42 offen offset:2048 sc1 lds
    buffer_load_dwordx4 v2, s[8:11], s42 offen offset:3072 sc1 lds
    s_add_u32 s42, s42, 16384
    s_add_u32 s44, s44, 16384
    s_cmp_ge_u32 s44, 65536
    s_cselect_b32 s44, 0, s44
    s_waitcnt vmcnt(12)
    s_barrier
    s_add_u32 m0, s44, s40
    s_nop 0
    buffer_load_dwordx4 v2, s[8:11], s42 offen offset:0 sc1 lds
    buffer_load_dwordx4 v2, s[8:11], s42 offen offset:1024 sc1 lds
    buffer_load_dwordx4 v2, s[8:11], s42 offen offset:2048 sc1 lds
    buffer_load_dwordx4 v2, s[8:11], s42 offen offset:3072 sc1 lds
    s_add_u32 s42, s42, 16384
    s_add_u32 s44, s44, 16384
    s_cmp_ge_u32 s44, 65536
    s_cselect_b32 s44, 0, s44
    s_waitcnt vmcnt(10)
    s_barrier
    s_add_u32 m0, s44, s40
    s_nop 0
    buffer_load_dwordx4 v2, s[8:11], s42 offen offset:0 sc1 lds
    buffer_load_dwordx4 v2, s[8:11], s42 offen offset:1024 sc1 lds
    buffer_load_dwordx4 v2, s[8:11], s42 offen offset:2048 sc1 lds
    buffer_load_dwordx4 v2, s[8:11], s42 offen offset:3072 sc1 lds
    s_add_u32 s42, s42, 16384
    s_add_u32 s44, s44, 16384
    s_cmp_ge_u32 s44, 65536
    s_cselect_b32 s44, 0, s44
    s_mov_b32 s46, 2
wo_ld_41:
    s_waitcnt vmcnt(8)
    s_barrier
    s_add_u32 m0, s44, s40
    s_nop 0
    buffer_load_dwordx4 v2, s[8:11], s42 offen offset:0 sc1 lds
    buffer_load_dwordx4 v2, s[8:11], s42 offen offset:1024 sc1 lds
    buffer_load_dwordx4 v2, s[8:11], s42 offen offset:2048 sc1 lds
    buffer_load_dwordx4 v2, s[8:11], s42 offen offset:3072 sc1 lds
    s_add_u32 s42, s42, 16384
    s_add_u32 s44, s44, 16384
    s_cmp_ge_u32 s44, 65536
    s_cselect_b32 s44, 0, s44
    s_sub_u32 s46, s46, 1
    s_cmp_lg_u32 s46, 0
    s_cbranch_scc1 wo_ld_41
    s_waitcnt vmcnt(8)
    s_barrier
    s_cmp_lg_u32 s6, 6
    s_cbranch_scc1 chkw_42
    s_cmp_lg_u32 s3, 0
    s_cbranch_scc1 chkw_42
    s_mov_b32 s48, 0x4551000
    v_lshrrev_b32 v5, 2, v0
    v_lshlrev_b32 v5, 7, v5
    v_and_b32 v8, 3, v0
    v_lshl_add_u32 v5, v8, 4, v5
    s_mov_b32 s49, 100000
poll_43:
    buffer_load_dwordx4 v[8:11], v5, s[8:11], s48 offen sc1
    s_waitcnt vmcnt(0)
    v_min_u32 v8, v8, v9
    v_min_u32 v8, v8, v10
    v_min_u32 v8, v8, v11
    v_cmp_eq_u32 vcc, 0, v8
    s_sub_u32 s49, s49, 1
    s_cbranch_scc1 polld_44
    s_nop 1
    s_cbranch_vccz polld_44
    s_sleep 16
    s_branch poll_43
polld_44:
chkw_42:
    s_waitcnt vmcnt(4)
    s_barrier
    s_mul_i32 s41, s7, 7168
    v_lshl_add_u32 v3, v0, 4, s41
    v_add_u32 v4, 4096, v3
    s_add_u32 s47, s41, 4096
    s_mul_i32 s43, s5, 458752
    s_add_u32 s43, s43, 0x5000000
    s_mov_b32 s51, s5
    s_mov_b32 s53, -1
    s_mov_b32 s45, 98304
    s_add_u32 m0, s45, s41
    s_mul_i32 s52, s51, 28672
    s_add_u32 s52, s52, s43
    buffer_load_dwordx4 v3, s[8:11], s52 offen offset:0 sc1 lds
    buffer_load_dwordx4 v3, s[8:11], s52 offen offset:1024 sc1 lds
    buffer_load_dwordx4 v3, s[8:11], s52 offen offset:2048 sc1 lds
    buffer_load_dwordx4 v3, s[8:11], s52 offen offset:3072 sc1 lds
    s_add_u32 m0, s45, s47
    s_add_u32 s53, s53, 1
    s_cmp_eq_u32 s53, s5
    s_addc_u32 s53, s53, 0
    s_mov_b32 s51, s53
    buffer_load_dwordx4 v4, s[8:11], s52 offen offset:0 sc1 lds
    buffer_load_dwordx4 v4, s[8:11], s52 offen offset:1024 sc1 lds
    buffer_load_dwordx4 v4, s[8:11], s52 offen offset:2048 sc1 lds
    s_waitcnt vmcnt(7)
    s_barrier
    s_mov_b32 s45, 126976
    s_add_u32 m0, s45, s41
    s_mul_i32 s52, s51, 28672
    s_add_u32 s52, s52, s43
    buffer_load_dwordx4 v3, s[8:11], s52 offen offset:0 sc1 lds
    buffer_load_dwordx4 v3, s[8:11], s52 offen offset:1024 sc1 lds
    buffer_load_dwordx4 v3, s[8:11], s52 offen offset:2048 sc1 lds
    buffer_load_dwordx4 v3, s[8:11], s52 offen offset:3072 sc1 lds
    s_add_u32 m0, s45, s47
    s_add_u32 s53, s53, 1
    s_cmp_eq_u32 s53, s5
    s_addc_u32 s53, s53, 0
    s_mov_b32 s51, s53
    buffer_load_dwordx4 v4, s[8:11], s52 offen offset:0 sc1 lds
    buffer_load_dwordx4 v4, s[8:11], s52 offen offset:1024 sc1 lds
    buffer_load_dwordx4 v4, s[8:11], s52 offen offset:2048 sc1 lds
    s_barrier
ffn1_loader:
    s_waitcnt vmcnt(7)
    s_barrier
    s_lshl_b32 s40, s7, 12
    v_lshl_add_u32 v2, v0, 4, s40
    s_lshl_b32 s42, s4, 18
    s_add_u32 s42, s42, s36
    s_add_u32 s42, s42, 0x400000
    s_mov_b32 s50, s5
    s_mov_b32 s54, -1
    v_and_b32 v12, 15, v0
    v_lshrrev_b32 v13, 4, v0
    s_mul_i32 s48, s7, 224
    v_lshl_add_u32 v5, v12, 4, s48
    v_mul_u32_u24 v10, 57344, v13
    v_add_u32 v10, v10, v5
    v_lshl_add_u32 v5, v13, 2, v5
    v_add_u32 v5, 156672, v5
    s_mul_i32 s55, s5, 896
    s_add_u32 s55, s55, 0x4400000
    s_lshl_b32 s48, s7, 8
    v_lshl_add_u32 v8, v12, 4, s48
    v_lshl_add_u32 v9, v13, 17, v8
    v_lshrrev_b32 v13, 5, v0
    v_lshl_add_u32 v8, v13, 3, v8
    v_add_u32 v8, 155648, v8
    s_lshl_b32 s48, s4, 10
    s_add_u32 s48, s48, s36
    s_add_u32 s48, s48, 0x1e40000
    buffer_load_dwordx4 v[64:67], v10, s[8:11], s55 offen sc1
    s_add_u32 s55, s55, 14336
    buffer_load_dwordx4 v[68:71], v10, s[8:11], s55 offen sc1
    s_add_u32 s55, s55, 14336
    buffer_load_dwordx4 v[72:75], v10, s[8:11], s55 offen sc1
    s_add_u32 s55, s55, 14336
    buffer_load_dwordx4 v[76:79], v10, s[8:11], s55 offen sc1
    s_add_u32 s55, s55, 14336
    s_mov_b32 s44, 16384
    s_mov_b32 s45, 69632
    s_barrier
    s_cmp_lg_u32 s6, 4
    s_cbranch_scc1 go_45
    s_lshl_b32 s60, s4, 11
    s_add_u32 s60, s60, s38
    s_add_u32 s60, s60, 32768
    v_and_b32 v14, 15, v0
    v_lshlrev_b32 v14, 2, v14
    s_sleep 14
    s_mov_b32 s61, 100000
poll_46:
    buffer_load_dword v15, v14, s[8:11], s60 offen sc1
    s_waitcnt vmcnt(0)
    v_cmp_eq_u32 vcc, 0, v15
    s_sub_u32 s61, s61, 1
    s_cbranch_scc1 polld_47
    s_nop 1
    s_cbranch_vccz polld_47
    s_sleep 2
    s_branch poll_46
polld_47:
go_45:
    s_barrier
    s_add_u32 m0, s44, s40
    s_add_u32 s54, s54, 1
    s_cmp_eq_u32 s54, s5
    s_addc_u32 s54, s54, 0
    s_mov_b32 s50, s54
    s_lshl_b32 s52, s50, 14
    s_add_u32 s52, s52, s42
    buffer_load_dwordx4 v2, s[8:11], s52 offen offset:0 sc1 lds
    buffer_load_dwordx4 v2, s[8:11], s52 offen offset:1024 sc1 lds
    buffer_load_dwordx4 v2, s[8:11], s52 offen offset:2048 sc1 lds
    buffer_load_dwordx4 v2, s[8:11], s52 offen offset:3072 sc1 lds
    s_add_u32 s44, s44, 16384
    s_cmp_ge_u32 s44, 49152
    s_cselect_b32 s44, 0, s44
    s_add_u32 m0, s45, s41
    s_mul_i32 s52, s51, 28672
    s_add_u32 s52, s52, s43
    buffer_load_dwordx4 v3, s[8:11], s52 offen offset:0 sc1 lds
    buffer_load_dwordx4 v3, s[8:11], s52 offen offset:1024 sc1 lds
    buffer_load_dwordx4 v3, s[8:11], s52 offen offset:2048 sc1 lds
    buffer_load_dwordx4 v3, s[8:11], s52 offen offset:3072 sc1 lds
    s_add_u32 m0, s45, s47
    s_add_u32 s53, s53, 1
    s_cmp_eq_u32 s53, s5
    s_addc_u32 s53, s53, 0
    s_mov_b32 s51, s53
    buffer_load_dwordx4 v4, s[8:11], s52 offen offset:0 sc1 lds
    buffer_load_dwordx4 v4, s[8:11], s52 offen offset:1024 sc1 lds
    buffer_load_dwordx4 v4, s[8:11], s52 offen offset:2048 sc1 lds
    s_add_u32 s45, s45, 28672
    s_cmp_ge_u32 s45, 155648
    s_cselect_b32 s45, 69632, s45
    s_add_u32 m0, s44, s40
    s_add_u32 s54, s54, 1
    s_cmp_eq_u32 s54, s5
    s_addc_u32 s54, s54, 0
    s_mov_b32 s50, s54
    s_lshl_b32 s52, s50, 14
    s_add_u32 s52, s52, s42
    buffer_load_dwordx4 v2, s[8:11], s52 offen offset:0 sc1 lds
    buffer_load_dwordx4 v2, s[8:11], s52 offen offset:1024 sc1 lds
    buffer_load_dwordx4 v2, s[8:11], s52 offen offset:2048 sc1 lds
    buffer_load_dwordx4 v2, s[8:11], s52 offen offset:3072 sc1 lds
    s_add_u32 s44, s44, 16384
    s_cmp_ge_u32 s44, 49152
    s_cselect_b32 s44, 0, s44
    s_waitcnt vmcnt(11)
    s_barrier
    s_add_u32 m0, s45, s41
    s_mul_i32 s52, s51, 28672
    s_add_u32 s52, s52, s43
    buffer_load_dwordx4 v3, s[8:11], s52 offen offset:0 sc1 lds
    buffer_load_dwordx4 v3, s[8:11], s52 offen offset:1024 sc1 lds
    buffer_load_dwordx4 v3, s[8:11], s52 offen offset:2048 sc1 lds
    buffer_load_dwordx4 v3, s[8:11], s52 offen offset:3072 sc1 lds
    s_add_u32 m0, s45, s47
    s_add_u32 s53, s53, 1
    s_cmp_eq_u32 s53, s5
    s_addc_u32 s53, s53, 0
    s_mov_b32 s51, s53
    buffer_load_dwordx4 v4, s[8:11], s52 offen offset:0 sc1 lds
    buffer_load_dwordx4 v4, s[8:11], s52 offen offset:1024 sc1 lds
    buffer_load_dwordx4 v4, s[8:11], s52 offen offset:2048 sc1 lds
    s_add_u32 s45, s45, 28672
    s_cmp_ge_u32 s45, 155648
    s_cselect_b32 s45, 69632, s45
    s_add_u32 m0, s44, s40
    s_add_u32 s54, s54, 1
    s_cmp_eq_u32 s54, s5
    s_addc_u32 s54, s54, 0
    s_mov_b32 s50, s54
    s_lshl_b32 s52, s50, 14
    s_add_u32 s52, s52, s42
    buffer_load_dwordx4 v2, s[8:11], s52 offen offset:0 sc1 lds
    buffer_load_dwordx4 v2, s[8:11], s52 offen offset:1024 sc1 lds
    buffer_load_dwordx4 v2, s[8:11], s52 offen offset:2048 sc1 lds
    buffer_load_dwordx4 v2, s[8:11], s52 offen offset:3072 sc1 lds
    s_add_u32 s44, s44, 16384
    s_cmp_ge_u32 s44, 49152
    s_cselect_b32 s44, 0, s44
    s_mov_b32 s46, 11
ffn1_ld_48:
    s_waitcnt vmcnt(11)
    s_barrier
    s_add_u32 m0, s45, s41
    s_mul_i32 s52, s51, 28672
    s_add_u32 s52, s52, s43
    buffer_load_dwordx4 v3, s[8:11], s52 offen offset:0 sc1 lds
    buffer_load_dwordx4 v3, s[8:11], s52 offen offset:1024 sc1 lds
    buffer_load_dwordx4 v3, s[8:11], s52 offen offset:2048 sc1 lds
    buffer_load_dwordx4 v3, s[8:11], s52 offen offset:3072 sc1 lds
    s_add_u32 m0, s45, s47
    s_add_u32 s53, s53, 1
    s_cmp_eq_u32 s53, s5
    s_addc_u32 s53, s53, 0
    s_mov_b32 s51, s53
    buffer_load_dwordx4 v4, s[8:11], s52 offen offset:0 sc1 lds
    buffer_load_dwordx4 v4, s[8:11], s52 offen offset:1024 sc1 lds
    buffer_load_dwordx4 v4, s[8:11], s52 offen offset:2048 sc1 lds
    s_add_u32 s45, s45, 28672
    s_cmp_ge_u32 s45, 155648
    s_cselect_b32 s45, 69632, s45
    s_add_u32 m0, s44, s40
    s_add_u32 s54, s54, 1
    s_cmp_eq_u32 s54, s5
    s_addc_u32 s54, s54, 0
    s_mov_b32 s50, s54
    s_lshl_b32 s52, s50, 14
    s_add_u32 s52, s52, s42
    buffer_load_dwordx4 v2, s[8:11], s52 offen offset:0 sc1 lds
    buffer_load_dwordx4 v2, s[8:11], s52 offen offset:1024 sc1 lds
    buffer_load_dwordx4 v2, s[8:11], s52 offen offset:2048 sc1 lds
    buffer_load_dwordx4 v2, s[8:11], s52 offen offset:3072 sc1 lds
    s_add_u32 s44, s44, 16384
    s_cmp_ge_u32 s44, 49152
    s_cselect_b32 s44, 0, s44
    s_sub_u32 s46, s46, 1
    s_cmp_lg_u32 s46, 0
    s_cbranch_scc1 ffn1_ld_48
    s_waitcnt vmcnt(11)
    s_barrier
    s_add_u32 m0, s45, s41
    s_mul_i32 s52, s51, 28672
    s_add_u32 s52, s52, s43
    buffer_load_dwordx4 v3, s[8:11], s52 offen offset:0 sc1 lds
    buffer_load_dwordx4 v3, s[8:11], s52 offen offset:1024 sc1 lds
    buffer_load_dwordx4 v3, s[8:11], s52 offen offset:2048 sc1 lds
    buffer_load_dwordx4 v3, s[8:11], s52 offen offset:3072 sc1 lds
    s_add_u32 m0, s45, s47
    s_add_u32 s53, s53, 1
    s_cmp_eq_u32 s53, s5
    s_addc_u32 s53, s53, 0
    s_mov_b32 s51, s53
    buffer_load_dwordx4 v4, s[8:11], s52 offen offset:0 sc1 lds
    buffer_load_dwordx4 v4, s[8:11], s52 offen offset:1024 sc1 lds
    buffer_load_dwordx4 v4, s[8:11], s52 offen offset:2048 sc1 lds
    s_add_u32 s45, s45, 28672
    s_cmp_ge_u32 s45, 155648
    s_cselect_b32 s45, 69632, s45
    s_add_u32 m0, s44, s40
    s_add_u32 s54, s54, 1
    s_cmp_eq_u32 s54, s5
    s_addc_u32 s54, s54, 0
    s_mov_b32 s50, s54
    s_lshl_b32 s52, s50, 14
    s_add_u32 s52, s52, s42
    buffer_load_dwordx4 v2, s[8:11], s52 offen offset:0 sc1 lds
    buffer_load_dwordx4 v2, s[8:11], s52 offen offset:1024 sc1 lds
    buffer_load_dwordx4 v2, s[8:11], s52 offen offset:2048 sc1 lds
    buffer_load_dwordx4 v2, s[8:11], s52 offen offset:3072 sc1 lds
    s_add_u32 s44, s44, 16384
    s_cmp_ge_u32 s44, 49152
    s_cselect_b32 s44, 0, s44
    s_cmp_lg_u32 s6, 7
    s_cbranch_scc1 tch_49
    s_getpc_b64 s[86:87]
tc_50:
    s_sub_u32 s86, s86, tc_50-ffn1_epi
    s_subb_u32 s87, s87, 0
    v_lshlrev_b32 v230, 7, v0
    v_min_u32 v230, wo_loader-ffn1_epi-4, v230
    global_load_dword v231, v230, s[86:87]
tch_49:
    s_waitcnt vmcnt(11)
    s_barrier
    buffer_load_dwordx4 v[32:35], v9, s[8:11], s48 offen sc1
    s_add_u32 s48, s48, 16384
    buffer_load_dwordx4 v[36:39], v9, s[8:11], s48 offen sc1
    s_add_u32 s48, s48, 16384
    buffer_load_dwordx4 v[40:43], v9, s[8:11], s48 offen sc1
    s_add_u32 s48, s48, 16384
    buffer_load_dwordx4 v[44:47], v9, s[8:11], s48 offen sc1
    s_add_u32 s48, s48, 16384
    buffer_load_dwordx4 v[48:51], v9, s[8:11], s48 offen sc1
    s_add_u32 s48, s48, 16384
    buffer_load_dwordx4 v[52:55], v9, s[8:11], s48 offen sc1
    s_add_u32 s48, s48, 16384
    buffer_load_dwordx4 v[56:59], v9, s[8:11], s48 offen sc1
    s_add_u32 s48, s48, 16384
    buffer_load_dwordx4 v[60:63], v9, s[8:11], s48 offen sc1
    s_add_u32 s48, s48, 16384
    v_add_f32 v64, v64, v72
    v_add_f32 v65, v65, v73
    v_add_f32 v66, v66, v74
    v_add_f32 v67, v67, v75
    v_add_f32 v68, v68, v76
    v_add_f32 v69, v69, v77
    v_add_f32 v70, v70, v78
    v_add_f32 v71, v71, v79
    v_add_f32 v64, v64, v68
    v_add_f32 v65, v65, v69
    v_add_f32 v66, v66, v70
    v_add_f32 v67, v67, v71
    s_nop 1
    v_permlane32_swap_b32 v64, v66
    v_permlane32_swap_b32 v65, v67
    s_nop 1
    v_add_f32 v64, v64, v66
    v_add_f32 v65, v65, v67
    s_nop 1
    v_permlane16_swap_b32 v64, v65
    s_nop 1
    v_add_f32 v64, v64, v65
    ds_write_b32 v5, v64
    s_waitcnt vmcnt(8)
    s_barrier
    s_setprio 3
    s_waitcnt vmcnt(0)
    v_add_f32 v32, v32, v48
    v_add_f32 v33, v33, v49
    v_add_f32 v34, v34, v50
    v_add_f32 v35, v35, v51
    v_add_f32 v36, v36, v52
    v_add_f32 v37, v37, v53
    v_add_f32 v38, v38, v54
    v_add_f32 v39, v39, v55
    v_add_f32 v40, v40, v56
    v_add_f32 v41, v41, v57
    v_add_f32 v42, v42, v58
    v_add_f32 v43, v43, v59
    v_add_f32 v44, v44, v60
    v_add_f32 v45, v45, v61
    v_add_f32 v46, v46, v62
    v_add_f32 v47, v47, v63
    v_add_f32 v32, v32, v40
    v_add_f32 v33, v33, v41
    v_add_f32 v34, v34, v42
    v_add_f32 v35, v35, v43
    v_add_f32 v36, v36, v44
    v_add_f32 v37, v37, v45
    v_add_f32 v38, v38, v46
    v_add_f32 v39, v39, v47
    v_add_f32 v32, v32, v36
    v_add_f32 v33, v33, v37
    v_add_f32 v34, v34, v38
    v_add_f32 v35, v35, v39
    s_nop 1
    v_permlane32_swap_b32 v32, v34
    v_permlane32_swap_b32 v33, v35
    s_nop 1
    v_add_f32 v32, v32, v34
    v_add_f32 v33, v33, v35
    v_mov_b32 v34, v32
    v_mov_b32 v35, v33
    s_nop 1
    v_permlane16_swap_b32 v32, v34
    v_permlane16_swap_b32 v33, v35
    s_nop 1
    v_add_f32 v32, v32, v34
    v_add_f32 v33, v33, v35
    v_mul_f32 v32, 0x3a800000, v32
    v_mul_f32 v33, 0x3a800000, v33
    v_fma_f32 v33, -v32, v32, v33
    v_max_f32 v33, 0, v33
    v_cvt_pk_bf16_f32 v34, v32, v33
    v_lshlrev_b32 v32, 16, v34
    v_and_b32 v33, 0xffff0000, v34
    v_add_f32 v33, 0x3727c5ac, v33
    v_cvt_pk_bf16_f32 v34, v33, v33
    v_lshlrev_b32 v33, 16, v34
    v_sqrt_f32 v33, v33
    s_nop 0
    v_cvt_pk_bf16_f32 v34, v33, v33
    v_lshlrev_b32 v33, 16, v34
    v_sub_f32 v32, 0, v32
    ds_write_b64 v8, v[32:33]
    s_waitcnt lgkmcnt(0)
    s_setprio 0
    s_lshl_b32 s40, s7, 12
    v_lshl_add_u32 v2, v0, 4, s40
    s_and_b32 s41, s5, 1
    s_mul_i32 s41, s41, 458752
    s_mul_i32 s42, s4, 917504
    s_add_u32 s42, s42, s41
    s_add_u32 s42, s42, s36
    s_add_u32 s42, s42, 0x1000000
    s_lshr_b32 s43, s5, 1
    s_mul_i32 s43, s43, 917504
    s_add_u32 s43, s43, s41
    s_add_u32 s43, s43, 0x5800000
    s_lshr_b32 s53, s5, 1
    s_mov_b32 s50, -1
    s_mov_b32 s51, s50
    s_add_u32 m0, s40, 65536
    s_add_u32 s52, s53, 0
    s_lshl_b32 s52, s52, 14
    s_add_u32 s52, s52, s43
    buffer_load_dwordx4 v2, s[8:11], s52 offen offset:0 sc1 lds
    buffer_load_dwordx4 v2, s[8:11], s52 offen offset:1024 sc1 lds
    buffer_load_dwordx4 v2, s[8:11], s52 offen offset:2048 sc1 lds
    buffer_load_dwordx4 v2, s[8:11], s52 offen offset:3072 sc1 lds
    s_add_u32 m0, s40, 81920
    s_add_u32 s52, s53, 8
    s_lshl_b32 s52, s52, 14
    s_add_u32 s52, s52, s43
    buffer_load_dwordx4 v2, s[8:11], s52 offen offset:0 sc1 lds
    buffer_load_dwordx4 v2, s[8:11], s52 offen offset:1024 sc1 lds
    buffer_load_dwordx4 v2, s[8:11], s52 offen offset:2048 sc1 lds
    buffer_load_dwordx4 v2, s[8:11], s52 offen offset:3072 sc1 lds
    s_barrier
ffn2_loader:
    v_mov_b32 v6, 157696
    v_mov_b32 v7, 0
    ds_write_b32 v6, v7
    s_waitcnt lgkmcnt(0)
    s_mov_b32 s44, 0
    s_mov_b32 s45, 65536
    s_add_u32 s45, s45, 32768
    s_add_u32 m0, s45, s40
    s_add_u32 s52, s53, 16
    s_lshl_b32 s52, s52, 14
    s_add_u32 s52, s52, s43
    buffer_load_dwordx4 v2, s[8:11], s52 offen offset:0 sc1 lds
    buffer_load_dwordx4 v2, s[8:11], s52 offen offset:1024 sc1 lds
    buffer_load_dwordx4 v2, s[8:11], s52 offen offset:2048 sc1 lds
    buffer_load_dwordx4 v2, s[8:11], s52 offen offset:3072 sc1 lds
    s_add_u32 s45, s45, 16384
    s_cmp_ge_u32 s45, 147456
    s_cselect_b32 s45, 65536, s45
    s_mov_b32 s44, 49152
    s_barrier
    s_waitcnt vmcnt(0)
    s_add_u32 m0, s45, s40
    s_add_u32 s51, s51, 1
    s_and_b32 s52, s51, 7
    s_cmp_eq_u32 s52, s53
    s_addc_u32 s51, s51, 0
    s_lshl_b32 s52, s51, 14
    s_add_u32 s52, s52, s43
    buffer_load_dwordx4 v2, s[8:11], s52 offen offset:0 sc1 lds
    buffer_load_dwordx4 v2, s[8:11], s52 offen offset:1024 sc1 lds
    buffer_load_dwordx4 v2, s[8:11], s52 offen offset:2048 sc1 lds
    buffer_load_dwordx4 v2, s[8:11], s52 offen offset:3072 sc1 lds
    s_add_u32 s45, s45, 16384
    s_cmp_ge_u32 s45, 147456
    s_cselect_b32 s45, 65536, s45
    s_cmp_lg_u32 s6, 4
    s_cbranch_scc1 go_55
    s_lshl_b32 s60, s4, 11
    s_add_u32 s60, s60, s38
    s_add_u32 s60, s60, 65536
    s_and_b32 s61, s5, 1
    v_and_b32 v14, 14, v0
    v_or_b32 v14, s61, v14
    v_lshlrev_b32 v14, 2, v14
    s_sleep 12
    buffer_load_dword v15, v14, s[8:11], s60 offen sc1
go_55:
    s_barrier
    s_barrier
    s_cmp_lg_u32 s6, 4
    s_cbranch_scc1 lgow_52
    s_waitcnt vmcnt(0)
    v_cmp_eq_u32 vcc, 0, v15
    s_nop 4
    s_cbranch_vccz lgob_54
    s_mov_b32 s61, 100000
poll_56:
    buffer_load_dword v15, v14, s[8:11], s60 offen sc1
    s_waitcnt vmcnt(0)
    v_cmp_eq_u32 vcc, 0, v15
    s_sub_u32 s61, s61, 1
    s_cbranch_scc1 polld_57
    s_nop 1
    s_cbranch_vccz polld_57
    s_sleep 2
    s_branch poll_56
polld_57:
lgob_54:
    v_mov_b32 v7, 1
    ds_write_b32 v6, v7
    s_branch lgo_51
lgow_52:
    ds_read_b32 v7, v6
    s_waitcnt lgkmcnt(0)
    v_cmp_eq_u32 vcc, 0, v7
    s_nop 4
    s_cbranch_vccnz lgow_52
lgo_51:
    s_add_u32 m0, s44, s40
    s_add_u32 s50, s50, 1
    s_and_b32 s52, s50, 7
    s_cmp_eq_u32 s52, s53
    s_addc_u32 s50, s50, 0
    s_lshl_b32 s52, s50, 14
    s_add_u32 s52, s52, s42
    buffer_load_dwordx4 v2, s[8:11], s52 offen offset:0 sc1 lds
    buffer_load_dwordx4 v2, s[8:11], s52 offen offset:1024 sc1 lds
    buffer_load_dwordx4 v2, s[8:11], s52 offen offset:2048 sc1 lds
    buffer_load_dwordx4 v2, s[8:11], s52 offen offset:3072 sc1 lds
    s_add_u32 s44, s44, 16384
    s_cmp_ge_u32 s44, 65536
    s_cselect_b32 s44, 0, s44
    s_add_u32 m0, s45, s40
    s_add_u32 s51, s51, 1
    s_and_b32 s52, s51, 7
    s_cmp_eq_u32 s52, s53
    s_addc_u32 s51, s51, 0
    s_lshl_b32 s52, s51, 14
    s_add_u32 s52, s52, s43
    buffer_load_dwordx4 v2, s[8:11], s52 offen offset:0 sc1 lds
    buffer_load_dwordx4 v2, s[8:11], s52 offen offset:1024 sc1 lds
    buffer_load_dwordx4 v2, s[8:11], s52 offen offset:2048 sc1 lds
    buffer_load_dwordx4 v2, s[8:11], s52 offen offset:3072 sc1 lds
    s_add_u32 s45, s45, 16384
    s_cmp_ge_u32 s45, 147456
    s_cselect_b32 s45, 65536, s45
    s_add_u32 m0, s44, s40
    s_add_u32 s50, s50, 1
    s_and_b32 s52, s50, 7
    s_cmp_eq_u32 s52, s53
    s_addc_u32 s50, s50, 0
    s_lshl_b32 s52, s50, 14
    s_add_u32 s52, s52, s42
    buffer_load_dwordx4 v2, s[8:11], s52 offen offset:0 sc1 lds
    buffer_load_dwordx4 v2, s[8:11], s52 offen offset:1024 sc1 lds
    buffer_load_dwordx4 v2, s[8:11], s52 offen offset:2048 sc1 lds
    buffer_load_dwordx4 v2, s[8:11], s52 offen offset:3072 sc1 lds
    s_add_u32 s44, s44, 16384
    s_cmp_ge_u32 s44, 65536
    s_cselect_b32 s44, 0, s44
    s_barrier
    s_add_u32 m0, s45, s40
    s_add_u32 s51, s51, 1
    s_and_b32 s52, s51, 7
    s_cmp_eq_u32 s52, s53
    s_addc_u32 s51, s51, 0
    s_lshl_b32 s52, s51, 14
    s_add_u32 s52, s52, s43
    buffer_load_dwordx4 v2, s[8:11], s52 offen offset:0 sc1 lds
    buffer_load_dwordx4 v2, s[8:11], s52 offen offset:1024 sc1 lds
    buffer_load_dwordx4 v2, s[8:11], s52 offen offset:2048 sc1 lds
    buffer_load_dwordx4 v2, s[8:11], s52 offen offset:3072 sc1 lds
    s_add_u32 s45, s45, 16384
    s_cmp_ge_u32 s45, 147456
    s_cselect_b32 s45, 65536, s45
    s_add_u32 m0, s44, s40
    s_add_u32 s50, s50, 1
    s_and_b32 s52, s50, 7
    s_cmp_eq_u32 s52, s53
    s_addc_u32 s50, s50, 0
    s_lshl_b32 s52, s50, 14
    s_add_u32 s52, s52, s42
    buffer_load_dwordx4 v2, s[8:11], s52 offen offset:0 sc1 lds
    buffer_load_dwordx4 v2, s[8:11], s52 offen offset:1024 sc1 lds
    buffer_load_dwordx4 v2, s[8:11], s52 offen offset:2048 sc1 lds
    buffer_load_dwordx4 v2, s[8:11], s52 offen offset:3072 sc1 lds
    s_add_u32 s44, s44, 16384
    s_cmp_ge_u32 s44, 65536
    s_cselect_b32 s44, 0, s44
    s_waitcnt vmcnt(16)
    s_barrier
    s_cmp_lg_u32 s6, 5
    s_cbranch_scc1 pub2_58
    s_lshl_b32 s60, s4, 11
    s_add_u32 s60, s60, s38
    s_add_u32 s60, s60, 131072
    s_lshl_b32 s61, s5, 2
    s_add_u32 s61, s61, s60
    v_mov_b32 v15, 1
    s_mov_b64 exec, 1
    buffer_store_dword v15, off, s[8:11], s61 sc0 sc1
    s_mov_b64 exec, -1
pub2_58:
    s_add_u32 m0, s45, s40
    s_add_u32 s51, s51, 1
    s_and_b32 s52, s51, 7
    s_cmp_eq_u32 s52, s53
    s_addc_u32 s51, s51, 0
    s_lshl_b32 s52, s51, 14
    s_add_u32 s52, s52, s43
    buffer_load_dwordx4 v2, s[8:11], s52 offen offset:0 sc1 lds
    buffer_load_dwordx4 v2, s[8:11], s52 offen offset:1024 sc1 lds
    buffer_load_dwordx4 v2, s[8:11], s52 offen offset:2048 sc1 lds
    buffer_load_dwordx4 v2, s[8:11], s52 offen offset:3072 sc1 lds
    s_add_u32 s45, s45, 16384
    s_cmp_ge_u32 s45, 147456
    s_cselect_b32 s45, 65536, s45
    s_add_u32 m0, s44, s40
    s_add_u32 s50, s50, 1
    s_and_b32 s52, s50, 7
    s_cmp_eq_u32 s52, s53
    s_addc_u32 s50, s50, 0
    s_lshl_b32 s52, s50, 14
    s_add_u32 s52, s52, s42
    buffer_load_dwordx4 v2, s[8:11], s52 offen offset:0 sc1 lds
    buffer_load_dwordx4 v2, s[8:11], s52 offen offset:1024 sc1 lds
    buffer_load_dwordx4 v2, s[8:11], s52 offen offset:2048 sc1 lds
    buffer_load_dwordx4 v2, s[8:11], s52 offen offset:3072 sc1 lds
    s_add_u32 s44, s44, 16384
    s_cmp_ge_u32 s44, 65536
    s_cselect_b32 s44, 0, s44
    s_mov_b32 s46, 2
ffn2_ld_59:
    s_waitcnt vmcnt(16)
    s_barrier
    s_add_u32 m0, s45, s40
    s_add_u32 s51, s51, 1
    s_and_b32 s52, s51, 7
    s_cmp_eq_u32 s52, s53
    s_addc_u32 s51, s51, 0
    s_lshl_b32 s52, s51, 14
    s_add_u32 s52, s52, s43
    buffer_load_dwordx4 v2, s[8:11], s52 offen offset:0 sc1 lds
    buffer_load_dwordx4 v2, s[8:11], s52 offen offset:1024 sc1 lds
    buffer_load_dwordx4 v2, s[8:11], s52 offen offset:2048 sc1 lds
    buffer_load_dwordx4 v2, s[8:11], s52 offen offset:3072 sc1 lds
    s_add_u32 s45, s45, 16384
    s_cmp_ge_u32 s45, 147456
    s_cselect_b32 s45, 65536, s45
    s_add_u32 m0, s44, s40
    s_add_u32 s50, s50, 1
    s_and_b32 s52, s50, 7
    s_cmp_eq_u32 s52, s53
    s_addc_u32 s50, s50, 0
    s_lshl_b32 s52, s50, 14
    s_add_u32 s52, s52, s42
    buffer_load_dwordx4 v2, s[8:11], s52 offen offset:0 sc1 lds
    buffer_load_dwordx4 v2, s[8:11], s52 offen offset:1024 sc1 lds
    buffer_load_dwordx4 v2, s[8:11], s52 offen offset:2048 sc1 lds
    buffer_load_dwordx4 v2, s[8:11], s52 offen offset:3072 sc1 lds
    s_add_u32 s44, s44, 16384
    s_cmp_ge_u32 s44, 65536
    s_cselect_b32 s44, 0, s44
    s_sub_u32 s46, s46, 1
    s_cmp_lg_u32 s46, 0
    s_cbranch_scc1 ffn2_ld_59
    s_waitcnt vmcnt(16)
    s_barrier
    s_cmp_lg_u32 s6, 4
    s_cbranch_scc1 look2_60
    s_lshl_b32 s60, s4, 11
    s_add_u32 s60, s60, s38
    s_add_u32 s60, s60, 131072
    buffer_load_dword v15, v14, s[8:11], s60 offen sc1
look2_60:
    s_add_u32 m0, s45, s40
    s_add_u32 s51, s51, 1
    s_and_b32 s52, s51, 7
    s_cmp_eq_u32 s52, s53
    s_addc_u32 s51, s51, 0
    s_lshl_b32 s52, s51, 14
    s_add_u32 s52, s52, s43
    buffer_load_dwordx4 v2, s[8:11], s52 offen offset:0 sc1 lds
    buffer_load_dwordx4 v2, s[8:11], s52 offen offset:1024 sc1 lds
    buffer_load_dwordx4 v2, s[8:11], s52 offen offset:2048 sc1 lds
    buffer_load_dwordx4 v2, s[8:11], s52 offen offset:3072 sc1 lds
    s_add_u32 s45, s45, 16384
    s_cmp_ge_u32 s45, 147456
    s_cselect_b32 s45, 65536, s45
    s_add_u32 m0, s44, s40
    s_add_u32 s50, s50, 1
    s_and_b32 s52, s50, 7
    s_cmp_eq_u32 s52, s53
    s_addc_u32 s50, s50, 0
    s_lshl_b32 s52, s50, 14
    s_add_u32 s52, s52, s42
    buffer_load_dwordx4 v2, s[8:11], s52 offen offset:0 sc1 lds
    buffer_load_dwordx4 v2, s[8:11], s52 offen offset:1024 sc1 lds
    buffer_load_dwordx4 v2, s[8:11], s52 offen offset:2048 sc1 lds
    buffer_load_dwordx4 v2, s[8:11], s52 offen offset:3072 sc1 lds
    s_add_u32 s44, s44, 16384
    s_cmp_ge_u32 s44, 65536
    s_cselect_b32 s44, 0, s44
    s_cmp_lg_u32 s6, 4
    s_cbranch_scc1 chk2_61
    s_waitcnt vmcnt(8)
    v_cmp_eq_u32 vcc, 0, v15
    s_nop 4
    s_cbranch_vccz chk2_61
    s_mov_b32 s61, 100000
poll_62:
    buffer_load_dword v15, v14, s[8:11], s60 offen sc1
    s_waitcnt vmcnt(0)
    v_cmp_eq_u32 vcc, 0, v15
    s_sub_u32 s61, s61, 1
    s_cbranch_scc1 polld_63
    s_nop 1
    s_cbranch_vccz polld_63
    s_sleep 2
    s_branch poll_62
polld_63:
chk2_61:
    s_mov_b32 s46, 14
ffn2_ld_64:
    s_waitcnt vmcnt(16)
    s_barrier
    s_add_u32 m0, s45, s40
    s_add_u32 s51, s51, 1
    s_and_b32 s52, s51, 7
    s_cmp_eq_u32 s52, s53
    s_addc_u32 s51, s51, 0
    s_lshl_b32 s52, s51, 14
    s_add_u32 s52, s52, s43
    buffer_load_dwordx4 v2, s[8:11], s52 offen offset:0 sc1 lds
    buffer_load_dwordx4 v2, s[8:11], s52 offen offset:1024 sc1 lds
    buffer_load_dwordx4 v2, s[8:11], s52 offen offset:2048 sc1 lds
    buffer_load_dwordx4 v2, s[8:11], s52 offen offset:3072 sc1 lds
    s_add_u32 s45, s45, 16384
    s_cmp_ge_u32 s45, 147456
    s_cselect_b32 s45, 65536, s45
    s_add_u32 m0, s44, s40
    s_add_u32 s50, s50, 1
    s_and_b32 s52, s50, 7
    s_cmp_eq_u32 s52, s53
    s_addc_u32 s50, s50, 0
    s_lshl_b32 s52, s50, 14
    s_add_u32 s52, s52, s42
    buffer_load_dwordx4 v2, s[8:11], s52 offen offset:0 sc1 lds
    buffer_load_dwordx4 v2, s[8:11], s52 offen offset:1024 sc1 lds
    buffer_load_dwordx4 v2, s[8:11], s52 offen offset:2048 sc1 lds
    buffer_load_dwordx4 v2, s[8:11], s52 offen offset:3072 sc1 lds
    s_add_u32 s44, s44, 16384
    s_cmp_ge_u32 s44, 65536
    s_cselect_b32 s44, 0, s44
    s_sub_u32 s46, s46, 1
    s_cmp_lg_u32 s46, 0
    s_cbranch_scc1 ffn2_ld_64
    s_waitcnt vmcnt(16)
    s_barrier
    s_add_u32 m0, s45, s40
    s_mov_b32 s51, 24
    s_lshl_b32 s52, s51, 14
    s_add_u32 s52, s52, s43
    buffer_load_dwordx4 v2, s[8:11], s52 offen offset:0 sc1 lds
    buffer_load_dwordx4 v2, s[8:11], s52 offen offset:1024 sc1 lds
    buffer_load_dwordx4 v2, s[8:11], s52 offen offset:2048 sc1 lds
    buffer_load_dwordx4 v2, s[8:11], s52 offen offset:3072 sc1 lds
    s_add_u32 s45, s45, 16384
    s_cmp_ge_u32 s45, 147456
    s_cselect_b32 s45, 65536, s45
    s_add_u32 m0, s44, s40
    s_mov_b32 s50, 24
    s_lshl_b32 s52, s50, 14
    s_add_u32 s52, s52, s42
    buffer_load_dwordx4 v2, s[8:11], s52 offen offset:0 sc1 lds
    buffer_load_dwordx4 v2, s[8:11], s52 offen offset:1024 sc1 lds
    buffer_load_dwordx4 v2, s[8:11], s52 offen offset:2048 sc1 lds
    buffer_load_dwordx4 v2, s[8:11], s52 offen offset:3072 sc1 lds
    s_add_u32 s44, s44, 16384
    s_cmp_ge_u32 s44, 65536
    s_cselect_b32 s44, 0, s44
    s_mov_b32 s46, 3
ffn2_ld_65:
    s_waitcnt vmcnt(16)
    s_barrier
    s_add_u32 m0, s45, s40
    s_add_u32 s51, s51, 1
    s_lshl_b32 s52, s51, 14
    s_add_u32 s52, s52, s43
    buffer_load_dwordx4 v2, s[8:11], s52 offen offset:0 sc1 lds
    buffer_load_dwordx4 v2, s[8:11], s52 offen offset:1024 sc1 lds
    buffer_load_dwordx4 v2, s[8:11], s52 offen offset:2048 sc1 lds
    buffer_load_dwordx4 v2, s[8:11], s52 offen offset:3072 sc1 lds
    s_add_u32 s45, s45, 16384
    s_cmp_ge_u32 s45, 147456
    s_cselect_b32 s45, 65536, s45
    s_add_u32 m0, s44, s40
    s_add_u32 s50, s50, 1
    s_lshl_b32 s52, s50, 14
    s_add_u32 s52, s52, s42
    buffer_load_dwordx4 v2, s[8:11], s52 offen offset:0 sc1 lds
    buffer_load_dwordx4 v2, s[8:11], s52 offen offset:1024 sc1 lds
    buffer_load_dwordx4 v2, s[8:11], s52 offen offset:2048 sc1 lds
    buffer_load_dwordx4 v2, s[8:11], s52 offen offset:3072 sc1 lds
    s_add_u32 s44, s44, 16384
    s_cmp_ge_u32 s44, 65536
    s_cselect_b32 s44, 0, s44
    s_sub_u32 s46, s46, 1
    s_cmp_lg_u32 s46, 0
    s_cbranch_scc1 ffn2_ld_65
    s_waitcnt vmcnt(16)
    s_barrier
    s_waitcnt vmcnt(8)
    s_barrier
    s_cmp_eq_u32 s3, 0
    s_cbranch_scc1 wkv_66
    s_waitcnt vmcnt(0)
    s_branch wkvj_67
wkv_66:
    v_lshrrev_b32 v12, 4, v0
    v_lshlrev_b32 v12, 3, v12
    v_bfe_u32 v13, v0, 2, 2
    v_add_u32 v12, v12, v13
    v_lshlrev_b32 v8, 6, v12
    v_bfe_u32 v12, v0, 4, 1
    v_lshlrev_b32 v12, 1, v12
    v_and_b32 v13, 3, v0
    v_xor_b32 v12, v12, v13
    v_lshl_add_u32 v8, v12, 4, v8
    s_lshl_b32 s50, s7, 14
    s_add_u32 s58, s50, 98304
    s_cmp_eq_u32 s7, 0
    s_cselect_b32 s58, 65536, s58
    s_add_u32 m0, s58, 0
    s_add_u32 s47, s50, 0
    buffer_load_dwordx4 v8, s[24:27], s47 offen lds
    s_add_u32 m0, s58, 1024
    s_add_u32 s47, s50, 256
    buffer_load_dwordx4 v8, s[24:27], s47 offen lds
    s_add_u32 m0, s58, 2048
    s_add_u32 s47, s50, 2048
    buffer_load_dwordx4 v8, s[24:27], s47 offen lds
    s_add_u32 m0, s58, 3072
    s_add_u32 s47, s50, 2304
    buffer_load_dwordx4 v8, s[24:27], s47 offen lds
    s_add_u32 m0, s58, 4096
    s_add_u32 s47, s50, 4096
    buffer_load_dwordx4 v8, s[24:27], s47 offen lds
    s_add_u32 m0, s58, 5120
    s_add_u32 s47, s50, 4352
    buffer_load_dwordx4 v8, s[24:27], s47 offen lds
    s_add_u32 m0, s58, 6144
    s_add_u32 s47, s50, 6144
    buffer_load_dwordx4 v8, s[24:27], s47 offen lds
    s_add_u32 m0, s58, 7168
    s_add_u32 s47, s50, 6400
    buffer_load_dwordx4 v8, s[24:27], s47 offen lds
wkvj_67:
    s_waitcnt vmcnt(8)
    s_barrier
    s_cmp_eq_u32 s3, 0
    s_cbranch_scc1 wkv_68
    s_waitcnt vmcnt(0)
    s_branch wkvj_69
wkv_68:
    s_add_u32 m0, s58, 8192
    s_add_u32 s47, s50, 8192
    buffer_load_dwordx4 v8, s[24:27], s47 offen lds
    s_add_u32 m0, s58, 9216
    s_add_u32 s47, s50, 8448
    buffer_load_dwordx4 v8, s[24:27], s47 offen lds
    s_add_u32 m0, s58, 10240
    s_add_u32 s47, s50, 10240
    buffer_load_dwordx4 v8, s[24:27], s47 offen lds
    s_add_u32 m0, s58, 11264
    s_add_u32 s47, s50, 10496
    buffer_load_dwordx4 v8, s[24:27], s47 offen lds
    s_add_u32 m0, s58, 12288
    s_add_u32 s47, s50, 12288
    buffer_load_dwordx4 v8, s[24:27], s47 offen lds
    s_add_u32 m0, s58, 13312
    s_add_u32 s47, s50, 12544
    buffer_load_dwordx4 v8, s[24:27], s47 offen lds
    s_add_u32 m0, s58, 14336
    s_add_u32 s47, s50, 14336
    buffer_load_dwordx4 v8, s[24:27], s47 offen lds
    s_add_u32 m0, s58, 15360
    s_add_u32 s47, s50, 14592
    buffer_load_dwordx4 v8, s[24:27], s47 offen lds
wkvj_69:
    s_barrier
    s_cmp_lg_u32 s3, 0
    s_cbranch_scc1 k_done
layer_end:
    s_cmp_lg_u32 s3, 0
    s_cbranch_scc1 k_done
    s_mov_b32 s3, 1
    s_mov_b32 s36, 0x2000000
    s_mov_b32 s38, 0x4528000
    s_mov_b32 s12, s16
    s_mov_b32 s13, s17
    s_mov_b32 s16, s70
    s_mov_b32 s17, s71
    s_add_u32 s20, s72, 0x6200000
    s_addc_u32 s21, s73, 0
    s_cmp_ge_u32 s6, 4
    s_cbranch_scc1 qkv_loader
    s_branch qkv_compute
k_done:
k_exit:
    s_endpgm
.section .rodata,"a"
.p2align 6
.amdhsa_kernel interleave_layers__grouped_kv_mqa__dense_activation_silu__prompt_kernel
  .amdhsa_next_free_vgpr 248
  .amdhsa_next_free_sgpr 90
  .amdhsa_accum_offset 248
  .amdhsa_group_segment_fixed_size 0
  .amdhsa_kernarg_size 88
  .amdhsa_user_sgpr_count 2
  .amdhsa_user_sgpr_kernarg_segment_ptr 1
  .amdhsa_system_sgpr_workgroup_id_x 1
.end_amdhsa_kernel
```
